```python
import torch

def _softmax(x, axis=-1):
    return torch.softmax(x, dim=axis)

def _gelu(x):
    return torch.nn.functional.gelu(x, approximate='tanh')

def _silu(x):
    return torch.nn.functional.silu(x)

def _sigmoid(x):
    return torch.sigmoid(x)

def _layernorm(x, axis=-1, eps=1e-05):
    m = x.mean(dim=axis, keepdim=True)
    v = x.var(dim=axis, keepdim=True, unbiased=False)
    return (x - m) / torch.sqrt(v + eps)

def _scatter_add(tgt, idx, src, axis=0):
    return tgt.clone().index_add_(axis, idx, src)

def _segment_sum(src, seg, n):
    out = torch.zeros((n,) + src.shape[1:], dtype=src.dtype)
    return out.index_add_(0, seg, src)

def _pad(x, pw):
    flat = tuple((v for pair in reversed(pw) for v in pair))
    return torch.nn.functional.pad(x, flat)
kernel_name = 'adaLN_cond__spectral_fnet__dense_activation_relu__prompt'

def setup_inputs():

    _w = lambda a: (lambda t: t.to(torch.bfloat16) if t.is_floating_point() else t)(torch.as_tensor(a))

    def _A_setup():
        B, S, D = (1, 2048, 512)
        ns = torch.arange(S)[:, None] * torch.arange(S)[None, :]
        nd = torch.arange(D)[:, None] * torch.arange(D)[None, :]
        Ws_re = torch.cos(-2.0 * torch.pi * ns / S).to(float)
        Ws_im = torch.sin(-2.0 * torch.pi * ns / S).to(float)
        Wd_re = torch.cos(-2.0 * torch.pi * nd / D).to(float)
        Wd_im = torch.sin(-2.0 * torch.pi * nd / D).to(float)
        return {'x': _w((lambda *s: torch.randn(*s, dtype=torch.bfloat16) * 0.1)(B, S, D)), 'dft_seq_re': _w(Ws_re), 'dft_seq_im': _w(Ws_im), 'dft_hid_re': _w(Wd_re), 'dft_hid_im': _w(Wd_im)}
    _A_in = _A_setup()

    def _B_setup():
        B, S, D, Dff = (1, 2048, 512, 1376)
        return {'x': _w((lambda *s: torch.randn(*s, dtype=torch.bfloat16) * 0.1)(B, S, D)), 'w1': _w((lambda *s: torch.randn(*s, dtype=torch.bfloat16) * 3.2)(D, Dff)), 'w2': _w((lambda *s: torch.randn(*s, dtype=torch.bfloat16) * 3.2)(Dff, D))}
    _B_in = _B_setup()
    return {'A_x': _A_in['x'], 'A_dft_seq_re': _A_in['dft_seq_re'], 'A_dft_seq_im': _A_in['dft_seq_im'], 'A_dft_hid_re': _A_in['dft_hid_re'], 'A_dft_hid_im': _A_in['dft_hid_im'], 'B_x': _B_in['x'], 'B_w1': _B_in['w1'], 'B_w2': _B_in['w2'], 'c': _w((lambda *s: torch.randn(*s, dtype=torch.bfloat16) * 0.2)(1, 512) * 8.0), 'w_mod': _w((lambda *s: torch.randn(*s, dtype=torch.bfloat16) * 0.2)(512, 6 * 512) * 512 ** (-0.5) * 8.0)}

def reference(A_x, A_dft_seq_re, A_dft_seq_im, A_dft_hid_re, A_dft_hid_im, B_x, B_w1, B_w2, c, w_mod):

    def _A_ref(x, dft_seq_re, dft_seq_im, dft_hid_re, dft_hid_im):
        a = torch.einsum('bsd,ed->bse', x, dft_hid_re)
        b = torch.einsum('bsd,ed->bse', x, dft_hid_im)
        y = torch.einsum('ts,bse->bte', dft_seq_re, a) - torch.einsum('ts,bse->bte', dft_seq_im, b)
        return y

    def _B_ref(x, w1, w2):
        h = torch.einsum('bsd,df->bsf', x, w1)
        zero = torch.zeros_like(h)
        h = torch.maximum(h, zero)
        return torch.einsum('bsf,fd->bsd', h, w2)
    x = A_x
    mod = (_silu(c) @ w_mod).reshape(c.shape[0], 6, 1, -1)
    sa, ca, ga, sb, cb, gb = (mod[:, 0].clone(), mod[:, 1].clone(), mod[:, 2].clone(), mod[:, 3].clone(), mod[:, 4].clone(), mod[:, 5].clone())
    h = _layernorm(x, axis=-1) * (1 + ca) + sa
    x = x + ga * _A_ref(h, A_dft_seq_re, A_dft_seq_im, A_dft_hid_re, A_dft_hid_im)
    h = _layernorm(x, axis=-1) * (1 + cb) + sb
    x = x + gb * _B_ref(h, B_w1, B_w2)
    return x
```

```asm
; @launch grid=(256,1,1) block=(256,1,1) lds=163840
.amdgcn_target "amdgcn-amd-amdhsa--gfx950"
.text
.globl adaLN_cond__spectral_fnet__dense_activation_relu__prompt_kernel
.p2align 8
.type adaLN_cond__spectral_fnet__dense_activation_relu__prompt_kernel,@function
adaLN_cond__spectral_fnet__dense_activation_relu__prompt_kernel:
    s_cmp_ge_u32 s2, 256
    s_cbranch_scc1 K_END
    s_load_dwordx4 s[52:55], s[0:1], 64
    s_load_dwordx8 s[40:47], s[0:1], 0
    s_load_dwordx2 s[48:49], s[0:1], 32
    s_load_dwordx4 s[56:59], s[0:1], 88
    s_memrealtime s[60:61]
    v_lshrrev_b32 v22, 6, v0
    v_and_b32 v23, 7, v0
    v_lshrrev_b32 v28, 3, v0
    v_and_b32 v0, 63, v0
    v_readfirstlane_b32 s3, v22
    v_lshlrev_b32 v1, 4, v0
    s_getpc_b64 s[62:63]
K_PC:
    s_lshr_b32 s65, s2, 3
    s_lshl2_add_u32 s65, s65, s3
    s_lshl_b32 s65, s65, 9
    v_lshlrev_b32 v22, 6, v0
    v_add_u32 v22, s65, v22
    v_min_u32 v22, K_LAST-K_PC, v22
    s_mov_b64 exec, 0xff
    global_load_dword v63, v22, s[62:63]
    s_mov_b64 exec, -1
    s_and_b32 s26, s2, 3
    s_lshr_b32 s36, s2, 3
    s_and_b32 s27, s36, 3
    s_lshr_b32 s28, s36, 2
    s_and_b32 s37, s2, 4
    s_lshl_b32 s37, s37, 1
    s_add_u32 s29, s37, s28
    s_mul_i32 s30, s3, 20480
    s_add_u32 s30, s30, 65536
    s_and_b32 s31, s27, 1
    s_xor_b32 s31, s31, s28
    s_lshl_b32 s31, s31, 1
    v_lshlrev_b32 v22, 3, v28
    v_mul_u32_u24 v28, 24576, v28
    v_lshl_add_u32 v23, v23, 4, v28
    s_lshl_b32 s23, s27, 3
    s_add_u32 s23, s23, s28
    s_lshl_b32 s23, s23, 3
    s_and_b32 s37, s2, 7
    s_add_u32 s23, s23, s37
    s_sub_u32 s23, s23, 64
    s_and_b32 s36, s26, 1
    s_lshl_b32 s37, s36, 4
    s_add_u32 s37, s37, s29
    s_lshl_b32 s22, s37, 3
    s_lshr_b32 s38, s27, 1
    s_mul_i32 s38, s38, 1
    s_lshl_b32 s37, s38, 2
    s_add_u32 s22, s22, s37
    s_add_u32 s22, s22, s3
    s_lshl_b32 s22, s22, 1
    s_and_b32 s37, s27, 1
    s_add_u32 s22, s22, s37
    s_lshl_b32 s22, s22, 12
    s_lshl_b32 s20, s29, 2
    s_add_u32 s20, s20, s3
    s_lshl_b32 s20, s20, 6
    s_add_u32 s20, s20, s36
    s_lshl_b32 s20, s20, 4
    s_add_u32 s20, s20, s31
    s_lshl_b32 s20, s20, 7
    s_lshl_b32 s21, s27, 2
    s_add_u32 s21, s21, s3
    s_lshl_b32 s21, s21, 8
    s_add_u32 s21, s21, s28
    s_lshl_b32 s21, s21, 7
    v_lshrrev_b32 v27, 3, v0
    v_lshrrev_b32 v28, 4, v0
    v_and_b32 v29, 7, v0
    v_xor_b32 v28, v29, v28
    v_xor_b32 v29, 4, v28
    v_lshlrev_b32 v28, 4, v28
    v_lshlrev_b32 v29, 4, v29
    v_lshl_add_u32 v6, v27, 10, v28
    v_lshl_add_u32 v7, v27, 10, v29
    v_add_u32 v8, 14336, v6
    v_add_u32 v9, 21504, v7
    v_add_u32 v7, 7168, v7
    v_lshl_add_u32 v2, v27, 12, v28
    v_lshl_add_u32 v3, v27, 12, v29
    v_add_u32 v4, 63488, v2
    v_add_u32 v5, 95232, v3
    v_add_u32 v3, 31744, v3
    s_and_b32 s37, s23, 3
    s_mul_i32 s36, s37, 786432
    s_lshr_b32 s38, s23, 2
    s_lshl_b32 s38, s38, 7
    s_add_u32 s36, s36, s38
    s_lshl_b32 s37, s37, 8
    s_lshl_b32 s38, s23, 2
    s_waitcnt lgkmcnt(0)
    s_mov_b32 s32, s56
    s_and_b32 s33, s57, 0xffff
    s_mov_b32 s34, 256
    s_mov_b32 s35, 0x00020000
    s_or_b32 s24, s60, 1
    s_cmp_lg_u32 s27, 1
    s_cbranch_scc1 NOMOD_1
    s_mov_b32 s12, s52
    s_and_b32 s13, s53, 0xffff
    s_mov_b32 s14, 1024
    s_mov_b32 s15, 0x00020000
    s_mov_b32 s16, s54
    s_and_b32 s17, s55, 0xffff
    s_mov_b32 s18, 3145728
    s_mov_b32 s19, 0x00020000
    buffer_load_dwordx4 v[32:35], v23, s[16:19], s36 offen
    buffer_load_dwordx2 v[48:49], v22, s[12:15], s37 offen
    s_add_u32 s36, s36, 6144
    buffer_load_dwordx4 v[36:39], v23, s[16:19], s36 offen
    s_add_u32 s36, s36, 6144
    buffer_load_dwordx4 v[40:43], v23, s[16:19], s36 offen
    s_add_u32 s36, s36, 6144
    buffer_load_dwordx4 v[44:47], v23, s[16:19], s36 offen
    v_mov_b32 v226, s24
    v_mov_b32 v227, s3
    v_lshlrev_b32 v227, 8, v227
    s_mov_b64 exec, 1
    buffer_store_dword v226, v227, s[32:35], s38 offen sc1
    s_mov_b64 exec, -1
NOMOD_1:
    s_mov_b32 s8, s40
    s_and_b32 s9, s41, 0xffff
    s_mov_b32 s10, 2097152
    s_mov_b32 s11, 0x00020000
    s_cmp_lt_u32 s26, 2
    s_cselect_b32 s12, s42, s44
    s_cselect_b32 s13, s43, s45
    s_cselect_b32 s16, s46, s48
    s_cselect_b32 s17, s47, s49
    s_and_b32 s13, s13, 0xffff
    s_mov_b32 s14, 8388608
    s_mov_b32 s15, 0x00020000
    s_and_b32 s17, s17, 0xffff
    s_mov_b32 s18, 524288
    s_mov_b32 s19, 0x00020000
    s_mov_b32 s4, s58
    s_and_b32 s5, s59, 0xffff
    s_mov_b32 s6, 30408704
    s_mov_b32 s7, 0x00020000
    s_xor_b32 s36, s22, 0
    buffer_load_dwordx4 v[68:71], v1, s[8:11], s36 offen offset:0
    buffer_load_dwordx4 v[76:79], v1, s[8:11], s36 offen offset:1024
    buffer_load_dwordx4 v[84:87], v1, s[8:11], s36 offen offset:2048
    buffer_load_dwordx4 v[92:95], v1, s[8:11], s36 offen offset:3072
    s_add_u32 m0, s30, 0
    s_xor_b32 s36, s21, 0
    buffer_load_dwordx4 v6, s[16:19], s36 offen offset:0  lds
    buffer_load_dwordx4 v7, s[16:19], s36 offen offset:1024  lds
    buffer_load_dwordx4 v8, s[16:19], s36 offen offset:2048  lds
    buffer_load_dwordx4 v9, s[16:19], s36 offen offset:3072  lds
    v_and_b32 v27, 19, v0
    v_and_b32 v28, 4, v0
    v_lshl_or_b32 v27, v28, 1, v27
    v_and_b32 v28, 8, v0
    v_lshrrev_b32 v28, 1, v28
    v_or_b32 v27, v27, v28
    v_lshrrev_b32 v28, 5, v0
    v_bfe_u32 v29, v27, 1, 3
    v_xor_b32 v29, v29, v28
    v_lshlrev_b32 v29, 4, v29
    v_lshl_add_u32 v29, v27, 7, v29
    v_add_u32 v10, s30, v29
    v_xor_b32 v11, 32, v10
    v_xor_b32 v12, 64, v10
    v_xor_b32 v13, 96, v10
    v_and_b32 v29, 15, v27
    v_xor_b32 v29, v29, v28
    v_lshlrev_b32 v29, 4, v29
    v_lshl_add_u32 v30, v27, 10, v29
    s_lshl_b32 s36, s28, 5
    v_xor_b32 v14, s36, v30
    v_xor_b32 v15, 32, v14
    v_xor_b32 v16, 64, v14
    v_xor_b32 v17, 96, v14
    v_xor_b32 v18, 128, v14
    v_xor_b32 v19, 160, v14
    v_xor_b32 v20, 192, v14
    v_xor_b32 v21, 224, v14
    v_bfe_u32 v27, v0, 1, 2
    v_lshrrev_b32 v28, 3, v0
    v_xor_b32 v28, v28, v27
    v_and_b32 v29, 1, v0
    v_lshl_or_b32 v28, v28, 1, v29
    v_lshl_or_b32 v28, v27, 4, v28
    v_lshlrev_b32 v31, 4, v28
    s_lshl_b32 s36, s3, 1
    s_and_b32 s37, s27, 1
    s_add_u32 s36, s36, s37
    s_and_b32 s37, s36, 3
    s_lshl_b32 s37, s37, 6
    s_lshl_b32 s36, s36, 12
    s_or_b32 s36, s36, s37
    v_xor_b32 v31, s36, v31
    v_lshrrev_b32 v29, 4, v0
    v_lshl_add_u32 v29, s3, 2, v29
    v_lshlrev_b32 v28, 4, v29
    v_mov_b32 v29, 0
    v_lshrrev_b32 v62, 1, v0
    v_and_b32 v27, 1, v0
    v_lshlrev_b32 v27, 7, v27
    v_lshl_add_u32 v62, v62, 12, v27
    s_cmp_ge_u32 s27, 2
    s_cbranch_scc1 K_CL1
    s_mov_b32 s39, 0x40000000
    s_cmp_lg_u32 s27, 1
    s_cbranch_scc1 NOMOD2_2
    s_mov_b32 s36, 0x05040100
    s_mov_b32 s37, 0x07060302
    s_waitcnt vmcnt(12)
    v_lshlrev_b32 v192, 16, v48
    v_and_b32 v193, 0xffff0000, v48
    v_lshlrev_b32 v194, 16, v49
    v_and_b32 v195, 0xffff0000, v49
    v_mul_f32 v200, 0xbfb8aa3b, v192
    v_mul_f32 v201, 0xbfb8aa3b, v193
    v_mul_f32 v202, 0xbfb8aa3b, v194
    v_mul_f32 v203, 0xbfb8aa3b, v195
    v_exp_f32 v200, v200
    v_exp_f32 v201, v201
    v_exp_f32 v202, v202
    v_exp_f32 v203, v203
    v_add_f32 v200, 1.0, v200
    v_add_f32 v201, 1.0, v201
    v_add_f32 v202, 1.0, v202
    v_add_f32 v203, 1.0, v203
    v_rcp_f32 v200, v200
    v_rcp_f32 v201, v201
    v_rcp_f32 v202, v202
    v_rcp_f32 v203, v203
    v_mul_f32 v192, v192, v200
    v_mul_f32 v193, v193, v201
    v_mul_f32 v194, v194, v202
    v_mul_f32 v195, v195, v203
    v_cvt_pk_bf16_f32 v48, v192, v193
    v_cvt_pk_bf16_f32 v49, v194, v195
    v_and_b32 v216, 7, v0
    v_lshlrev_b32 v216, 5, v216
    v_and_b32 v217, 16, v0
    v_or_b32 v216, v216, v217
    v_lshrrev_b32 v217, 5, v0
    v_lshl_or_b32 v216, v217, 3, v216
    s_lshl_b32 s38, s3, 8
    s_add_u32 s38, s38, 147456
    v_add_u32 v216, s38, v216
    v_add_u32 v217, 147456, v1
    s_waitcnt vmcnt(11)
    v_perm_b32 v192, v36, v32, s36
    v_perm_b32 v193, v36, v32, s37
    v_perm_b32 v194, v37, v33, s36
    v_perm_b32 v195, v37, v33, s37
    v_perm_b32 v196, v38, v34, s36
    v_perm_b32 v197, v38, v34, s37
    v_perm_b32 v198, v39, v35, s36
    v_perm_b32 v199, v39, v35, s37
    v_dot2_f32_bf16 v208, v192, v48, 0
    v_dot2_f32_bf16 v209, v193, v48, 0
    v_dot2_f32_bf16 v210, v194, v48, 0
    v_dot2_f32_bf16 v211, v195, v48, 0
    v_dot2_f32_bf16 v212, v196, v48, 0
    v_dot2_f32_bf16 v213, v197, v48, 0
    v_dot2_f32_bf16 v214, v198, v48, 0
    v_dot2_f32_bf16 v215, v199, v48, 0
    s_waitcnt vmcnt(9)
    v_perm_b32 v192, v44, v40, s36
    v_perm_b32 v193, v44, v40, s37
    v_perm_b32 v194, v45, v41, s36
    v_perm_b32 v195, v45, v41, s37
    v_perm_b32 v196, v46, v42, s36
    v_perm_b32 v197, v46, v42, s37
    v_perm_b32 v198, v47, v43, s36
    v_perm_b32 v199, v47, v43, s37
    v_dot2c_f32_bf16 v208, v192, v49
    v_dot2c_f32_bf16 v209, v193, v49
    v_dot2c_f32_bf16 v210, v194, v49
    v_dot2c_f32_bf16 v211, v195, v49
    v_dot2c_f32_bf16 v212, v196, v49
    v_dot2c_f32_bf16 v213, v197, v49
    v_dot2c_f32_bf16 v214, v198, v49
    v_dot2c_f32_bf16 v215, v199, v49
    v_add_f32_dpp v208, v208, v208 row_ror:8 row_mask:0xf bank_mask:0xf
    v_add_f32_dpp v209, v209, v209 row_ror:8 row_mask:0xf bank_mask:0xf
    v_add_f32_dpp v210, v210, v210 row_ror:8 row_mask:0xf bank_mask:0xf
    v_add_f32_dpp v211, v211, v211 row_ror:8 row_mask:0xf bank_mask:0xf
    v_add_f32_dpp v212, v212, v212 row_ror:8 row_mask:0xf bank_mask:0xf
    v_add_f32_dpp v213, v213, v213 row_ror:8 row_mask:0xf bank_mask:0xf
    v_add_f32_dpp v214, v214, v214 row_ror:8 row_mask:0xf bank_mask:0xf
    v_add_f32_dpp v215, v215, v215 row_ror:8 row_mask:0xf bank_mask:0xf
    v_permlane16_swap_b32 v208, v212
    v_permlane16_swap_b32 v209, v213
    v_permlane16_swap_b32 v210, v214
    v_permlane16_swap_b32 v211, v215
    v_add_f32 v208, v208, v212
    v_add_f32 v209, v209, v213
    v_add_f32 v210, v210, v214
    v_add_f32 v211, v211, v215
    s_nop 0
    v_permlane32_swap_b32 v208, v210
    v_permlane32_swap_b32 v209, v211
    v_add_f32 v208, v208, v210
    v_add_f32 v209, v209, v211
    ds_write_b64 v216, v[208:209]
    s_and_b32 s36, s23, 3
    s_mul_i32 s36, s36, 12288
    s_lshr_b32 s37, s23, 2
    s_lshl_b32 s37, s37, 8
    s_add_u32 s36, s36, s37
    s_add_u32 s23, s36, 25690112
    s_mov_b32 s36, 0x07060501
    s_mov_b32 s37, 0x07060502
    s_mov_b32 s38, 0x07060503
    s_waitcnt lgkmcnt(0)
    s_barrier
    s_cmp_lg_u32 s3, 0
    s_cbranch_scc1 NOMOD2_2
    ds_read_b128 v[192:195], v217
    ds_read_b128 v[196:199], v217 offset:256
    ds_read_b128 v[200:203], v217 offset:512
    ds_read_b128 v[204:207], v217 offset:768
    v_mov_b32 v27, s24
    s_waitcnt lgkmcnt(2)
    v_add_f32 v192, v192, v196
    v_add_f32 v193, v193, v197
    v_add_f32 v194, v194, v198
    v_add_f32 v195, v195, v199
    s_waitcnt lgkmcnt(0)
    v_add_f32 v200, v200, v204
    v_add_f32 v201, v201, v205
    v_add_f32 v202, v202, v206
    v_add_f32 v203, v203, v207
    v_add_f32 v192, v192, v200
    v_add_f32 v193, v193, v201
    v_add_f32 v194, v194, v202
    v_add_f32 v195, v195, v203
    v_perm_b32 v24, v192, v195, s36
    v_perm_b32 v25, v193, v195, s37
    v_perm_b32 v26, v194, v195, s38
    s_mov_b32 s39, s23
NOMOD2_2:
    s_mov_b64 exec, 0xffff
    buffer_store_dwordx4 v[24:27], v1, s[4:7], s39 offen sc1
    s_mov_b64 exec, -1
    s_xor_b32 s36, s22, 4096
    buffer_load_dwordx4 v[100:103], v1, s[8:11], s36 offen offset:0
    buffer_load_dwordx4 v[108:111], v1, s[8:11], s36 offen offset:1024
    buffer_load_dwordx4 v[116:119], v1, s[8:11], s36 offen offset:2048
    buffer_load_dwordx4 v[124:127], v1, s[8:11], s36 offen offset:3072
    s_xor_b32 s36, s22, 32768
    buffer_load_dwordx4 v[132:135], v1, s[8:11], s36 offen offset:0
    buffer_load_dwordx4 v[140:143], v1, s[8:11], s36 offen offset:1024
    buffer_load_dwordx4 v[148:151], v1, s[8:11], s36 offen offset:2048
    buffer_load_dwordx4 v[156:159], v1, s[8:11], s36 offen offset:3072
    s_xor_b32 s36, s22, 36864
    buffer_load_dwordx4 v[164:167], v1, s[8:11], s36 offen offset:0
    buffer_load_dwordx4 v[172:175], v1, s[8:11], s36 offen offset:1024
    buffer_load_dwordx4 v[180:183], v1, s[8:11], s36 offen offset:2048
    buffer_load_dwordx4 v[188:191], v1, s[8:11], s36 offen offset:3072
    s_add_u32 m0, s30, 4096
    s_xor_b32 s36, s20, 0
    buffer_load_dwordx4 v2, s[12:15], s36 offen offset:0  lds
    buffer_load_dwordx4 v3, s[12:15], s36 offen offset:1024  lds
    buffer_load_dwordx4 v4, s[12:15], s36 offen offset:2048  lds
    buffer_load_dwordx4 v5, s[12:15], s36 offen offset:3072  lds
    s_add_u32 m0, s30, 8192
    s_xor_b32 s36, s20, 128
    buffer_load_dwordx4 v2, s[12:15], s36 offen offset:0  lds
    buffer_load_dwordx4 v3, s[12:15], s36 offen offset:1024  lds
    buffer_load_dwordx4 v4, s[12:15], s36 offen offset:2048  lds
    buffer_load_dwordx4 v5, s[12:15], s36 offen offset:3072  lds
    s_mov_b32 s38, 0x3f803f80
    s_waitcnt vmcnt(28)
    v_dot2_f32_bf16 v224, v68, s38, 0
    v_dot2_f32_bf16 v240, v68, v68, 0
    v_lshlrev_b32 v64, 16, v68
    v_and_b32 v65, 0xffff0000, v68
    v_lshlrev_b32 v66, 16, v69
    v_and_b32 v67, 0xffff0000, v69
    v_dot2c_f32_bf16 v224, s38, v69
    v_dot2c_f32_bf16 v240, v69, v69
    v_dot2c_f32_bf16 v224, s38, v70
    v_dot2c_f32_bf16 v240, v70, v70
    v_dot2c_f32_bf16 v224, s38, v71
    v_dot2c_f32_bf16 v240, v71, v71
    v_lshlrev_b32 v68, 16, v70
    v_and_b32 v69, 0xffff0000, v70
    v_lshlrev_b32 v70, 16, v71
    v_and_b32 v71, 0xffff0000, v71
    s_waitcnt vmcnt(27)
    v_dot2_f32_bf16 v225, v76, s38, 0
    v_dot2_f32_bf16 v241, v76, v76, 0
    v_lshlrev_b32 v72, 16, v76
    v_and_b32 v73, 0xffff0000, v76
    v_lshlrev_b32 v74, 16, v77
    v_and_b32 v75, 0xffff0000, v77
    v_dot2c_f32_bf16 v225, s38, v77
    v_dot2c_f32_bf16 v241, v77, v77
    v_dot2c_f32_bf16 v225, s38, v78
    v_dot2c_f32_bf16 v241, v78, v78
    v_dot2c_f32_bf16 v225, s38, v79
    v_dot2c_f32_bf16 v241, v79, v79
    v_lshlrev_b32 v76, 16, v78
    v_and_b32 v77, 0xffff0000, v78
    v_lshlrev_b32 v78, 16, v79
    v_and_b32 v79, 0xffff0000, v79
    s_waitcnt vmcnt(26)
    v_dot2_f32_bf16 v226, v84, s38, 0
    v_dot2_f32_bf16 v242, v84, v84, 0
    v_lshlrev_b32 v80, 16, v84
    v_and_b32 v81, 0xffff0000, v84
    v_lshlrev_b32 v82, 16, v85
    v_and_b32 v83, 0xffff0000, v85
    v_dot2c_f32_bf16 v226, s38, v85
    v_dot2c_f32_bf16 v242, v85, v85
    v_dot2c_f32_bf16 v226, s38, v86
    v_dot2c_f32_bf16 v242, v86, v86
    v_dot2c_f32_bf16 v226, s38, v87
    v_dot2c_f32_bf16 v242, v87, v87
    v_lshlrev_b32 v84, 16, v86
    v_and_b32 v85, 0xffff0000, v86
    v_lshlrev_b32 v86, 16, v87
    v_and_b32 v87, 0xffff0000, v87
    s_waitcnt vmcnt(25)
    v_dot2_f32_bf16 v227, v92, s38, 0
    v_dot2_f32_bf16 v243, v92, v92, 0
    v_lshlrev_b32 v88, 16, v92
    v_and_b32 v89, 0xffff0000, v92
    v_lshlrev_b32 v90, 16, v93
    v_and_b32 v91, 0xffff0000, v93
    v_dot2c_f32_bf16 v227, s38, v93
    v_dot2c_f32_bf16 v243, v93, v93
    v_dot2c_f32_bf16 v227, s38, v94
    v_dot2c_f32_bf16 v243, v94, v94
    v_dot2c_f32_bf16 v227, s38, v95
    v_dot2c_f32_bf16 v243, v95, v95
    v_lshlrev_b32 v92, 16, v94
    v_and_b32 v93, 0xffff0000, v94
    v_lshlrev_b32 v94, 16, v95
    v_and_b32 v95, 0xffff0000, v95
    s_waitcnt vmcnt(21)
    ds_read_b128 a[192:195], v10 offset:0
    ds_read_b128 a[196:199], v11 offset:0
    ds_read_b128 a[200:203], v12 offset:0
    ds_read_b128 a[204:207], v13 offset:0
    s_mov_b32 s38, 0x3f803f80
    s_waitcnt vmcnt(19)
    v_dot2_f32_bf16 v228, v100, s38, 0
    v_dot2_f32_bf16 v244, v100, v100, 0
    v_lshlrev_b32 v96, 16, v100
    v_and_b32 v97, 0xffff0000, v100
    v_lshlrev_b32 v98, 16, v101
    v_and_b32 v99, 0xffff0000, v101
    v_dot2c_f32_bf16 v228, s38, v101
    v_dot2c_f32_bf16 v244, v101, v101
    v_dot2c_f32_bf16 v228, s38, v102
    v_dot2c_f32_bf16 v244, v102, v102
    v_dot2c_f32_bf16 v228, s38, v103
    v_dot2c_f32_bf16 v244, v103, v103
    v_lshlrev_b32 v100, 16, v102
    v_and_b32 v101, 0xffff0000, v102
    v_lshlrev_b32 v102, 16, v103
    v_and_b32 v103, 0xffff0000, v103
    s_waitcnt vmcnt(18)
    v_dot2_f32_bf16 v229, v108, s38, 0
    v_dot2_f32_bf16 v245, v108, v108, 0
    v_lshlrev_b32 v104, 16, v108
    v_and_b32 v105, 0xffff0000, v108
    v_lshlrev_b32 v106, 16, v109
    v_and_b32 v107, 0xffff0000, v109
    v_dot2c_f32_bf16 v229, s38, v109
    v_dot2c_f32_bf16 v245, v109, v109
    v_dot2c_f32_bf16 v229, s38, v110
    v_dot2c_f32_bf16 v245, v110, v110
    v_dot2c_f32_bf16 v229, s38, v111
    v_dot2c_f32_bf16 v245, v111, v111
    v_lshlrev_b32 v108, 16, v110
    v_and_b32 v109, 0xffff0000, v110
    v_lshlrev_b32 v110, 16, v111
    v_and_b32 v111, 0xffff0000, v111
    s_waitcnt vmcnt(17)
    v_dot2_f32_bf16 v230, v116, s38, 0
    v_dot2_f32_bf16 v246, v116, v116, 0
    v_lshlrev_b32 v112, 16, v116
    v_and_b32 v113, 0xffff0000, v116
    v_lshlrev_b32 v114, 16, v117
    v_and_b32 v115, 0xffff0000, v117
    v_dot2c_f32_bf16 v230, s38, v117
    v_dot2c_f32_bf16 v246, v117, v117
    v_dot2c_f32_bf16 v230, s38, v118
    v_dot2c_f32_bf16 v246, v118, v118
    v_dot2c_f32_bf16 v230, s38, v119
    v_dot2c_f32_bf16 v246, v119, v119
    v_lshlrev_b32 v116, 16, v118
    v_and_b32 v117, 0xffff0000, v118
    v_lshlrev_b32 v118, 16, v119
    v_and_b32 v119, 0xffff0000, v119
    s_waitcnt vmcnt(16)
    v_dot2_f32_bf16 v231, v124, s38, 0
    v_dot2_f32_bf16 v247, v124, v124, 0
    v_lshlrev_b32 v120, 16, v124
    v_and_b32 v121, 0xffff0000, v124
    v_lshlrev_b32 v122, 16, v125
    v_and_b32 v123, 0xffff0000, v125
    v_dot2c_f32_bf16 v231, s38, v125
    v_dot2c_f32_bf16 v247, v125, v125
    v_dot2c_f32_bf16 v231, s38, v126
    v_dot2c_f32_bf16 v247, v126, v126
    v_dot2c_f32_bf16 v231, s38, v127
    v_dot2c_f32_bf16 v247, v127, v127
    v_lshlrev_b32 v124, 16, v126
    v_and_b32 v125, 0xffff0000, v126
    v_lshlrev_b32 v126, 16, v127
    v_and_b32 v127, 0xffff0000, v127
    s_mov_b32 s38, 0x3f803f80
    s_waitcnt vmcnt(15)
    v_dot2_f32_bf16 v232, v132, s38, 0
    v_dot2_f32_bf16 v248, v132, v132, 0
    v_lshlrev_b32 v128, 16, v132
    v_and_b32 v129, 0xffff0000, v132
    v_lshlrev_b32 v130, 16, v133
    v_and_b32 v131, 0xffff0000, v133
    v_dot2c_f32_bf16 v232, s38, v133
    v_dot2c_f32_bf16 v248, v133, v133
    v_dot2c_f32_bf16 v232, s38, v134
    v_dot2c_f32_bf16 v248, v134, v134
    v_dot2c_f32_bf16 v232, s38, v135
    s_add_u32 m0, s30, 12288
    s_xor_b32 s36, s21, 128
    buffer_load_dwordx4 v6, s[16:19], s36 offen offset:0  lds
    v_dot2c_f32_bf16 v248, v135, v135
    v_lshlrev_b32 v132, 16, v134
    v_and_b32 v133, 0xffff0000, v134
    v_lshlrev_b32 v134, 16, v135
    v_and_b32 v135, 0xffff0000, v135
    s_waitcnt vmcnt(15)
    v_dot2_f32_bf16 v233, v140, s38, 0
    v_dot2_f32_bf16 v249, v140, v140, 0
    v_lshlrev_b32 v136, 16, v140
    v_and_b32 v137, 0xffff0000, v140
    v_lshlrev_b32 v138, 16, v141
    v_and_b32 v139, 0xffff0000, v141
    v_dot2c_f32_bf16 v233, s38, v141
    s_add_u32 m0, s30, 12288
    s_xor_b32 s36, s21, 128
    buffer_load_dwordx4 v7, s[16:19], s36 offen offset:1024  lds
    v_dot2c_f32_bf16 v249, v141, v141
    v_dot2c_f32_bf16 v233, s38, v142
    v_dot2c_f32_bf16 v249, v142, v142
    v_dot2c_f32_bf16 v233, s38, v143
    v_dot2c_f32_bf16 v249, v143, v143
    v_lshlrev_b32 v140, 16, v142
    v_and_b32 v141, 0xffff0000, v142
    v_lshlrev_b32 v142, 16, v143
    v_and_b32 v143, 0xffff0000, v143
    s_waitcnt vmcnt(15)
    v_dot2_f32_bf16 v234, v148, s38, 0
    v_dot2_f32_bf16 v250, v148, v148, 0
    v_lshlrev_b32 v144, 16, v148
    s_add_u32 m0, s30, 12288
    s_xor_b32 s36, s21, 128
    buffer_load_dwordx4 v8, s[16:19], s36 offen offset:2048  lds
    v_and_b32 v145, 0xffff0000, v148
    v_lshlrev_b32 v146, 16, v149
    v_and_b32 v147, 0xffff0000, v149
    v_dot2c_f32_bf16 v234, s38, v149
    v_dot2c_f32_bf16 v250, v149, v149
    v_dot2c_f32_bf16 v234, s38, v150
    v_dot2c_f32_bf16 v250, v150, v150
    v_dot2c_f32_bf16 v234, s38, v151
    v_dot2c_f32_bf16 v250, v151, v151
    v_lshlrev_b32 v148, 16, v150
    v_and_b32 v149, 0xffff0000, v150
    v_lshlrev_b32 v150, 16, v151
    v_and_b32 v151, 0xffff0000, v151
    s_add_u32 m0, s30, 12288
    s_xor_b32 s36, s21, 128
    buffer_load_dwordx4 v9, s[16:19], s36 offen offset:3072  lds
    s_waitcnt vmcnt(16)
    v_dot2_f32_bf16 v235, v156, s38, 0
    v_dot2_f32_bf16 v251, v156, v156, 0
    v_lshlrev_b32 v152, 16, v156
    v_and_b32 v153, 0xffff0000, v156
    v_lshlrev_b32 v154, 16, v157
    v_and_b32 v155, 0xffff0000, v157
    v_dot2c_f32_bf16 v235, s38, v157
    v_dot2c_f32_bf16 v251, v157, v157
    v_dot2c_f32_bf16 v235, s38, v158
    v_dot2c_f32_bf16 v251, v158, v158
    v_dot2c_f32_bf16 v235, s38, v159
    v_dot2c_f32_bf16 v251, v159, v159
    v_lshlrev_b32 v156, 16, v158
    v_and_b32 v157, 0xffff0000, v158
    v_lshlrev_b32 v158, 16, v159
    v_and_b32 v159, 0xffff0000, v159
    s_mov_b32 s38, 0x3f803f80
    s_waitcnt vmcnt(15)
    v_dot2_f32_bf16 v236, v164, s38, 0
    v_dot2_f32_bf16 v252, v164, v164, 0
    v_lshlrev_b32 v160, 16, v164
    v_and_b32 v161, 0xffff0000, v164
    v_lshlrev_b32 v162, 16, v165
    v_and_b32 v163, 0xffff0000, v165
    s_add_u32 m0, s30, 16384
    s_xor_b32 s36, s21, 256
    buffer_load_dwordx4 v6, s[16:19], s36 offen offset:0  lds
    v_dot2c_f32_bf16 v236, s38, v165
    v_dot2c_f32_bf16 v252, v165, v165
    v_dot2c_f32_bf16 v236, s38, v166
    v_dot2c_f32_bf16 v252, v166, v166
    v_dot2c_f32_bf16 v236, s38, v167
    v_dot2c_f32_bf16 v252, v167, v167
    v_lshlrev_b32 v164, 16, v166
    s_add_u32 m0, s30, 16384
    s_xor_b32 s36, s21, 256
    buffer_load_dwordx4 v7, s[16:19], s36 offen offset:1024  lds
    v_and_b32 v165, 0xffff0000, v166
    v_lshlrev_b32 v166, 16, v167
    v_and_b32 v167, 0xffff0000, v167
    s_waitcnt vmcnt(16)
    v_dot2_f32_bf16 v237, v172, s38, 0
    v_dot2_f32_bf16 v253, v172, v172, 0
    v_lshlrev_b32 v168, 16, v172
    s_add_u32 m0, s30, 16384
    s_xor_b32 s36, s21, 256
    buffer_load_dwordx4 v8, s[16:19], s36 offen offset:2048  lds
    v_and_b32 v169, 0xffff0000, v172
    v_lshlrev_b32 v170, 16, v173
    v_and_b32 v171, 0xffff0000, v173
    v_dot2c_f32_bf16 v237, s38, v173
    v_dot2c_f32_bf16 v253, v173, v173
    v_dot2c_f32_bf16 v237, s38, v174
    v_dot2c_f32_bf16 v253, v174, v174
    s_add_u32 m0, s30, 16384
    s_xor_b32 s36, s21, 256
    buffer_load_dwordx4 v9, s[16:19], s36 offen offset:3072  lds
    v_dot2c_f32_bf16 v237, s38, v175
    v_dot2c_f32_bf16 v253, v175, v175
    v_lshlrev_b32 v172, 16, v174
    v_and_b32 v173, 0xffff0000, v174
    v_lshlrev_b32 v174, 16, v175
    v_and_b32 v175, 0xffff0000, v175
    s_waitcnt vmcnt(17)
    s_waitcnt lgkmcnt(0)
    s_add_u32 m0, s30, 0
    s_xor_b32 s36, s21, 384
    buffer_load_dwordx4 v6, s[16:19], s36 offen offset:0  lds
    v_dot2_f32_bf16 v238, v180, s38, 0
    v_dot2_f32_bf16 v254, v180, v180, 0
    v_lshlrev_b32 v176, 16, v180
    v_and_b32 v177, 0xffff0000, v180
    v_lshlrev_b32 v178, 16, v181
    v_and_b32 v179, 0xffff0000, v181
    v_dot2c_f32_bf16 v238, s38, v181
    s_add_u32 m0, s30, 0
    s_xor_b32 s36, s21, 384
    buffer_load_dwordx4 v7, s[16:19], s36 offen offset:1024  lds
    v_dot2c_f32_bf16 v254, v181, v181
    v_dot2c_f32_bf16 v238, s38, v182
    v_dot2c_f32_bf16 v254, v182, v182
    v_dot2c_f32_bf16 v238, s38, v183
    v_dot2c_f32_bf16 v254, v183, v183
    v_lshlrev_b32 v180, 16, v182
    v_and_b32 v181, 0xffff0000, v182
    s_add_u32 m0, s30, 0
    s_xor_b32 s36, s21, 384
    buffer_load_dwordx4 v8, s[16:19], s36 offen offset:2048  lds
    v_lshlrev_b32 v182, 16, v183
    v_and_b32 v183, 0xffff0000, v183
    s_waitcnt vmcnt(19)
    v_dot2_f32_bf16 v239, v188, s38, 0
    v_dot2_f32_bf16 v255, v188, v188, 0
    v_lshlrev_b32 v184, 16, v188
    v_and_b32 v185, 0xffff0000, v188
    s_add_u32 m0, s30, 0
    s_xor_b32 s36, s21, 384
    buffer_load_dwordx4 v9, s[16:19], s36 offen offset:3072  lds
    v_lshlrev_b32 v186, 16, v189
    v_and_b32 v187, 0xffff0000, v189
    v_dot2c_f32_bf16 v239, s38, v189
    v_dot2c_f32_bf16 v255, v189, v189
    v_dot2c_f32_bf16 v239, s38, v190
    v_dot2c_f32_bf16 v255, v190, v190
    v_dot2c_f32_bf16 v239, s38, v191
    v_dot2c_f32_bf16 v255, v191, v191
    v_lshlrev_b32 v188, 16, v190
    v_and_b32 v189, 0xffff0000, v190
    v_lshlrev_b32 v190, 16, v191
    v_and_b32 v191, 0xffff0000, v191
    v_permlane32_swap_b32 v224, v232
    v_permlane32_swap_b32 v225, v233
    v_permlane32_swap_b32 v226, v234
    v_permlane32_swap_b32 v227, v235
    v_permlane32_swap_b32 v228, v236
    v_permlane32_swap_b32 v229, v237
    v_permlane32_swap_b32 v230, v238
    v_permlane32_swap_b32 v231, v239
    v_add_f32 v224, v224, v232
    v_add_f32 v225, v225, v233
    v_add_f32 v226, v226, v234
    v_add_f32 v227, v227, v235
    s_waitcnt vmcnt(16)
    ds_read_b128 a[0:3], v10 offset:4096
    ds_read_b128 a[4:7], v11 offset:4096
    ds_read_b128 a[8:11], v12 offset:4096
    ds_read_b128 a[12:15], v13 offset:4096
    s_waitcnt vmcnt(12)
    ds_read_b128 a[16:19], v10 offset:8192
    ds_read_b128 a[20:23], v11 offset:8192
    ds_read_b128 a[24:27], v12 offset:8192
    ds_read_b128 a[28:31], v13 offset:8192
    s_waitcnt lgkmcnt(4)
    s_add_u32 m0, s30, 4096
    s_xor_b32 s36, s21, 512
    buffer_load_dwordx4 v6, s[16:19], s36 offen offset:0  lds
    v_add_f32 v228, v228, v236
    v_add_f32 v229, v229, v237
    v_add_f32 v230, v230, v238
    v_add_f32 v231, v231, v239
    v_permlane32_swap_b32 v240, v248
    v_permlane32_swap_b32 v241, v249
    v_permlane32_swap_b32 v242, v250
    v_permlane32_swap_b32 v243, v251
    v_permlane32_swap_b32 v244, v252
    v_permlane32_swap_b32 v245, v253
    v_permlane32_swap_b32 v246, v254
    v_permlane32_swap_b32 v247, v255
    s_add_u32 m0, s30, 4096
    s_xor_b32 s36, s21, 512
    buffer_load_dwordx4 v7, s[16:19], s36 offen offset:1024  lds
    v_add_f32 v240, v240, v248
    v_add_f32 v241, v241, v249
    v_add_f32 v242, v242, v250
    v_add_f32 v243, v243, v251
    v_add_f32 v244, v244, v252
    v_add_f32 v245, v245, v253
    v_add_f32 v246, v246, v254
    v_add_f32 v247, v247, v255
    v_permlane16_swap_b32 v224, v228
    v_permlane16_swap_b32 v225, v229
    v_permlane16_swap_b32 v226, v230
    v_permlane16_swap_b32 v227, v231
    s_add_u32 m0, s30, 4096
    s_xor_b32 s36, s21, 512
    buffer_load_dwordx4 v8, s[16:19], s36 offen offset:2048  lds
    v_permlane16_swap_b32 v240, v244
    v_permlane16_swap_b32 v241, v245
    v_permlane16_swap_b32 v242, v246
    v_permlane16_swap_b32 v243, v247
    v_add_f32 v224, v224, v228
    v_add_f32 v225, v225, v229
    v_add_f32 v226, v226, v230
    v_add_f32 v227, v227, v231
    v_add_f32 v240, v240, v244
    v_add_f32 v241, v241, v245
    v_add_f32 v242, v242, v246
    v_add_f32 v243, v243, v247
    s_add_u32 m0, s30, 4096
    s_xor_b32 s36, s21, 512
    buffer_load_dwordx4 v9, s[16:19], s36 offen offset:3072  lds
    v_add_f32_dpp v224, v224, v224 row_ror:8 row_mask:0xf bank_mask:0xf
    v_add_f32_dpp v225, v225, v225 row_ror:8 row_mask:0xf bank_mask:0xf
    v_add_f32_dpp v226, v226, v226 row_ror:8 row_mask:0xf bank_mask:0xf
    v_add_f32_dpp v227, v227, v227 row_ror:8 row_mask:0xf bank_mask:0xf
    v_add_f32_dpp v240, v240, v240 row_ror:8 row_mask:0xf bank_mask:0xf
    v_add_f32_dpp v241, v241, v241 row_ror:8 row_mask:0xf bank_mask:0xf
    v_add_f32_dpp v242, v242, v242 row_ror:8 row_mask:0xf bank_mask:0xf
    v_add_f32_dpp v243, v243, v243 row_ror:8 row_mask:0xf bank_mask:0xf
    v_add_f32_dpp v224, v224, v224 row_ror:4 row_mask:0xf bank_mask:0xf
    v_add_f32_dpp v225, v225, v225 row_ror:4 row_mask:0xf bank_mask:0xf
    v_add_f32_dpp v226, v226, v226 row_ror:4 row_mask:0xf bank_mask:0xf
    v_add_f32_dpp v227, v227, v227 row_ror:4 row_mask:0xf bank_mask:0xf
    s_waitcnt lgkmcnt(0)
    s_add_u32 m0, s30, 8192
    s_xor_b32 s36, s21, 640
    buffer_load_dwordx4 v6, s[16:19], s36 offen offset:0  lds
    v_add_f32_dpp v240, v240, v240 row_ror:4 row_mask:0xf bank_mask:0xf
    v_add_f32_dpp v241, v241, v241 row_ror:4 row_mask:0xf bank_mask:0xf
    v_add_f32_dpp v242, v242, v242 row_ror:4 row_mask:0xf bank_mask:0xf
    v_add_f32_dpp v243, v243, v243 row_ror:4 row_mask:0xf bank_mask:0xf
    v_add_f32_dpp v224, v224, v224 row_ror:2 row_mask:0xf bank_mask:0xf
    v_add_f32_dpp v225, v225, v225 row_ror:2 row_mask:0xf bank_mask:0xf
    v_add_f32_dpp v226, v226, v226 row_ror:2 row_mask:0xf bank_mask:0xf
    v_add_f32_dpp v227, v227, v227 row_ror:2 row_mask:0xf bank_mask:0xf
    v_add_f32_dpp v240, v240, v240 row_ror:2 row_mask:0xf bank_mask:0xf
    v_add_f32_dpp v241, v241, v241 row_ror:2 row_mask:0xf bank_mask:0xf
    v_add_f32_dpp v242, v242, v242 row_ror:2 row_mask:0xf bank_mask:0xf
    v_add_f32_dpp v243, v243, v243 row_ror:2 row_mask:0xf bank_mask:0xf
    s_add_u32 m0, s30, 8192
    s_xor_b32 s36, s21, 640
    buffer_load_dwordx4 v7, s[16:19], s36 offen offset:1024  lds
    v_add_f32_dpp v224, v224, v224 row_ror:1 row_mask:0xf bank_mask:0xf
    v_add_f32_dpp v225, v225, v225 row_ror:1 row_mask:0xf bank_mask:0xf
    v_add_f32_dpp v226, v226, v226 row_ror:1 row_mask:0xf bank_mask:0xf
    v_add_f32_dpp v227, v227, v227 row_ror:1 row_mask:0xf bank_mask:0xf
    v_add_f32_dpp v240, v240, v240 row_ror:1 row_mask:0xf bank_mask:0xf
    v_add_f32_dpp v241, v241, v241 row_ror:1 row_mask:0xf bank_mask:0xf
    v_add_f32_dpp v242, v242, v242 row_ror:1 row_mask:0xf bank_mask:0xf
    v_add_f32_dpp v243, v243, v243 row_ror:1 row_mask:0xf bank_mask:0xf
    v_mul_f32 v224, 0x3b000000, v224
    v_mul_f32 v225, 0x3b000000, v225
    v_mul_f32 v226, 0x3b000000, v226
    v_mul_f32 v227, 0x3b000000, v227
    s_add_u32 m0, s30, 8192
    s_xor_b32 s36, s21, 640
    buffer_load_dwordx4 v8, s[16:19], s36 offen offset:2048  lds
    v_mul_f32 v240, 0x3b000000, v240
    v_mul_f32 v241, 0x3b000000, v241
    v_mul_f32 v242, 0x3b000000, v242
    v_mul_f32 v243, 0x3b000000, v243
    v_fma_f32 v240, -v224, v224, v240
    v_fma_f32 v241, -v225, v225, v241
    v_fma_f32 v242, -v226, v226, v242
    v_fma_f32 v243, -v227, v227, v243
    v_max_f32 v240, 0, v240
    v_max_f32 v241, 0, v241
    v_max_f32 v242, 0, v242
    v_max_f32 v243, 0, v243
    s_add_u32 m0, s30, 8192
    s_xor_b32 s36, s21, 640
    buffer_load_dwordx4 v9, s[16:19], s36 offen offset:3072  lds
    v_add_f32 v240, 0x3727c5ac, v240
    v_add_f32 v241, 0x3727c5ac, v241
    v_add_f32 v242, 0x3727c5ac, v242
    v_add_f32 v243, 0x3727c5ac, v243
    v_rsq_f32 v240, v240
    v_rsq_f32 v241, v241
    v_rsq_f32 v242, v242
    v_rsq_f32 v243, v243
    v_mul_f32 v224, v224, -v240
    v_mul_f32 v225, v225, -v241
    v_mul_f32 v226, v226, -v242
    v_mul_f32 v227, v227, -v243
    s_waitcnt lgkmcnt(0)
    v_readlane_b32 s40, v240, 0
    v_readlane_b32 s41, v224, 0
    v_readlane_b32 s42, v241, 0
    v_readlane_b32 s43, v225, 0
    v_readlane_b32 s44, v242, 0
    v_readlane_b32 s45, v226, 0
    v_readlane_b32 s46, v243, 0
    v_readlane_b32 s47, v227, 0
    v_readlane_b32 s48, v240, 16
    v_readlane_b32 s49, v224, 16
    v_readlane_b32 s50, v241, 16
    v_readlane_b32 s51, v225, 16
    v_readlane_b32 s52, v242, 16
    v_readlane_b32 s53, v226, 16
    v_readlane_b32 s54, v243, 16
    v_readlane_b32 s55, v227, 16
    v_readlane_b32 s56, v240, 32
    v_readlane_b32 s57, v224, 32
    v_readlane_b32 s58, v241, 32
    v_readlane_b32 s59, v225, 32
    v_readlane_b32 s60, v242, 32
    v_readlane_b32 s61, v226, 32
    v_readlane_b32 s62, v243, 32
    v_readlane_b32 s63, v227, 32
    v_readlane_b32 s64, v240, 48
    v_readlane_b32 s65, v224, 48
    v_readlane_b32 s66, v241, 48
    v_readlane_b32 s67, v225, 48
    v_readlane_b32 s68, v242, 48
    v_readlane_b32 s69, v226, 48
    v_readlane_b32 s70, v243, 48
    v_readlane_b32 s71, v227, 48
    s_lshl_b32 s25, s3, 10
    s_add_u32 s25, s25, 25690112
    buffer_load_dword v30, v29, s[32:35], 0 offen sc1
    buffer_load_dwordx4 v[32:35], v28, s[32:35], 0 offen sc1
    buffer_load_dwordx4 v[36:39], v1, s[4:7], s25 offen sc1
    s_add_u32 s36, s25, 12288
    buffer_load_dwordx4 v[40:43], v1, s[4:7], s36 offen sc1
    s_add_u32 s36, s36, 12288
    buffer_load_dwordx4 v[44:47], v1, s[4:7], s36 offen sc1
    s_add_u32 s36, s36, 12288
    buffer_load_dwordx4 v[48:51], v1, s[4:7], s36 offen sc1
    v_pk_fma_f32 v[64:65], v[64:65], s[40:41], s[40:41] op_sel:[0,0,1] op_sel_hi:[1,0,1]
    v_pk_fma_f32 v[66:67], v[66:67], s[40:41], s[40:41] op_sel:[0,0,1] op_sel_hi:[1,0,1]
    v_pk_fma_f32 v[68:69], v[68:69], s[40:41], s[40:41] op_sel:[0,0,1] op_sel_hi:[1,0,1]
    v_pk_fma_f32 v[70:71], v[70:71], s[40:41], s[40:41] op_sel:[0,0,1] op_sel_hi:[1,0,1]
    v_pk_fma_f32 v[72:73], v[72:73], s[42:43], s[42:43] op_sel:[0,0,1] op_sel_hi:[1,0,1]
    v_pk_fma_f32 v[74:75], v[74:75], s[42:43], s[42:43] op_sel:[0,0,1] op_sel_hi:[1,0,1]
    v_pk_fma_f32 v[76:77], v[76:77], s[42:43], s[42:43] op_sel:[0,0,1] op_sel_hi:[1,0,1]
    v_pk_fma_f32 v[78:79], v[78:79], s[42:43], s[42:43] op_sel:[0,0,1] op_sel_hi:[1,0,1]
    s_waitcnt vmcnt(22)
    ds_read_b128 a[208:211], v10 offset:12288
    ds_read_b128 a[212:215], v11 offset:12288
    ds_read_b128 a[216:219], v12 offset:12288
    ds_read_b128 a[220:223], v13 offset:12288
    s_waitcnt lgkmcnt(0)
    s_add_u32 m0, s30, 12288
    s_xor_b32 s36, s21, 768
    buffer_load_dwordx4 v6, s[16:19], s36 offen offset:0  lds
    v_pk_fma_f32 v[80:81], v[80:81], s[44:45], s[44:45] op_sel:[0,0,1] op_sel_hi:[1,0,1]
    v_pk_fma_f32 v[82:83], v[82:83], s[44:45], s[44:45] op_sel:[0,0,1] op_sel_hi:[1,0,1]
    v_pk_fma_f32 v[84:85], v[84:85], s[44:45], s[44:45] op_sel:[0,0,1] op_sel_hi:[1,0,1]
    v_pk_fma_f32 v[86:87], v[86:87], s[44:45], s[44:45] op_sel:[0,0,1] op_sel_hi:[1,0,1]
    v_pk_fma_f32 v[88:89], v[88:89], s[46:47], s[46:47] op_sel:[0,0,1] op_sel_hi:[1,0,1]
    v_pk_fma_f32 v[90:91], v[90:91], s[46:47], s[46:47] op_sel:[0,0,1] op_sel_hi:[1,0,1]
    v_pk_fma_f32 v[92:93], v[92:93], s[46:47], s[46:47] op_sel:[0,0,1] op_sel_hi:[1,0,1]
    s_add_u32 m0, s30, 12288
    s_xor_b32 s36, s21, 768
    buffer_load_dwordx4 v7, s[16:19], s36 offen offset:1024  lds
    v_pk_fma_f32 v[94:95], v[94:95], s[46:47], s[46:47] op_sel:[0,0,1] op_sel_hi:[1,0,1]
    v_pk_fma_f32 v[96:97], v[96:97], s[48:49], s[48:49] op_sel:[0,0,1] op_sel_hi:[1,0,1]
    v_pk_fma_f32 v[98:99], v[98:99], s[48:49], s[48:49] op_sel:[0,0,1] op_sel_hi:[1,0,1]
    v_pk_fma_f32 v[100:101], v[100:101], s[48:49], s[48:49] op_sel:[0,0,1] op_sel_hi:[1,0,1]
    v_pk_fma_f32 v[102:103], v[102:103], s[48:49], s[48:49] op_sel:[0,0,1] op_sel_hi:[1,0,1]
    v_pk_fma_f32 v[104:105], v[104:105], s[50:51], s[50:51] op_sel:[0,0,1] op_sel_hi:[1,0,1]
    v_pk_fma_f32 v[106:107], v[106:107], s[50:51], s[50:51] op_sel:[0,0,1] op_sel_hi:[1,0,1]
    s_add_u32 m0, s30, 12288
    s_xor_b32 s36, s21, 768
    buffer_load_dwordx4 v8, s[16:19], s36 offen offset:2048  lds
    v_pk_fma_f32 v[108:109], v[108:109], s[50:51], s[50:51] op_sel:[0,0,1] op_sel_hi:[1,0,1]
    v_pk_fma_f32 v[110:111], v[110:111], s[50:51], s[50:51] op_sel:[0,0,1] op_sel_hi:[1,0,1]
    v_pk_fma_f32 v[112:113], v[112:113], s[52:53], s[52:53] op_sel:[0,0,1] op_sel_hi:[1,0,1]
    v_pk_fma_f32 v[114:115], v[114:115], s[52:53], s[52:53] op_sel:[0,0,1] op_sel_hi:[1,0,1]
    v_pk_fma_f32 v[116:117], v[116:117], s[52:53], s[52:53] op_sel:[0,0,1] op_sel_hi:[1,0,1]
    v_pk_fma_f32 v[118:119], v[118:119], s[52:53], s[52:53] op_sel:[0,0,1] op_sel_hi:[1,0,1]
    v_pk_fma_f32 v[120:121], v[120:121], s[54:55], s[54:55] op_sel:[0,0,1] op_sel_hi:[1,0,1]
    s_add_u32 m0, s30, 12288
    s_xor_b32 s36, s21, 768
    buffer_load_dwordx4 v9, s[16:19], s36 offen offset:3072  lds
    v_pk_fma_f32 v[122:123], v[122:123], s[54:55], s[54:55] op_sel:[0,0,1] op_sel_hi:[1,0,1]
    v_pk_fma_f32 v[124:125], v[124:125], s[54:55], s[54:55] op_sel:[0,0,1] op_sel_hi:[1,0,1]
    v_pk_fma_f32 v[126:127], v[126:127], s[54:55], s[54:55] op_sel:[0,0,1] op_sel_hi:[1,0,1]
    v_pk_fma_f32 v[128:129], v[128:129], s[56:57], s[56:57] op_sel:[0,0,1] op_sel_hi:[1,0,1]
    v_pk_fma_f32 v[130:131], v[130:131], s[56:57], s[56:57] op_sel:[0,0,1] op_sel_hi:[1,0,1]
    v_pk_fma_f32 v[132:133], v[132:133], s[56:57], s[56:57] op_sel:[0,0,1] op_sel_hi:[1,0,1]
    v_pk_fma_f32 v[134:135], v[134:135], s[56:57], s[56:57] op_sel:[0,0,1] op_sel_hi:[1,0,1]
    s_waitcnt vmcnt(22)
    ds_read_b128 a[224:227], v10 offset:16384
    ds_read_b128 a[228:231], v11 offset:16384
    ds_read_b128 a[232:235], v12 offset:16384
    ds_read_b128 a[236:239], v13 offset:16384
    s_waitcnt lgkmcnt(0)
    s_add_u32 m0, s30, 16384
    s_xor_b32 s36, s21, 896
    buffer_load_dwordx4 v6, s[16:19], s36 offen offset:0  lds
    v_pk_fma_f32 v[136:137], v[136:137], s[58:59], s[58:59] op_sel:[0,0,1] op_sel_hi:[1,0,1]
    v_pk_fma_f32 v[138:139], v[138:139], s[58:59], s[58:59] op_sel:[0,0,1] op_sel_hi:[1,0,1]
    v_pk_fma_f32 v[140:141], v[140:141], s[58:59], s[58:59] op_sel:[0,0,1] op_sel_hi:[1,0,1]
    v_pk_fma_f32 v[142:143], v[142:143], s[58:59], s[58:59] op_sel:[0,0,1] op_sel_hi:[1,0,1]
    v_pk_fma_f32 v[144:145], v[144:145], s[60:61], s[60:61] op_sel:[0,0,1] op_sel_hi:[1,0,1]
    v_pk_fma_f32 v[146:147], v[146:147], s[60:61], s[60:61] op_sel:[0,0,1] op_sel_hi:[1,0,1]
    v_pk_fma_f32 v[148:149], v[148:149], s[60:61], s[60:61] op_sel:[0,0,1] op_sel_hi:[1,0,1]
    s_add_u32 m0, s30, 16384
    s_xor_b32 s36, s21, 896
    buffer_load_dwordx4 v7, s[16:19], s36 offen offset:1024  lds
    v_pk_fma_f32 v[150:151], v[150:151], s[60:61], s[60:61] op_sel:[0,0,1] op_sel_hi:[1,0,1]
    v_pk_fma_f32 v[152:153], v[152:153], s[62:63], s[62:63] op_sel:[0,0,1] op_sel_hi:[1,0,1]
    v_pk_fma_f32 v[154:155], v[154:155], s[62:63], s[62:63] op_sel:[0,0,1] op_sel_hi:[1,0,1]
    v_pk_fma_f32 v[156:157], v[156:157], s[62:63], s[62:63] op_sel:[0,0,1] op_sel_hi:[1,0,1]
    v_pk_fma_f32 v[158:159], v[158:159], s[62:63], s[62:63] op_sel:[0,0,1] op_sel_hi:[1,0,1]
    v_pk_fma_f32 v[160:161], v[160:161], s[64:65], s[64:65] op_sel:[0,0,1] op_sel_hi:[1,0,1]
    v_pk_fma_f32 v[162:163], v[162:163], s[64:65], s[64:65] op_sel:[0,0,1] op_sel_hi:[1,0,1]
    s_add_u32 m0, s30, 16384
    s_xor_b32 s36, s21, 896
    buffer_load_dwordx4 v8, s[16:19], s36 offen offset:2048  lds
    v_pk_fma_f32 v[164:165], v[164:165], s[64:65], s[64:65] op_sel:[0,0,1] op_sel_hi:[1,0,1]
    v_pk_fma_f32 v[166:167], v[166:167], s[64:65], s[64:65] op_sel:[0,0,1] op_sel_hi:[1,0,1]
    v_pk_fma_f32 v[168:169], v[168:169], s[66:67], s[66:67] op_sel:[0,0,1] op_sel_hi:[1,0,1]
    v_pk_fma_f32 v[170:171], v[170:171], s[66:67], s[66:67] op_sel:[0,0,1] op_sel_hi:[1,0,1]
    v_pk_fma_f32 v[172:173], v[172:173], s[66:67], s[66:67] op_sel:[0,0,1] op_sel_hi:[1,0,1]
    v_pk_fma_f32 v[174:175], v[174:175], s[66:67], s[66:67] op_sel:[0,0,1] op_sel_hi:[1,0,1]
    v_pk_fma_f32 v[176:177], v[176:177], s[68:69], s[68:69] op_sel:[0,0,1] op_sel_hi:[1,0,1]
    s_add_u32 m0, s30, 16384
    s_xor_b32 s36, s21, 896
    buffer_load_dwordx4 v9, s[16:19], s36 offen offset:3072  lds
    v_pk_fma_f32 v[178:179], v[178:179], s[68:69], s[68:69] op_sel:[0,0,1] op_sel_hi:[1,0,1]
    v_pk_fma_f32 v[180:181], v[180:181], s[68:69], s[68:69] op_sel:[0,0,1] op_sel_hi:[1,0,1]
    v_pk_fma_f32 v[182:183], v[182:183], s[68:69], s[68:69] op_sel:[0,0,1] op_sel_hi:[1,0,1]
    v_pk_fma_f32 v[184:185], v[184:185], s[70:71], s[70:71] op_sel:[0,0,1] op_sel_hi:[1,0,1]
    v_pk_fma_f32 v[186:187], v[186:187], s[70:71], s[70:71] op_sel:[0,0,1] op_sel_hi:[1,0,1]
    v_pk_fma_f32 v[188:189], v[188:189], s[70:71], s[70:71] op_sel:[0,0,1] op_sel_hi:[1,0,1]
    v_pk_fma_f32 v[190:191], v[190:191], s[70:71], s[70:71] op_sel:[0,0,1] op_sel_hi:[1,0,1]
    s_mov_b32 s37, 0x04000c0c
    s_mov_b32 s38, 0x0706000c
    s_cmp_ge_u32 s3, 2
    s_cselect_b32 s40, 1.0, 0
    s_lshl_b32 s41, s3, 10
    s_add_u32 s41, s41, 149504
    v_add_u32 v22, s41, v1
    v_lshlrev_b32 v23, 5, v0
    v_add_u32 v23, 149504, v23
    s_waitcnt vmcnt(8)
    v_xor_b32 v52, v32, v39
    v_xor_b32 v53, v33, v43
    v_xor_b32 v54, v34, v47
    v_xor_b32 v55, v35, v51
    v_and_b32 v56, v32, v33
    v_and_b32 v57, v34, v35
    v_or3_b32 v52, v52, v53, v54
    v_and_b32 v56, v56, v57
    v_and_b32 v56, v56, v30
    v_not_b32 v56, v56
    v_and_b32 v56, 1, v56
    v_or3_b32 v52, v52, v55, v56
    v_cmp_ne_u32 vcc, 0, v52
    s_nop 3
    s_cbranch_vccnz MG_3
MGD_4:
    s_load_dwordx4 s[48:51], s[0:1], 64
    v_lshrrev_b32 v28, 1, v0
    v_and_b32 v27, 1, v0
    v_lshlrev_b32 v27, 7, v27
    v_lshl_add_u32 v28, v28, 12, v27
    v_readfirstlane_b32 s24, v30
    v_perm_b32 v32, v38, v37, s37
    v_perm_b32 v33, v42, v41, s37
    v_perm_b32 v34, v46, v45, s37
    v_perm_b32 v35, v50, v49, s37
    v_perm_b32 v39, v32, v36, s38
    v_perm_b32 v43, v33, v40, s38
    v_perm_b32 v47, v34, v44, s38
    v_perm_b32 v51, v35, v48, s38
    v_add_f32 v36, v36, v40
    v_add_f32 v37, v37, v41
    v_add_f32 v38, v38, v42
    v_add_f32 v39, v39, v43
    v_add_f32 v44, v44, v48
    v_add_f32 v45, v45, v49
    v_add_f32 v46, v46, v50
    v_add_f32 v47, v47, v51
    v_add_f32 v36, v36, v44
    v_add_f32 v37, v37, v45
    v_add_f32 v38, v38, v46
    v_add_f32 v39, v39, v47
    v_cvt_pk_bf16_f32 v40, v36, v37
    v_cvt_pk_bf16_f32 v41, v38, v39
    v_lshlrev_b32 v36, 16, v40
    v_and_b32 v37, 0xffff0000, v40
    v_lshlrev_b32 v38, 16, v41
    v_and_b32 v39, 0xffff0000, v41
    v_add_f32 v36, s40, v36
    v_add_f32 v37, s40, v37
    v_add_f32 v38, s40, v38
    v_add_f32 v39, s40, v39
    v_cvt_pk_bf16_f32 v40, v36, v37
    v_cvt_pk_bf16_f32 v41, v38, v39
    v_lshlrev_b32 v36, 16, v40
    v_and_b32 v37, 0xffff0000, v40
    v_lshlrev_b32 v38, 16, v41
    v_and_b32 v39, 0xffff0000, v41
    ds_write_b128 v22, v[36:39]
NOLATE_5:
    ds_read_b128 a[240:243], v10 offset:0
    ds_read_b128 a[244:247], v11 offset:0
    ds_read_b128 a[248:251], v12 offset:0
    ds_read_b128 a[252:255], v13 offset:0
    ds_read_b128 v[192:195], v10 offset:4096
    ds_read_b128 v[196:199], v11 offset:4096
    ds_read_b128 v[200:203], v12 offset:4096
    ds_read_b128 v[204:207], v13 offset:4096
    s_waitcnt lgkmcnt(4)
    s_add_u32 m0, s30, 0
    s_xor_b32 s36, s20, 1024
    buffer_load_dwordx4 v2, s[12:15], s36 offen offset:0  lds
    buffer_load_dwordx4 v3, s[12:15], s36 offen offset:1024  lds
    buffer_load_dwordx4 v4, s[12:15], s36 offen offset:2048  lds
    buffer_load_dwordx4 v5, s[12:15], s36 offen offset:3072  lds
    s_waitcnt lgkmcnt(0)
    s_add_u32 m0, s30, 4096
    s_xor_b32 s36, s20, 1152
    buffer_load_dwordx4 v2, s[12:15], s36 offen offset:0  lds
    buffer_load_dwordx4 v3, s[12:15], s36 offen offset:1024  lds
    buffer_load_dwordx4 v4, s[12:15], s36 offen offset:2048  lds
    buffer_load_dwordx4 v5, s[12:15], s36 offen offset:3072  lds
    s_waitcnt lgkmcnt(0)
    s_barrier
    ds_read_b128 v[56:59], v23 offset:0
    ds_read_b128 v[60:63], v23 offset:16
    ds_read_b128 v[48:51], v23 offset:2048
    ds_read_b128 v[52:55], v23 offset:2064
    s_lshl_b32 s36, s26, 2
    s_add_u32 s36, s36, s27
    s_lshl_b32 s44, s36, 2
    s_add_u32 s44, s44, s3
    s_lshl_b32 s44, s44, 4
    s_add_u32 s44, s44, s29
    s_lshl_b32 s44, s44, 1
    s_lshr_b32 s37, s27, 1
    s_mul_i32 s37, s37, 1
    s_add_u32 s44, s44, s37
    s_lshl_b32 s44, s44, 11
    s_xor_b32 s45, s44, 2048
    s_lshl_b32 s46, s36, 6
    s_add_u32 s46, s46, s29
    s_lshl_b32 s46, s46, 2
    s_add_u32 s46, s46, 25755648
    s_cmp_lt_u32 s26, 2
    s_cselect_b32 s47, 0, 0x80008000
    s_waitcnt lgkmcnt(0)
    v_pk_fma_f32 v[64:65], v[64:65], v[48:49], v[56:57]
    v_pk_fma_f32 v[66:67], v[66:67], v[50:51], v[58:59]
    v_pk_fma_f32 v[68:69], v[68:69], v[52:53], v[60:61]
    v_pk_fma_f32 v[70:71], v[70:71], v[54:55], v[62:63]
    v_cvt_pk_bf16_f32 v64, v64, v65
    v_cvt_pk_bf16_f32 v65, v66, v67
    v_cvt_pk_bf16_f32 v66, v68, v69
    v_cvt_pk_bf16_f32 v67, v70, v71
    v_xor_b32 v68, 0, v31
    ds_write_b128 v68, v[64:67] offset:0
    v_pk_fma_f32 v[72:73], v[72:73], v[48:49], v[56:57]
    v_pk_fma_f32 v[74:75], v[74:75], v[50:51], v[58:59]
    v_pk_fma_f32 v[76:77], v[76:77], v[52:53], v[60:61]
    v_pk_fma_f32 v[78:79], v[78:79], v[54:55], v[62:63]
    v_cvt_pk_bf16_f32 v72, v72, v73
    v_cvt_pk_bf16_f32 v73, v74, v75
    v_cvt_pk_bf16_f32 v74, v76, v77
    v_cvt_pk_bf16_f32 v75, v78, v79
    v_xor_b32 v76, 1040, v31
    ds_write_b128 v76, v[72:75] offset:0
    v_pk_fma_f32 v[80:81], v[80:81], v[48:49], v[56:57]
    v_pk_fma_f32 v[82:83], v[82:83], v[50:51], v[58:59]
    v_pk_fma_f32 v[84:85], v[84:85], v[52:53], v[60:61]
    v_pk_fma_f32 v[86:87], v[86:87], v[54:55], v[62:63]
    v_cvt_pk_bf16_f32 v80, v80, v81
    v_cvt_pk_bf16_f32 v81, v82, v83
    v_cvt_pk_bf16_f32 v82, v84, v85
    v_cvt_pk_bf16_f32 v83, v86, v87
    v_xor_b32 v84, 2080, v31
    ds_write_b128 v84, v[80:83] offset:0
    v_pk_fma_f32 v[88:89], v[88:89], v[48:49], v[56:57]
    v_pk_fma_f32 v[90:91], v[90:91], v[50:51], v[58:59]
    v_pk_fma_f32 v[92:93], v[92:93], v[52:53], v[60:61]
    v_pk_fma_f32 v[94:95], v[94:95], v[54:55], v[62:63]
    v_cvt_pk_bf16_f32 v88, v88, v89
    v_cvt_pk_bf16_f32 v89, v90, v91
    v_cvt_pk_bf16_f32 v90, v92, v93
    v_cvt_pk_bf16_f32 v91, v94, v95
    v_xor_b32 v92, 3120, v31
    ds_write_b128 v92, v[88:91] offset:0
    v_pk_fma_f32 v[96:97], v[96:97], v[48:49], v[56:57]
    v_pk_fma_f32 v[98:99], v[98:99], v[50:51], v[58:59]
    v_pk_fma_f32 v[100:101], v[100:101], v[52:53], v[60:61]
    v_pk_fma_f32 v[102:103], v[102:103], v[54:55], v[62:63]
    v_cvt_pk_bf16_f32 v96, v96, v97
    v_cvt_pk_bf16_f32 v97, v98, v99
    v_cvt_pk_bf16_f32 v98, v100, v101
    v_cvt_pk_bf16_f32 v99, v102, v103
    v_xor_b32 v100, 4160, v31
    ds_write_b128 v100, v[96:99] offset:0
    v_pk_fma_f32 v[104:105], v[104:105], v[48:49], v[56:57]
    v_pk_fma_f32 v[106:107], v[106:107], v[50:51], v[58:59]
    v_pk_fma_f32 v[108:109], v[108:109], v[52:53], v[60:61]
    v_pk_fma_f32 v[110:111], v[110:111], v[54:55], v[62:63]
    v_cvt_pk_bf16_f32 v104, v104, v105
    v_cvt_pk_bf16_f32 v105, v106, v107
    v_cvt_pk_bf16_f32 v106, v108, v109
    v_cvt_pk_bf16_f32 v107, v110, v111
    v_xor_b32 v108, 5200, v31
    ds_write_b128 v108, v[104:107] offset:0
    v_pk_fma_f32 v[112:113], v[112:113], v[48:49], v[56:57]
    v_pk_fma_f32 v[114:115], v[114:115], v[50:51], v[58:59]
    v_pk_fma_f32 v[116:117], v[116:117], v[52:53], v[60:61]
    v_pk_fma_f32 v[118:119], v[118:119], v[54:55], v[62:63]
    v_cvt_pk_bf16_f32 v112, v112, v113
    v_cvt_pk_bf16_f32 v113, v114, v115
    v_cvt_pk_bf16_f32 v114, v116, v117
    v_cvt_pk_bf16_f32 v115, v118, v119
    v_xor_b32 v116, 6240, v31
    ds_write_b128 v116, v[112:115] offset:0
    v_pk_fma_f32 v[120:121], v[120:121], v[48:49], v[56:57]
    v_pk_fma_f32 v[122:123], v[122:123], v[50:51], v[58:59]
    v_pk_fma_f32 v[124:125], v[124:125], v[52:53], v[60:61]
    v_pk_fma_f32 v[126:127], v[126:127], v[54:55], v[62:63]
    v_cvt_pk_bf16_f32 v120, v120, v121
    v_cvt_pk_bf16_f32 v121, v122, v123
    v_cvt_pk_bf16_f32 v122, v124, v125
    v_cvt_pk_bf16_f32 v123, v126, v127
    v_xor_b32 v124, 7280, v31
    ds_write_b128 v124, v[120:123] offset:0
    ds_read_b128 v[208:211], v10 offset:8192
    ds_read_b128 v[212:215], v11 offset:8192
    ds_read_b128 v[216:219], v12 offset:8192
    ds_read_b128 v[220:223], v13 offset:8192
    s_waitcnt vmcnt(12)
    ds_read_b128 v[224:227], v10 offset:12288
    ds_read_b128 v[228:231], v11 offset:12288
    ds_read_b128 v[232:235], v12 offset:12288
    ds_read_b128 v[236:239], v13 offset:12288
    s_waitcnt vmcnt(8)
    ds_read_b128 v[240:243], v10 offset:16384
    ds_read_b128 v[244:247], v11 offset:16384
    ds_read_b128 v[248:251], v12 offset:16384
    ds_read_b128 v[252:255], v13 offset:16384
    s_waitcnt lgkmcnt(12)
    s_barrier
    ds_read_b128 v[80:83], v14 offset:0
    ds_read_b128 v[84:87], v15 offset:256
    ds_read_b128 v[88:91], v16 offset:512
    ds_read_b128 v[92:95], v17 offset:768
    ds_read_b128 v[96:99], v15 offset:0
    ds_read_b128 v[100:103], v14 offset:256
    s_waitcnt lgkmcnt(5)
    v_mfma_f32_32x32x16_bf16 v[32:47], v[80:83], a[192:195], 0
    ds_read_b128 v[104:107], v17 offset:512
    v_fma_f32 v128, v128, v48, v56
    v_fma_f32 v129, v129, v49, v57
    v_fma_f32 v130, v130, v50, v58
    v_fma_f32 v131, v131, v51, v59
    v_fma_f32 v132, v132, v52, v60
    s_waitcnt lgkmcnt(5)
    v_mfma_f32_32x32x16_bf16 v[32:47], v[84:87], a[196:199], v[32:47]
    ds_read_b128 v[108:111], v16 offset:768
    v_fma_f32 v133, v133, v53, v61
    v_fma_f32 v134, v134, v54, v62
    v_fma_f32 v135, v135, v55, v63
    v_cvt_pk_bf16_f32 v128, v128, v129
    v_cvt_pk_bf16_f32 v129, v130, v131
    s_waitcnt lgkmcnt(5)
    v_mfma_f32_32x32x16_bf16 v[32:47], v[88:91], a[200:203], v[32:47]
    ds_read_b128 v[80:83], v16 offset:0
    v_cvt_pk_bf16_f32 v130, v132, v133
    v_cvt_pk_bf16_f32 v131, v134, v135
    v_xor_b32 v132, 0, v31
    ds_write_b128 v132, v[128:131] offset:32768
    v_fma_f32 v136, v136, v48, v56
    s_waitcnt lgkmcnt(6)
    v_mfma_f32_32x32x16_bf16 v[32:47], v[92:95], a[204:207], v[32:47]
    ds_read_b128 v[84:87], v17 offset:256
    v_fma_f32 v137, v137, v49, v57
    v_fma_f32 v138, v138, v50, v58
    v_fma_f32 v139, v139, v51, v59
    v_fma_f32 v140, v140, v52, v60
    v_fma_f32 v141, v141, v53, v61
    s_waitcnt lgkmcnt(6)
    v_mfma_f32_32x32x16_bf16 v[32:47], v[96:99], a[208:211], v[32:47]
    ds_read_b128 v[88:91], v14 offset:512
    v_fma_f32 v142, v142, v54, v62
    v_fma_f32 v143, v143, v55, v63
    v_cvt_pk_bf16_f32 v136, v136, v137
    v_cvt_pk_bf16_f32 v137, v138, v139
    v_cvt_pk_bf16_f32 v138, v140, v141
    s_waitcnt lgkmcnt(6)
    v_mfma_f32_32x32x16_bf16 v[32:47], v[100:103], a[212:215], v[32:47]
    ds_read_b128 v[92:95], v15 offset:768
    v_cvt_pk_bf16_f32 v139, v142, v143
    v_xor_b32 v140, 1040, v31
    ds_write_b128 v140, v[136:139] offset:32768
    v_fma_f32 v144, v144, v48, v56
    v_fma_f32 v145, v145, v49, v57
    s_waitcnt lgkmcnt(7)
    v_mfma_f32_32x32x16_bf16 v[32:47], v[104:107], a[216:219], v[32:47]
    ds_read_b128 v[96:99], v17 offset:0
    v_fma_f32 v146, v146, v50, v58
    v_fma_f32 v147, v147, v51, v59
    v_fma_f32 v148, v148, v52, v60
    v_fma_f32 v149, v149, v53, v61
    v_fma_f32 v150, v150, v54, v62
    s_waitcnt lgkmcnt(7)
    v_mfma_f32_32x32x16_bf16 v[32:47], v[108:111], a[220:223], v[32:47]
    ds_read_b128 v[100:103], v16 offset:256
    v_fma_f32 v151, v151, v55, v63
    v_cvt_pk_bf16_f32 v144, v144, v145
    v_cvt_pk_bf16_f32 v145, v146, v147
    v_cvt_pk_bf16_f32 v146, v148, v149
    v_cvt_pk_bf16_f32 v147, v150, v151
    s_waitcnt lgkmcnt(7)
    v_mfma_f32_32x32x16_bf16 v[32:47], v[80:83], a[224:227], v[32:47]
    ds_read_b128 v[104:107], v15 offset:512
    v_xor_b32 v148, 2080, v31
    ds_write_b128 v148, v[144:147] offset:32768
    v_fma_f32 v152, v152, v48, v56
    v_fma_f32 v153, v153, v49, v57
    v_fma_f32 v154, v154, v50, v58
    s_waitcnt lgkmcnt(7)
    v_mfma_f32_32x32x16_bf16 v[32:47], v[84:87], a[228:231], v[32:47]
    ds_read_b128 v[108:111], v14 offset:768
    v_fma_f32 v155, v155, v51, v59
    v_fma_f32 v156, v156, v52, v60
    v_fma_f32 v157, v157, v53, v61
    v_fma_f32 v158, v158, v54, v62
    v_fma_f32 v159, v159, v55, v63
    s_waitcnt lgkmcnt(7)
    v_mfma_f32_32x32x16_bf16 v[32:47], v[88:91], a[232:235], v[32:47]
    ds_read_b128 v[80:83], v18 offset:0
    v_cvt_pk_bf16_f32 v152, v152, v153
    v_cvt_pk_bf16_f32 v153, v154, v155
    v_cvt_pk_bf16_f32 v154, v156, v157
    v_cvt_pk_bf16_f32 v155, v158, v159
    v_xor_b32 v156, 3120, v31
    s_waitcnt lgkmcnt(7)
    v_mfma_f32_32x32x16_bf16 v[32:47], v[92:95], a[236:239], v[32:47]
    ds_read_b128 v[84:87], v19 offset:256
    ds_write_b128 v156, v[152:155] offset:32768
    v_fma_f32 v160, v160, v48, v56
    v_fma_f32 v161, v161, v49, v57
    v_fma_f32 v162, v162, v50, v58
    v_fma_f32 v163, v163, v51, v59
    s_waitcnt lgkmcnt(7)
    v_mfma_f32_32x32x16_bf16 v[32:47], v[96:99], a[240:243], v[32:47]
    ds_read_b128 v[88:91], v20 offset:512
    v_fma_f32 v164, v164, v52, v60
    v_fma_f32 v165, v165, v53, v61
    v_fma_f32 v166, v166, v54, v62
    v_fma_f32 v167, v167, v55, v63
    v_cvt_pk_bf16_f32 v160, v160, v161
    s_waitcnt lgkmcnt(7)
    v_mfma_f32_32x32x16_bf16 v[32:47], v[100:103], a[244:247], v[32:47]
    ds_read_b128 v[92:95], v21 offset:768
    v_cvt_pk_bf16_f32 v161, v162, v163
    v_cvt_pk_bf16_f32 v162, v164, v165
    v_cvt_pk_bf16_f32 v163, v166, v167
    v_xor_b32 v164, 4160, v31
    ds_write_b128 v164, v[160:163] offset:32768
    s_waitcnt lgkmcnt(8)
    v_mfma_f32_32x32x16_bf16 v[32:47], v[104:107], a[248:251], v[32:47]
    ds_read_b128 v[96:99], v19 offset:0
    v_fma_f32 v168, v168, v48, v56
    v_fma_f32 v169, v169, v49, v57
    v_fma_f32 v170, v170, v50, v58
    v_fma_f32 v171, v171, v51, v59
    v_fma_f32 v172, v172, v52, v60
    s_waitcnt lgkmcnt(7)
    v_mfma_f32_32x32x16_bf16 v[32:47], v[108:111], a[252:255], v[32:47]
    ds_read_b128 v[100:103], v18 offset:256
    v_fma_f32 v173, v173, v53, v61
    v_fma_f32 v174, v174, v54, v62
    v_fma_f32 v175, v175, v55, v63
    v_cvt_pk_bf16_f32 v168, v168, v169
    v_cvt_pk_bf16_f32 v169, v170, v171
    s_waitcnt lgkmcnt(7)
    v_mfma_f32_32x32x16_bf16 v[32:47], v[80:83], v[192:195], v[32:47]
    ds_read_b128 v[104:107], v21 offset:512
    v_cvt_pk_bf16_f32 v170, v172, v173
    v_cvt_pk_bf16_f32 v171, v174, v175
    v_xor_b32 v172, 5200, v31
    ds_write_b128 v172, v[168:171] offset:32768
    v_fma_f32 v176, v176, v48, v56
    s_waitcnt lgkmcnt(8)
    v_mfma_f32_32x32x16_bf16 v[32:47], v[84:87], v[196:199], v[32:47]
    ds_read_b128 v[108:111], v20 offset:768
    v_fma_f32 v177, v177, v49, v57
    v_fma_f32 v178, v178, v50, v58
    v_fma_f32 v179, v179, v51, v59
    v_fma_f32 v180, v180, v52, v60
    v_fma_f32 v181, v181, v53, v61
    s_waitcnt lgkmcnt(7)
    v_mfma_f32_32x32x16_bf16 v[32:47], v[88:91], v[200:203], v[32:47]
    ds_read_b128 v[80:83], v20 offset:0
    v_fma_f32 v182, v182, v54, v62
    v_fma_f32 v183, v183, v55, v63
    v_cvt_pk_bf16_f32 v176, v176, v177
    v_cvt_pk_bf16_f32 v177, v178, v179
    v_cvt_pk_bf16_f32 v178, v180, v181
    s_waitcnt lgkmcnt(7)
    v_mfma_f32_32x32x16_bf16 v[32:47], v[92:95], v[204:207], v[32:47]
    ds_read_b128 v[84:87], v21 offset:256
    v_cvt_pk_bf16_f32 v179, v182, v183
    v_xor_b32 v180, 6240, v31
    ds_write_b128 v180, v[176:179] offset:32768
    v_fma_f32 v184, v184, v48, v56
    v_fma_f32 v185, v185, v49, v57
    s_waitcnt lgkmcnt(7)
    v_mfma_f32_32x32x16_bf16 v[32:47], v[96:99], v[208:211], v[32:47]
    ds_read_b128 v[88:91], v18 offset:512
    s_add_u32 m0, s30, 8192
    s_xor_b32 s36, s20, 256
    buffer_load_dwordx4 v2, s[12:15], s36 offen offset:0  lds
    v_fma_f32 v186, v186, v50, v58
    v_fma_f32 v187, v187, v51, v59
    s_waitcnt lgkmcnt(7)
    v_mfma_f32_32x32x16_bf16 v[32:47], v[100:103], v[212:215], v[32:47]
    ds_read_b128 v[92:95], v19 offset:768
    v_fma_f32 v188, v188, v52, v60
    v_fma_f32 v189, v189, v53, v61
    v_fma_f32 v190, v190, v54, v62
    v_fma_f32 v191, v191, v55, v63
    v_cvt_pk_bf16_f32 v184, v184, v185
    s_waitcnt lgkmcnt(7)
    v_mfma_f32_32x32x16_bf16 v[32:47], v[104:107], v[216:219], v[32:47]
    ds_read_b128 v[96:99], v21 offset:0
    s_add_u32 m0, s30, 8192
    s_xor_b32 s36, s20, 256
    buffer_load_dwordx4 v3, s[12:15], s36 offen offset:1024  lds
    v_cvt_pk_bf16_f32 v185, v186, v187
    v_cvt_pk_bf16_f32 v186, v188, v189
    s_waitcnt lgkmcnt(6)
    v_mfma_f32_32x32x16_bf16 v[32:47], v[108:111], v[220:223], v[32:47]
    ds_read_b128 v[100:103], v20 offset:256
    v_cvt_pk_bf16_f32 v187, v190, v191
    v_xor_b32 v188, 7280, v31
    ds_write_b128 v188, v[184:187] offset:32768
    s_waitcnt lgkmcnt(7)
    v_mfma_f32_32x32x16_bf16 v[32:47], v[80:83], v[224:227], v[32:47]
    ds_read_b128 v[104:107], v19 offset:512
    s_add_u32 m0, s30, 8192
    s_xor_b32 s36, s20, 256
    buffer_load_dwordx4 v4, s[12:15], s36 offen offset:2048  lds
    s_waitcnt lgkmcnt(7)
    v_mfma_f32_32x32x16_bf16 v[32:47], v[84:87], v[228:231], v[32:47]
    ds_read_b128 v[108:111], v18 offset:768
    s_waitcnt lgkmcnt(6)
    v_mfma_f32_32x32x16_bf16 v[32:47], v[88:91], v[232:235], v[32:47]
    s_waitcnt lgkmcnt(2)
    s_barrier
    ds_read_b128 v[80:83], v14 offset:32768
    s_add_u32 m0, s30, 8192
    s_xor_b32 s36, s20, 256
    buffer_load_dwordx4 v5, s[12:15], s36 offen offset:3072  lds
    v_mfma_f32_32x32x16_bf16 v[32:47], v[92:95], v[236:239], v[32:47]
    ds_read_b128 v[84:87], v15 offset:33024
    v_mfma_f32_32x32x16_bf16 v[32:47], v[96:99], v[240:243], v[32:47]
    ds_read_b128 v[88:91], v16 offset:33280
    s_add_u32 m0, s30, 12288
    s_xor_b32 s36, s20, 384
    buffer_load_dwordx4 v2, s[12:15], s36 offen offset:0  lds
    v_mfma_f32_32x32x16_bf16 v[32:47], v[100:103], v[244:247], v[32:47]
    ds_read_b128 v[92:95], v17 offset:33536
    s_waitcnt lgkmcnt(5)
    v_mfma_f32_32x32x16_bf16 v[32:47], v[104:107], v[248:251], v[32:47]
    ds_read_b128 v[96:99], v15 offset:32768
    s_add_u32 m0, s30, 12288
    s_xor_b32 s36, s20, 384
    buffer_load_dwordx4 v3, s[12:15], s36 offen offset:1024  lds
    s_waitcnt lgkmcnt(5)
    v_mfma_f32_32x32x16_bf16 v[32:47], v[108:111], v[252:255], v[32:47]
    ds_read_b128 v[100:103], v14 offset:33024
    s_waitcnt lgkmcnt(5)
    v_mfma_f32_32x32x16_bf16 v[64:79], v[80:83], a[192:195], 0
    ds_read_b128 v[104:107], v17 offset:33280
    s_add_u32 m0, s30, 12288
    s_xor_b32 s36, s20, 384
    buffer_load_dwordx4 v4, s[12:15], s36 offen offset:2048  lds
    s_waitcnt lgkmcnt(5)
    v_mfma_f32_32x32x16_bf16 v[64:79], v[84:87], a[196:199], v[64:79]
    ds_read_b128 v[108:111], v16 offset:33536
    s_nop 1
    v_cvt_pk_bf16_f32 v32, v32, v33
    v_cvt_pk_bf16_f32 v33, v34, v35
    v_cvt_pk_bf16_f32 v34, v36, v37
    v_cvt_pk_bf16_f32 v35, v38, v39
    v_cvt_pk_bf16_f32 v36, v40, v41
    s_waitcnt lgkmcnt(5)
    v_mfma_f32_32x32x16_bf16 v[64:79], v[88:91], a[200:203], v[64:79]
    ds_read_b128 v[80:83], v16 offset:32768
    s_add_u32 m0, s30, 12288
    s_xor_b32 s36, s20, 384
    buffer_load_dwordx4 v5, s[12:15], s36 offen offset:3072  lds
    v_cvt_pk_bf16_f32 v37, v42, v43
    v_cvt_pk_bf16_f32 v38, v44, v45
    s_waitcnt lgkmcnt(5)
    v_mfma_f32_32x32x16_bf16 v[64:79], v[92:95], a[204:207], v[64:79]
    ds_read_b128 v[84:87], v17 offset:33024
    v_cvt_pk_bf16_f32 v39, v46, v47
    v_xor_b32 v32, s47, v32
    v_xor_b32 v33, s47, v33
    v_xor_b32 v34, s47, v34
    v_xor_b32 v35, s47, v35
    s_waitcnt lgkmcnt(5)
    v_mfma_f32_32x32x16_bf16 v[64:79], v[96:99], a[208:211], v[64:79]
    ds_read_b128 v[88:91], v14 offset:33280
    s_add_u32 m0, s30, 16384
    s_xor_b32 s36, s20, 512
    buffer_load_dwordx4 v2, s[12:15], s36 offen offset:0  lds
    v_xor_b32 v36, s47, v36
    v_xor_b32 v37, s47, v37
    s_waitcnt lgkmcnt(5)
    v_mfma_f32_32x32x16_bf16 v[64:79], v[100:103], a[212:215], v[64:79]
    ds_read_b128 v[92:95], v15 offset:33536
    v_xor_b32 v38, s47, v38
    v_xor_b32 v39, s47, v39
    s_waitcnt lgkmcnt(5)
    v_mfma_f32_32x32x16_bf16 v[64:79], v[104:107], a[216:219], v[64:79]
    ds_read_b128 v[96:99], v17 offset:32768
    s_add_u32 m0, s30, 16384
    s_xor_b32 s36, s20, 512
    buffer_load_dwordx4 v3, s[12:15], s36 offen offset:1024  lds
    s_waitcnt lgkmcnt(5)
    v_mfma_f32_32x32x16_bf16 v[64:79], v[108:111], a[220:223], v[64:79]
    ds_read_b128 v[100:103], v16 offset:33024
    s_waitcnt lgkmcnt(5)
    v_mfma_f32_32x32x16_bf16 v[64:79], v[80:83], a[224:227], v[64:79]
    ds_read_b128 v[104:107], v15 offset:33280
    s_add_u32 m0, s30, 16384
    s_xor_b32 s36, s20, 512
    buffer_load_dwordx4 v4, s[12:15], s36 offen offset:2048  lds
    s_waitcnt lgkmcnt(5)
    v_mfma_f32_32x32x16_bf16 v[64:79], v[84:87], a[228:231], v[64:79]
    ds_read_b128 v[108:111], v14 offset:33536
    s_waitcnt lgkmcnt(5)
    v_mfma_f32_32x32x16_bf16 v[64:79], v[88:91], a[232:235], v[64:79]
    ds_read_b128 v[80:83], v18 offset:32768
    s_add_u32 m0, s30, 16384
    s_xor_b32 s36, s20, 512
    buffer_load_dwordx4 v5, s[12:15], s36 offen offset:3072  lds
    s_waitcnt lgkmcnt(5)
    v_mfma_f32_32x32x16_bf16 v[64:79], v[92:95], a[236:239], v[64:79]
    ds_read_b128 v[84:87], v19 offset:33024
    s_waitcnt lgkmcnt(5)
    v_mfma_f32_32x32x16_bf16 v[64:79], v[96:99], a[240:243], v[64:79]
    ds_read_b128 v[88:91], v20 offset:33280
    buffer_store_dwordx4 v[32:35], v1, s[4:7], s44 offen offset:0 sc1
    s_waitcnt vmcnt(17)
    ds_read_b128 a[128:131], v10 offset:0
    ds_read_b128 a[132:135], v11 offset:0
    s_waitcnt lgkmcnt(7)
    v_mfma_f32_32x32x16_bf16 v[64:79], v[100:103], a[244:247], v[64:79]
    ds_read_b128 v[92:95], v21 offset:33536
    ds_read_b128 a[136:139], v12 offset:0
    ds_read_b128 a[140:143], v13 offset:0
    s_waitcnt vmcnt(13)
    ds_read_b128 a[144:147], v10 offset:4096
    ds_read_b128 a[148:151], v11 offset:4096
    ds_read_b128 a[152:155], v12 offset:4096
    s_waitcnt lgkmcnt(12)
    v_mfma_f32_32x32x16_bf16 v[64:79], v[104:107], a[248:251], v[64:79]
    ds_read_b128 v[96:99], v19 offset:32768
    buffer_store_dwordx4 v[36:39], v1, s[4:7], s44 offen offset:1024 sc1
    ds_read_b128 a[156:159], v13 offset:4096
    s_waitcnt lgkmcnt(13)
    v_mfma_f32_32x32x16_bf16 v[64:79], v[108:111], a[252:255], v[64:79]
    ds_read_b128 v[100:103], v18 offset:33024
    s_waitcnt lgkmcnt(13)
    v_mfma_f32_32x32x16_bf16 v[64:79], v[80:83], v[192:195], v[64:79]
    ds_read_b128 v[104:107], v21 offset:33280
    s_waitcnt lgkmcnt(7)
    s_add_u32 m0, s30, 0
    s_xor_b32 s36, s20, 640
    buffer_load_dwordx4 v2, s[12:15], s36 offen offset:0  lds
    v_mfma_f32_32x32x16_bf16 v[64:79], v[84:87], v[196:199], v[64:79]
    ds_read_b128 v[108:111], v20 offset:33536
    v_mfma_f32_32x32x16_bf16 v[64:79], v[88:91], v[200:203], v[64:79]
    ds_read_b128 v[80:83], v20 offset:32768
    s_add_u32 m0, s30, 0
    s_xor_b32 s36, s20, 640
    buffer_load_dwordx4 v3, s[12:15], s36 offen offset:1024  lds
    v_mfma_f32_32x32x16_bf16 v[64:79], v[92:95], v[204:207], v[64:79]
    ds_read_b128 v[84:87], v21 offset:33024
    s_waitcnt lgkmcnt(6)
    v_mfma_f32_32x32x16_bf16 v[64:79], v[96:99], v[208:211], v[64:79]
    ds_read_b128 v[88:91], v18 offset:33280
    s_add_u32 m0, s30, 0
    s_xor_b32 s36, s20, 640
    buffer_load_dwordx4 v4, s[12:15], s36 offen offset:2048  lds
    s_waitcnt lgkmcnt(5)
    v_mfma_f32_32x32x16_bf16 v[64:79], v[100:103], v[212:215], v[64:79]
    ds_read_b128 v[92:95], v19 offset:33536
    s_waitcnt lgkmcnt(5)
    v_mfma_f32_32x32x16_bf16 v[64:79], v[104:107], v[216:219], v[64:79]
    ds_read_b128 v[96:99], v21 offset:32768
    s_add_u32 m0, s30, 0
    s_xor_b32 s36, s20, 640
    buffer_load_dwordx4 v5, s[12:15], s36 offen offset:3072  lds
    s_waitcnt lgkmcnt(5)
    v_mfma_f32_32x32x16_bf16 v[64:79], v[108:111], v[220:223], v[64:79]
    ds_read_b128 v[100:103], v20 offset:33024
    s_waitcnt lgkmcnt(5)
    v_mfma_f32_32x32x16_bf16 v[64:79], v[80:83], v[224:227], v[64:79]
    ds_read_b128 v[104:107], v19 offset:33280
    s_add_u32 m0, s30, 4096
    s_xor_b32 s36, s20, 768
    buffer_load_dwordx4 v2, s[12:15], s36 offen offset:0  lds
    s_waitcnt lgkmcnt(5)
    v_mfma_f32_32x32x16_bf16 v[64:79], v[84:87], v[228:231], v[64:79]
    ds_read_b128 v[108:111], v18 offset:33536
    s_waitcnt lgkmcnt(5)
    v_mfma_f32_32x32x16_bf16 v[64:79], v[88:91], v[232:235], v[64:79]
    s_add_u32 m0, s30, 4096
    s_xor_b32 s36, s20, 768
    buffer_load_dwordx4 v3, s[12:15], s36 offen offset:1024  lds
    s_waitcnt lgkmcnt(4)
    v_mfma_f32_32x32x16_bf16 v[64:79], v[92:95], v[236:239], v[64:79]
    s_waitcnt lgkmcnt(3)
    v_mfma_f32_32x32x16_bf16 v[64:79], v[96:99], v[240:243], v[64:79]
    s_add_u32 m0, s30, 4096
    s_xor_b32 s36, s20, 768
    buffer_load_dwordx4 v4, s[12:15], s36 offen offset:2048  lds
    s_waitcnt lgkmcnt(2)
    v_mfma_f32_32x32x16_bf16 v[64:79], v[100:103], v[244:247], v[64:79]
    s_waitcnt lgkmcnt(1)
    v_mfma_f32_32x32x16_bf16 v[64:79], v[104:107], v[248:251], v[64:79]
    s_add_u32 m0, s30, 4096
    s_xor_b32 s36, s20, 768
    buffer_load_dwordx4 v5, s[12:15], s36 offen offset:3072  lds
    s_waitcnt vmcnt(18)
    ds_read_b128 a[32:35], v10 offset:8192
    ds_read_b128 a[36:39], v11 offset:8192
    s_waitcnt lgkmcnt(2)
    v_mfma_f32_32x32x16_bf16 v[64:79], v[108:111], v[252:255], v[64:79]
    ds_read_b128 a[40:43], v12 offset:8192
    ds_read_b128 a[44:47], v13 offset:8192
    s_nop 9
    v_cvt_pk_bf16_f32 v64, v64, v65
    v_cvt_pk_bf16_f32 v65, v66, v67
    v_cvt_pk_bf16_f32 v66, v68, v69
    v_cvt_pk_bf16_f32 v67, v70, v71
    v_cvt_pk_bf16_f32 v68, v72, v73
    v_cvt_pk_bf16_f32 v69, v74, v75
    v_cvt_pk_bf16_f32 v70, v76, v77
    v_cvt_pk_bf16_f32 v71, v78, v79
    v_xor_b32 v64, s47, v64
    v_xor_b32 v65, s47, v65
    v_xor_b32 v66, s47, v66
    v_xor_b32 v67, s47, v67
    v_xor_b32 v68, s47, v68
    v_xor_b32 v69, s47, v69
    v_xor_b32 v70, s47, v70
    v_xor_b32 v71, s47, v71
    buffer_store_dwordx4 v[64:67], v1, s[4:7], s45 offen offset:0 sc1
    buffer_store_dwordx4 v[68:71], v1, s[4:7], s45 offen offset:1024 sc1
    s_load_dwordx4 s[56:59], s[0:1], 48
    s_mov_b32 s62, s46
    s_lshl_b32 s36, s27, 2
    s_add_u32 s36, s36, s26
    s_lshl_b32 s37, s29, 2
    s_add_u32 s37, s37, s3
    s_lshl_b32 s48, s37, 9
    s_add_u32 s48, s48, s36
    s_lshl_b32 s48, s48, 6
    v_lshrrev_b32 v8, 5, v0
    v_lshlrev_b32 v8, 4, v8
    v_subrev_u32 v7, s30, v10
    v_lshrrev_b32 v7, 7, v7
    v_lshl_add_u32 v7, v7, 10, v8
    s_lshl_b32 s54, s3, 11
    s_lshl_b32 s51, s37, 6
    s_add_u32 s51, s51, s36
    s_lshl_b32 s51, s51, 2
    s_add_u32 s51, s51, 25821184
    s_lshl_b32 s38, s37, 4
    s_add_u32 s38, s38, s36
    s_lshl_b32 s49, s38, 11
    s_add_u32 s49, s49, 14680064
    s_lshl_b32 s50, s38, 8
    s_add_u32 s50, s50, 25165824
    s_lshl_b32 s36, s36, 6
    s_add_u32 s36, s36, 57344
    v_add_u32 v8, s36, v8
    buffer_load_dwordx4 v[180:183], v7, s[8:11], s48 offen offset:0
    buffer_load_dwordx4 v[184:187], v7, s[8:11], s48 offen offset:32
    s_lshl_b32 s36, s26, 2
    s_add_u32 s36, s36, s27
    s_lshl_b32 s37, s36, 6
    s_add_u32 s37, s37, s31
    s_lshl_b32 s37, s37, 1
    s_add_u32 s37, s37, s3
    s_lshl_b32 s37, s37, 11
    s_lshl_b32 s21, s36, 3
    s_and_b32 s38, s2, 4
    s_add_u32 s21, s21, s38
    s_lshl_b32 s21, s21, 5
    s_add_u32 s21, s21, 25755648
    s_lshl_b32 s38, s29, 2
    s_add_u32 s38, s38, s27
    s_lshl_b32 s38, s38, 4
    s_add_u32 s38, s38, s3
    s_mul_i32 s38, s38, 9216
    s_add_u32 s38, s38, 4194304
    s_add_u32 s36, s26, 1
    s_and_b32 s36, s36, 3
    s_lshl_b32 s39, s36, 16
    s_or_b32 s40, s37, s39
    s_mul_i32 s36, s36, 36864
    s_add_u32 s44, s36, s38
    s_add_u32 s36, s26, 2
    s_and_b32 s36, s36, 3
    s_lshl_b32 s39, s36, 16
    s_or_b32 s41, s37, s39
    s_mul_i32 s36, s36, 36864
    s_add_u32 s45, s36, s38
    s_add_u32 s45, s45, 3072
    s_add_u32 s36, s26, 3
    s_and_b32 s36, s36, 3
    s_lshl_b32 s39, s36, 16
    s_or_b32 s42, s37, s39
    s_mul_i32 s36, s36, 36864
    s_add_u32 s46, s36, s38
    s_add_u32 s46, s46, 6144
    s_add_u32 s36, s26, 4
    s_and_b32 s36, s36, 3
    s_lshl_b32 s39, s36, 16
    s_or_b32 s43, s37, s39
    s_mul_i32 s36, s36, 36864
    s_add_u32 s47, s36, s38
    v_lshlrev_b32 v6, 7, v0
    s_lshr_b32 s36, s2, 3
    s_and_b32 s37, s36, 7
    s_mul_i32 s37, s37, 3
    s_min_u32 s37, s37, 20
    s_bitcmp1_b32 s2, 0
    s_cselect_b32 s38, 22, 0
    s_add_u32 s55, s37, s38
    s_lshl_b32 s37, s55, 6
    s_lshr_b32 s36, s36, 3
    s_lshl_b32 s38, s3, 2
    s_add_u32 s36, s36, s38
    s_lshl_b32 s52, s36, 1
    s_lshl_b32 s53, s36, 11
    s_add_u32 s53, s53, 65536
    v_lshrrev_b32 v14, 2, v0
    v_mul_u32_u24 v14, 2752, v14
    v_and_b32 v15, 3, v0
    v_lshl_add_u32 v14, v15, 4, v14
    v_add_u32 v14, s37, v14
    v_add_u32 v15, 64, v14
    v_add_u32 v16, 128, v14
    v_mov_b32 v131, v30
    v_mov_b32 v135, v30
    v_mov_b32 v139, v30
    v_mov_b32 v138, 0
    s_waitcnt vmcnt(2)
    s_barrier
    s_cmp_lg_u32 s3, 0
    s_cbranch_scc1 NOFA_6
    s_mov_b64 exec, 3
    buffer_store_dword v30, v6, s[4:7], s62 offen sc1
    s_mov_b64 exec, -1
NOFA_6:
    s_waitcnt lgkmcnt(0)
    s_mov_b32 s16, s56
    s_and_b32 s17, s57, 0xffff
    s_mov_b32 s18, 1409024
    s_mov_b32 s19, 0x00020000
    s_mov_b64 s[22:23], s[58:59]
    s_lshr_b32 s64, s2, 5
    s_lshl_b32 s65, s64, 1
    s_lshr_b32 s66, 149796, s65
    s_add_u32 m0, s30, 8192
    s_xor_b32 s36, s20, 896
    buffer_load_dwordx4 v2, s[12:15], s36 offen offset:0  lds
    s_and_b32 s66, s66, 3
    s_mul_i32 s66, s66, 12288
    s_add_u32 s26, s66, 4096
    s_add_u32 m0, s30, 8192
    s_xor_b32 s36, s20, 896
    buffer_load_dwordx4 v3, s[12:15], s36 offen offset:1024  lds
    s_lshr_b32 s66, 37449, s65
    s_and_b32 s66, s66, 3
    s_mul_i32 s66, s66, 12288
    s_add_u32 m0, s30, 8192
    s_xor_b32 s36, s20, 896
    buffer_load_dwordx4 v4, s[12:15], s36 offen offset:2048  lds
    s_add_u32 s27, s66, 4096
    s_lshr_b32 s66, 9362, s65
    s_and_b32 s66, s66, 3
    s_add_u32 m0, s30, 8192
    s_xor_b32 s36, s20, 896
    buffer_load_dwordx4 v5, s[12:15], s36 offen offset:3072  lds
    s_mul_i32 s66, s66, 12288
    s_add_u32 s28, s66, 4096
    s_mov_b32 s32, s22
    ds_read_b128 a[48:51], v10 offset:12288
    ds_read_b128 a[52:55], v11 offset:12288
    ds_read_b128 a[56:59], v12 offset:12288
    ds_read_b128 a[60:63], v13 offset:12288
    s_waitcnt lgkmcnt(0)
    s_add_u32 m0, s30, 12288
    s_xor_b32 s36, s20, 1280
    buffer_load_dwordx4 v2, s[12:15], s36 offen offset:0  lds
    s_and_b32 s33, s23, 0xffff
    s_mov_b32 s34, 1409024
    s_mov_b32 s35, 0x00020000
    s_add_u32 m0, s30, 12288
    s_xor_b32 s36, s20, 1280
    buffer_load_dwordx4 v3, s[12:15], s36 offen offset:1024  lds
    s_bfe_u32 s65, s2, 0x20001
    s_lshr_b32 s66, s2, 6
    s_lshl2_add_u32 s65, s65, s66
    s_add_u32 m0, s30, 12288
    s_xor_b32 s36, s20, 1280
    buffer_load_dwordx4 v4, s[12:15], s36 offen offset:2048  lds
    s_lshl2_add_u32 s65, s65, s3
    s_bfe_u32 s66, s2, 0x30003
    s_add_u32 m0, s30, 12288
    s_xor_b32 s36, s20, 1280
    buffer_load_dwordx4 v5, s[12:15], s36 offen offset:3072  lds
    s_lshl3_add_u32 s65, s65, s66
    s_lshl_b32 s29, s65, 12
    s_add_u32 s29, s29, 14680064
    ds_read_b128 a[64:67], v10 offset:16384
    ds_read_b128 a[68:71], v11 offset:16384
    ds_read_b128 a[72:75], v12 offset:16384
    ds_read_b128 a[76:79], v13 offset:16384
    s_waitcnt lgkmcnt(0)
    s_add_u32 m0, s30, 16384
    s_xor_b32 s36, s20, 1408
    buffer_load_dwordx4 v2, s[12:15], s36 offen offset:0  lds
    s_lshr_b32 s31, s65, 1
    s_lshl_b32 s31, s31, 10
    s_add_u32 s31, s31, 25165824
    s_add_u32 m0, s30, 16384
    s_xor_b32 s36, s20, 1408
    buffer_load_dwordx4 v3, s[12:15], s36 offen offset:1024  lds
    v_lshrrev_b32 v22, 5, v0
    v_lshlrev_b32 v9, 9, v22
    v_bfe_u32 v26, v0, 2, 2
    s_add_u32 m0, s30, 16384
    s_xor_b32 s36, s20, 1408
    buffer_load_dwordx4 v4, s[12:15], s36 offen offset:2048  lds
    v_lshl_or_b32 v9, v26, 6, v9
    v_bfe_u32 v21, v0, 4, 1
    v_lshl_or_b32 v9, v21, 5, v9
    s_add_u32 m0, s30, 16384
    s_xor_b32 s36, s20, 1408
    buffer_load_dwordx4 v5, s[12:15], s36 offen offset:3072  lds
    v_and_b32 v26, 1, v0
    v_lshl_or_b32 v9, v26, 4, v9
    v_bfe_u32 v26, v0, 1, 1
    ds_read_b128 a[80:83], v10 offset:0
    ds_read_b128 a[84:87], v11 offset:0
    ds_read_b128 a[88:91], v12 offset:0
    ds_read_b128 a[92:95], v13 offset:0
    s_waitcnt lgkmcnt(0)
    s_add_u32 m0, s30, 0
    s_xor_b32 s36, s20, 1536
    buffer_load_dwordx4 v2, s[12:15], s36 offen offset:0  lds
    v_lshl_or_b32 v9, v26, 3, v9
    s_lshl_b32 s66, s66, 12
    s_add_u32 s66, s66, 65536
    s_add_u32 m0, s30, 0
    s_xor_b32 s36, s20, 1536
    buffer_load_dwordx4 v3, s[12:15], s36 offen offset:1024  lds
    v_add_u32 v17, s66, v9
    v_add_u32 v18, 0x10000, v17
    s_add_u32 m0, s30, 0
    s_xor_b32 s36, s20, 1536
    buffer_load_dwordx4 v4, s[12:15], s36 offen offset:2048  lds
    s_min_u32 s66, s3, 2
    s_lshl_b32 s67, s66, 15
    s_add_u32 s67, s67, 65536
    s_add_u32 m0, s30, 0
    s_xor_b32 s36, s20, 1536
    buffer_load_dwordx4 v5, s[12:15], s36 offen offset:3072  lds
    v_add_u32 v20, s67, v9
    s_lshl_b32 s67, s3, 12
    v_add_u32 v9, s67, v9
    ds_read_b128 a[96:99], v10 offset:4096
    ds_read_b128 a[100:103], v11 offset:4096
    ds_read_b128 a[104:107], v12 offset:4096
    ds_read_b128 a[108:111], v13 offset:4096
    s_waitcnt lgkmcnt(0)
    s_add_u32 m0, s30, 4096
    s_xor_b32 s36, s20, 1664
    buffer_load_dwordx4 v2, s[12:15], s36 offen offset:0  lds
    v_lshlrev_b32 v26, 10, v21
    v_sub_u32 v19, 59392, v26
    v_lshl_add_u32 v19, v22, 4, v19
    s_add_u32 m0, s30, 4096
    s_xor_b32 s36, s20, 1664
    buffer_load_dwordx4 v3, s[12:15], s36 offen offset:1024  lds
    v_lshlrev_b32 v22, 6, v22
    v_add_u32 v22, 61440, v22
    v_lshl_add_u32 v21, v21, 7, v22
    s_add_u32 m0, s30, 4096
    s_xor_b32 s36, s20, 1664
    buffer_load_dwordx4 v4, s[12:15], s36 offen offset:2048  lds
    s_lshl_b32 s66, s66, 8
    v_add_u32 v21, s66, v21
    v_add_u32 v23, 65536, v1
    s_add_u32 m0, s30, 4096
    s_xor_b32 s36, s20, 1664
    buffer_load_dwordx4 v5, s[12:15], s36 offen offset:3072  lds
    v_add_u32 v24, 110592, v1
    s_waitcnt vmcnt(16)
    ds_read_b128 a[112:115], v10 offset:8192
    ds_read_b128 a[116:119], v11 offset:8192
    ds_read_b128 a[120:123], v12 offset:8192
    ds_read_b128 a[124:127], v13 offset:8192
    s_waitcnt vmcnt(12)
    ds_read_b128 a[160:163], v10 offset:12288
    ds_read_b128 a[164:167], v11 offset:12288
    ds_read_b128 a[168:171], v12 offset:12288
    ds_read_b128 a[172:175], v13 offset:12288
    s_waitcnt lgkmcnt(0)
    s_waitcnt lgkmcnt(0)
    s_cmp_lg_u32 s3, 0
    s_cbranch_scc1 FAJ_9
    s_mov_b32 s25, s24
    s_mov_b32 s39, 20000
    s_load_dwordx16 s[56:71], s[4:5], s21 glc
FAJ_9:
    s_add_u32 m0, s30, 8192
    s_xor_b32 s36, s20, 1792
    buffer_load_dwordx4 v2, s[12:15], s36 offen offset:0  lds
    buffer_load_dwordx4 v3, s[12:15], s36 offen offset:1024  lds
    buffer_load_dwordx4 v4, s[12:15], s36 offen offset:2048  lds
    buffer_load_dwordx4 v5, s[12:15], s36 offen offset:3072  lds
    s_add_u32 m0, s30, 12288
    s_xor_b32 s36, s20, 1920
    buffer_load_dwordx4 v2, s[12:15], s36 offen offset:0  lds
    buffer_load_dwordx4 v3, s[12:15], s36 offen offset:1024  lds
    buffer_load_dwordx4 v4, s[12:15], s36 offen offset:2048  lds
    buffer_load_dwordx4 v5, s[12:15], s36 offen offset:3072  lds
    s_cmp_lg_u32 s3, 0
    s_cbranch_scc1 FAD_8
FA_7:
    s_waitcnt lgkmcnt(0)
    s_xor_b64 s[56:57], s[56:57], s[24:25]
    s_xor_b64 s[58:59], s[58:59], s[24:25]
    s_xor_b64 s[60:61], s[60:61], s[24:25]
    s_xor_b64 s[62:63], s[62:63], s[24:25]
    s_xor_b64 s[64:65], s[64:65], s[24:25]
    s_xor_b64 s[66:67], s[66:67], s[24:25]
    s_xor_b64 s[68:69], s[68:69], s[24:25]
    s_xor_b64 s[70:71], s[70:71], s[24:25]
    s_or_b64 s[56:57], s[56:57], s[64:65]
    s_or_b64 s[58:59], s[58:59], s[66:67]
    s_or_b64 s[60:61], s[60:61], s[68:69]
    s_or_b64 s[62:63], s[62:63], s[70:71]
    s_or_b64 s[56:57], s[56:57], s[60:61]
    s_or_b64 s[58:59], s[58:59], s[62:63]
    s_or_b64 s[56:57], s[56:57], s[58:59]
    s_cbranch_scc0 FAD_8
    s_sleep 1
    s_load_dwordx16 s[56:71], s[4:5], s21 glc
    s_sub_u32 s39, s39, 1
    s_cmp_lg_u32 s39, 0
    s_cbranch_scc1 FA_7
    s_waitcnt lgkmcnt(0)
FAD_8:
    s_barrier
    s_add_u32 m0, s54, 24576
    s_xor_b32 s36, s40, 0
    buffer_load_dwordx4 v1, s[4:7], s36 offen offset:0 sc1 lds
    s_add_u32 m0, s54, 24576
    s_xor_b32 s36, s40, 0
    buffer_load_dwordx4 v1, s[4:7], s36 offen offset:1024 sc1 lds
    s_add_u32 m0, s54, 32768
    s_xor_b32 s36, s40, 8192
    buffer_load_dwordx4 v1, s[4:7], s36 offen offset:0 sc1 lds
    s_add_u32 m0, s54, 32768
    s_xor_b32 s36, s40, 8192
    buffer_load_dwordx4 v1, s[4:7], s36 offen offset:1024 sc1 lds
    s_waitcnt vmcnt(20)
    ds_read_b128 a[176:179], v10 offset:16384
    ds_read_b128 a[180:183], v11 offset:16384
    ds_read_b128 a[184:187], v12 offset:16384
    ds_read_b128 a[188:191], v13 offset:16384
    s_waitcnt vmcnt(16)
    ds_read_b128 a[192:195], v10 offset:0
    ds_read_b128 a[196:199], v11 offset:0
    ds_read_b128 a[200:203], v12 offset:0
    ds_read_b128 a[204:207], v13 offset:0
    s_waitcnt vmcnt(12)
    ds_read_b128 a[208:211], v10 offset:4096
    ds_read_b128 a[212:215], v11 offset:4096
    ds_read_b128 a[216:219], v12 offset:4096
    ds_read_b128 a[220:223], v13 offset:4096
    s_waitcnt vmcnt(8)
    ds_read_b128 a[224:227], v10 offset:8192
    ds_read_b128 a[228:231], v11 offset:8192
    ds_read_b128 a[232:235], v12 offset:8192
    ds_read_b128 a[236:239], v13 offset:8192
    s_waitcnt vmcnt(4)
    ds_read_b128 a[240:243], v10 offset:12288
    ds_read_b128 a[244:247], v11 offset:12288
    ds_read_b128 a[248:251], v12 offset:12288
    ds_read_b128 a[252:255], v13 offset:12288
    s_add_u32 m0, s54, 40960
    s_xor_b32 s36, s40, 16384
    buffer_load_dwordx4 v1, s[4:7], s36 offen offset:0 sc1 lds
    s_add_u32 m0, s54, 40960
    s_xor_b32 s36, s40, 16384
    buffer_load_dwordx4 v1, s[4:7], s36 offen offset:1024 sc1 lds
    s_add_u32 m0, s54, 49152
    s_xor_b32 s36, s40, 24576
    buffer_load_dwordx4 v1, s[4:7], s36 offen offset:0 sc1 lds
    s_add_u32 m0, s54, 49152
    s_xor_b32 s36, s40, 24576
    buffer_load_dwordx4 v1, s[4:7], s36 offen offset:1024 sc1 lds
    s_add_u32 m0, s54, 0
    s_xor_b32 s36, s40, 32768
    buffer_load_dwordx4 v1, s[4:7], s36 offen offset:0 sc1 lds
    s_add_u32 m0, s54, 0
    s_xor_b32 s36, s40, 32768
    buffer_load_dwordx4 v1, s[4:7], s36 offen offset:1024 sc1 lds
    s_add_u32 m0, s54, 8192
    s_xor_b32 s36, s40, 40960
    buffer_load_dwordx4 v1, s[4:7], s36 offen offset:0 sc1 lds
    s_add_u32 m0, s54, 8192
    s_xor_b32 s36, s40, 40960
    buffer_load_dwordx4 v1, s[4:7], s36 offen offset:1024 sc1 lds
    s_waitcnt vmcnt(10)
    s_barrier
    ds_read_b128 v[96:99], v1 offset:24576
    ds_read_b128 v[100:103], v1 offset:25600
    ds_read_b128 v[104:107], v1 offset:26624
    ds_read_b128 v[108:111], v1 offset:27648
    ds_read_b128 v[112:115], v1 offset:28672
    ds_read_b128 v[116:119], v1 offset:29696
    s_waitcnt lgkmcnt(5)
    v_mfma_f32_32x32x16_bf16 v[32:47], v[96:99], a[0:3], 0
    ds_read_b128 v[120:123], v1 offset:30720
    s_waitcnt lgkmcnt(5)
    v_mfma_f32_32x32x16_bf16 v[32:47], v[100:103], a[4:7], v[32:47]
    ds_read_b128 v[124:127], v1 offset:31744
    s_waitcnt lgkmcnt(5)
    v_mfma_f32_32x32x16_bf16 v[32:47], v[104:107], a[8:11], v[32:47]
    s_waitcnt vmcnt(8)
    s_barrier
    ds_read_b128 v[96:99], v1 offset:32768
    s_waitcnt lgkmcnt(5)
    v_mfma_f32_32x32x16_bf16 v[32:47], v[108:111], a[12:15], v[32:47]
    ds_read_b128 v[100:103], v1 offset:33792
    s_add_u32 m0, s54, 16384
    s_xor_b32 s36, s40, 49152
    buffer_load_dwordx4 v1, s[4:7], s36 offen offset:0 sc1 lds
    s_waitcnt lgkmcnt(5)
    v_mfma_f32_32x32x16_bf16 v[32:47], v[112:115], a[16:19], v[32:47]
    ds_read_b128 v[104:107], v1 offset:34816
    s_waitcnt lgkmcnt(5)
    v_mfma_f32_32x32x16_bf16 v[32:47], v[116:119], a[20:23], v[32:47]
    ds_read_b128 v[108:111], v1 offset:35840
    s_waitcnt lgkmcnt(5)
    v_mfma_f32_32x32x16_bf16 v[32:47], v[120:123], a[24:27], v[32:47]
    ds_read_b128 v[112:115], v1 offset:36864
    s_waitcnt lgkmcnt(5)
    v_mfma_f32_32x32x16_bf16 v[32:47], v[124:127], a[28:31], v[32:47]
    ds_read_b128 v[116:119], v1 offset:37888
    s_add_u32 m0, s54, 16384
    s_xor_b32 s36, s40, 49152
    buffer_load_dwordx4 v1, s[4:7], s36 offen offset:1024 sc1 lds
    s_waitcnt lgkmcnt(5)
    v_mfma_f32_32x32x16_bf16 v[32:47], v[96:99], a[32:35], v[32:47]
    ds_read_b128 v[120:123], v1 offset:38912
    s_lshr_b32 s64, s2, 5
    s_xor_b32 s65, s64, 0
    s_mul_i32 s65, s65, 3
    s_min_u32 s65, s65, 20
    s_waitcnt lgkmcnt(5)
    v_mfma_f32_32x32x16_bf16 v[32:47], v[100:103], a[36:39], v[32:47]
    ds_read_b128 v[124:127], v1 offset:39936
    s_lshl_b32 s8, s65, 11
    s_xor_b32 s65, s64, 1
    s_mul_i32 s65, s65, 3
    s_min_u32 s65, s65, 20
    s_waitcnt lgkmcnt(5)
    v_mfma_f32_32x32x16_bf16 v[32:47], v[104:107], a[40:43], v[32:47]
    s_waitcnt vmcnt(8)
    s_barrier
    ds_read_b128 v[96:99], v1 offset:40960
    s_lshl_b32 s9, s65, 11
    s_xor_b32 s65, s64, 2
    s_waitcnt lgkmcnt(5)
    v_mfma_f32_32x32x16_bf16 v[32:47], v[108:111], a[44:47], v[32:47]
    ds_read_b128 v[100:103], v1 offset:41984
    s_add_u32 m0, s54, 24576
    s_xor_b32 s36, s40, 57344
    buffer_load_dwordx4 v1, s[4:7], s36 offen offset:0 sc1 lds
    s_mul_i32 s65, s65, 3
    s_waitcnt lgkmcnt(5)
    v_mfma_f32_32x32x16_bf16 v[32:47], v[112:115], a[48:51], v[32:47]
    ds_read_b128 v[104:107], v1 offset:43008
    s_xor_b32 m0, s53, 0
    s_xor_b32 s36, s52, 0
    s_mul_i32 s36, s36, 44032
    buffer_load_dwordx4 v14, s[16:19], s36 offen lds
    s_min_u32 s65, s65, 20
    s_waitcnt lgkmcnt(5)
    v_mfma_f32_32x32x16_bf16 v[32:47], v[116:119], a[52:55], v[32:47]
    ds_read_b128 v[108:111], v1 offset:44032
    s_xor_b32 m0, s53, 32768
    s_xor_b32 s36, s52, 0
    s_mul_i32 s36, s36, 44032
    buffer_load_dwordx4 v15, s[16:19], s36 offen lds
    s_lshl_b32 s10, s65, 11
    s_waitcnt lgkmcnt(5)
    v_mfma_f32_32x32x16_bf16 v[32:47], v[120:123], a[56:59], v[32:47]
    ds_read_b128 v[112:115], v1 offset:45056
    s_xor_b32 m0, s53, 196608
    s_xor_b32 s36, s52, 0
    s_mul_i32 s36, s36, 44032
    buffer_load_dwordx4 v16, s[16:19], s36 offen lds
    s_xor_b32 s65, s64, 3
    s_waitcnt lgkmcnt(5)
    v_mfma_f32_32x32x16_bf16 v[32:47], v[124:127], a[60:63], v[32:47]
    ds_read_b128 v[116:119], v1 offset:46080
    s_add_u32 m0, s54, 24576
    s_xor_b32 s36, s40, 57344
    buffer_load_dwordx4 v1, s[4:7], s36 offen offset:1024 sc1 lds
    s_mul_i32 s65, s65, 3
    s_waitcnt lgkmcnt(5)
    v_mfma_f32_32x32x16_bf16 v[32:47], v[96:99], a[64:67], v[32:47]
    ds_read_b128 v[120:123], v1 offset:47104
    s_xor_b32 m0, s53, 1024
    s_xor_b32 s36, s52, 1
    s_mul_i32 s36, s36, 44032
    buffer_load_dwordx4 v14, s[16:19], s36 offen lds
    s_min_u32 s65, s65, 20
    s_waitcnt lgkmcnt(5)
    v_mfma_f32_32x32x16_bf16 v[32:47], v[100:103], a[68:71], v[32:47]
    ds_read_b128 v[124:127], v1 offset:48128
    s_xor_b32 m0, s53, 33792
    s_xor_b32 s36, s52, 1
    s_mul_i32 s36, s36, 44032
    buffer_load_dwordx4 v15, s[16:19], s36 offen lds
    s_lshl_b32 s11, s65, 11
    s_waitcnt lgkmcnt(5)
    v_mfma_f32_32x32x16_bf16 v[32:47], v[104:107], a[72:75], v[32:47]
    s_waitcnt vmcnt(13)
    s_barrier
    ds_read_b128 v[96:99], v1 offset:49152
    s_xor_b32 s65, s64, 4
    s_mul_i32 s65, s65, 3
    s_waitcnt lgkmcnt(5)
    v_mfma_f32_32x32x16_bf16 v[32:47], v[108:111], a[76:79], v[32:47]
    ds_read_b128 v[100:103], v1 offset:50176
    s_add_u32 m0, s54, 32768
    s_xor_b32 s36, s41, 0
    buffer_load_dwordx4 v1, s[4:7], s36 offen offset:0 sc1 lds
    s_min_u32 s65, s65, 20
    s_waitcnt lgkmcnt(5)
    v_mfma_f32_32x32x16_bf16 v[32:47], v[112:115], a[80:83], v[32:47]
    ds_read_b128 v[104:107], v1 offset:51200
    s_lshl_b32 s12, s65, 11
    s_xor_b32 s65, s64, 5
    s_mul_i32 s65, s65, 3
    s_min_u32 s65, s65, 20
    s_waitcnt lgkmcnt(5)
    v_mfma_f32_32x32x16_bf16 v[32:47], v[116:119], a[84:87], v[32:47]
    ds_read_b128 v[108:111], v1 offset:52224
    s_lshl_b32 s13, s65, 11
    s_xor_b32 s65, s64, 6
    s_mul_i32 s65, s65, 3
    s_min_u32 s65, s65, 20
    s_waitcnt lgkmcnt(5)
    v_mfma_f32_32x32x16_bf16 v[32:47], v[120:123], a[88:91], v[32:47]
    ds_read_b128 v[112:115], v1 offset:53248
    s_lshl_b32 s14, s65, 11
    s_xor_b32 s65, s64, 7
    s_mul_i32 s65, s65, 3
    s_min_u32 s65, s65, 20
    s_waitcnt lgkmcnt(5)
    v_mfma_f32_32x32x16_bf16 v[32:47], v[124:127], a[92:95], v[32:47]
    ds_read_b128 v[116:119], v1 offset:54272
    s_add_u32 m0, s54, 32768
    s_xor_b32 s36, s41, 0
    buffer_load_dwordx4 v1, s[4:7], s36 offen offset:1024 sc1 lds
    s_lshl_b32 s15, s65, 11
    s_waitcnt lgkmcnt(5)
    v_mfma_f32_32x32x16_bf16 v[32:47], v[96:99], a[96:99], v[32:47]
    ds_read_b128 v[120:123], v1 offset:55296
    s_and_b32 s64, s2, 1
    s_mul_i32 s20, s64, 11264
    s_bfe_u32 s65, s2, 0x20003
    s_lshl2_add_u32 s65, s65, s3
    s_waitcnt lgkmcnt(5)
    v_mfma_f32_32x32x16_bf16 v[32:47], v[100:103], a[100:103], v[32:47]
    ds_read_b128 v[124:127], v1 offset:56320
    s_add_u32 s20, s20, s65
    s_lshl_b32 s20, s20, 6
    s_lshl_b32 s30, s3, 12
    s_sub_u32 s65, s29, 14680064
    s_waitcnt lgkmcnt(5)
    v_mfma_f32_32x32x16_bf16 v[32:47], v[104:107], a[104:107], v[32:47]
    s_waitcnt vmcnt(13)
    s_barrier
    ds_read_b128 v[96:99], v1 offset:0
    s_lshr_b32 s65, s65, 15
    s_lshl1_add_u32 s21, s65, s64
    s_waitcnt lgkmcnt(5)
    v_mfma_f32_32x32x16_bf16 v[32:47], v[108:111], a[108:111], v[32:47]
    ds_read_b128 v[100:103], v1 offset:1024
    s_add_u32 m0, s54, 40960
    s_xor_b32 s36, s41, 8192
    buffer_load_dwordx4 v1, s[4:7], s36 offen offset:0 sc1 lds
    s_lshl_b32 s21, s21, 7
    s_waitcnt lgkmcnt(5)
    v_mfma_f32_32x32x16_bf16 v[32:47], v[112:115], a[112:115], v[32:47]
    ds_read_b128 v[104:107], v1 offset:2048
    s_add_u32 s21, s21, 25821184
    v_lshrrev_b32 v2, 2, v0
    v_and_b32 v3, 3, v0
    v_lshlrev_b32 v3, 4, v3
    s_waitcnt lgkmcnt(5)
    v_mfma_f32_32x32x16_bf16 v[32:47], v[116:119], a[116:119], v[32:47]
    ds_read_b128 v[108:111], v1 offset:3072
    v_lshl_add_u32 v2, v2, 10, v3
    v_add_u32 v3, 15360, v2
    v_add_u32 v4, 30720, v2
    v_add_u32 v5, 46080, v2
    s_waitcnt lgkmcnt(5)
    v_mfma_f32_32x32x16_bf16 v[32:47], v[120:123], a[120:123], v[32:47]
    ds_read_b128 v[112:115], v1 offset:4096
    v_and_b32 v10, 15, v0
    v_lshlrev_b32 v10, 2, v10
    s_waitcnt lgkmcnt(5)
    v_mfma_f32_32x32x16_bf16 v[32:47], v[124:127], a[124:127], v[32:47]
    ds_read_b128 v[116:119], v1 offset:5120
    s_add_u32 m0, s54, 40960
    s_xor_b32 s36, s41, 8192
    buffer_load_dwordx4 v1, s[4:7], s36 offen offset:1024 sc1 lds
    s_waitcnt lgkmcnt(5)
    v_mfma_f32_32x32x16_bf16 v[32:47], v[96:99], a[128:131], v[32:47]
    ds_read_b128 v[120:123], v1 offset:6144
    s_waitcnt lgkmcnt(5)
    v_mfma_f32_32x32x16_bf16 v[32:47], v[100:103], a[132:135], v[32:47]
    ds_read_b128 v[124:127], v1 offset:7168
    s_waitcnt lgkmcnt(5)
    v_mfma_f32_32x32x16_bf16 v[32:47], v[104:107], a[136:139], v[32:47]
    s_waitcnt vmcnt(13)
    s_barrier
    ds_read_b128 v[96:99], v1 offset:8192
    s_waitcnt lgkmcnt(5)
    v_mfma_f32_32x32x16_bf16 v[32:47], v[108:111], a[140:143], v[32:47]
    ds_read_b128 v[100:103], v1 offset:9216
    s_add_u32 m0, s54, 49152
    s_xor_b32 s36, s41, 16384
    buffer_load_dwordx4 v1, s[4:7], s36 offen offset:0 sc1 lds
    s_waitcnt lgkmcnt(5)
    v_mfma_f32_32x32x16_bf16 v[32:47], v[112:115], a[144:147], v[32:47]
    ds_read_b128 v[104:107], v1 offset:10240
    s_waitcnt lgkmcnt(5)
    v_mfma_f32_32x32x16_bf16 v[32:47], v[116:119], a[148:151], v[32:47]
    ds_read_b128 v[108:111], v1 offset:11264
    s_waitcnt lgkmcnt(5)
    v_mfma_f32_32x32x16_bf16 v[32:47], v[120:123], a[152:155], v[32:47]
    ds_read_b128 v[112:115], v1 offset:12288
    s_xor_b32 m0, s53, 197632
    s_xor_b32 s36, s52, 1
    s_mul_i32 s36, s36, 44032
    buffer_load_dwordx4 v16, s[16:19], s36 offen lds
    s_waitcnt lgkmcnt(5)
    v_mfma_f32_32x32x16_bf16 v[32:47], v[124:127], a[156:159], v[32:47]
    ds_read_b128 v[116:119], v1 offset:13312
    s_add_u32 m0, s54, 49152
    s_xor_b32 s36, s41, 16384
    buffer_load_dwordx4 v1, s[4:7], s36 offen offset:1024 sc1 lds
    s_waitcnt lgkmcnt(5)
    v_mfma_f32_32x32x16_bf16 v[32:47], v[96:99], a[160:163], v[32:47]
    ds_read_b128 v[120:123], v1 offset:14336
    s_waitcnt lgkmcnt(5)
    v_mfma_f32_32x32x16_bf16 v[32:47], v[100:103], a[164:167], v[32:47]
    ds_read_b128 v[124:127], v1 offset:15360
    s_waitcnt lgkmcnt(5)
    v_mfma_f32_32x32x16_bf16 v[32:47], v[104:107], a[168:171], v[32:47]
    s_waitcnt vmcnt(14)
    s_barrier
    ds_read_b128 v[96:99], v1 offset:16384
    s_waitcnt lgkmcnt(5)
    v_mfma_f32_32x32x16_bf16 v[32:47], v[108:111], a[172:175], v[32:47]
    ds_read_b128 v[100:103], v1 offset:17408
    s_add_u32 m0, s54, 0
    s_xor_b32 s36, s41, 24576
    buffer_load_dwordx4 v1, s[4:7], s36 offen offset:0 sc1 lds
    s_waitcnt lgkmcnt(5)
    v_mfma_f32_32x32x16_bf16 v[32:47], v[112:115], a[176:179], v[32:47]
    ds_read_b128 v[104:107], v1 offset:18432
    s_waitcnt lgkmcnt(5)
    v_mfma_f32_32x32x16_bf16 v[32:47], v[116:119], a[180:183], v[32:47]
    ds_read_b128 v[108:111], v1 offset:19456
    s_waitcnt lgkmcnt(5)
    v_mfma_f32_32x32x16_bf16 v[32:47], v[120:123], a[184:187], v[32:47]
    ds_read_b128 v[112:115], v1 offset:20480
    s_waitcnt lgkmcnt(5)
    v_mfma_f32_32x32x16_bf16 v[32:47], v[124:127], a[188:191], v[32:47]
    ds_read_b128 v[116:119], v1 offset:21504
    s_add_u32 m0, s54, 0
    s_xor_b32 s36, s41, 24576
    buffer_load_dwordx4 v1, s[4:7], s36 offen offset:1024 sc1 lds
    s_waitcnt lgkmcnt(5)
    v_mfma_f32_32x32x16_bf16 v[32:47], v[96:99], a[192:195], v[32:47]
    ds_read_b128 v[120:123], v1 offset:22528
    s_waitcnt lgkmcnt(5)
    v_mfma_f32_32x32x16_bf16 v[32:47], v[100:103], a[196:199], v[32:47]
    ds_read_b128 v[124:127], v1 offset:23552
    s_waitcnt lgkmcnt(5)
    v_mfma_f32_32x32x16_bf16 v[32:47], v[104:107], a[200:203], v[32:47]
    s_waitcnt vmcnt(11)
    s_barrier
    ds_read_b128 v[96:99], v1 offset:24576
    s_waitcnt lgkmcnt(5)
    v_mfma_f32_32x32x16_bf16 v[32:47], v[108:111], a[204:207], v[32:47]
    ds_read_b128 v[100:103], v1 offset:25600
    s_add_u32 m0, s54, 8192
    s_xor_b32 s36, s41, 32768
    buffer_load_dwordx4 v1, s[4:7], s36 offen offset:0 sc1 lds
    s_waitcnt lgkmcnt(5)
    v_mfma_f32_32x32x16_bf16 v[32:47], v[112:115], a[208:211], v[32:47]
    ds_read_b128 v[104:107], v1 offset:26624
    s_waitcnt lgkmcnt(5)
    v_mfma_f32_32x32x16_bf16 v[32:47], v[116:119], a[212:215], v[32:47]
    ds_read_b128 v[108:111], v1 offset:27648
    s_waitcnt lgkmcnt(5)
    v_mfma_f32_32x32x16_bf16 v[32:47], v[120:123], a[216:219], v[32:47]
    ds_read_b128 v[112:115], v1 offset:28672
    s_waitcnt lgkmcnt(5)
    v_mfma_f32_32x32x16_bf16 v[32:47], v[124:127], a[220:223], v[32:47]
    ds_read_b128 v[116:119], v1 offset:29696
    s_add_u32 m0, s54, 8192
    s_xor_b32 s36, s41, 32768
    buffer_load_dwordx4 v1, s[4:7], s36 offen offset:1024 sc1 lds
    s_waitcnt lgkmcnt(5)
    v_mfma_f32_32x32x16_bf16 v[32:47], v[96:99], a[224:227], v[32:47]
    ds_read_b128 v[120:123], v1 offset:30720
    s_waitcnt lgkmcnt(5)
    v_mfma_f32_32x32x16_bf16 v[32:47], v[100:103], a[228:231], v[32:47]
    ds_read_b128 v[124:127], v1 offset:31744
    s_waitcnt lgkmcnt(5)
    v_mfma_f32_32x32x16_bf16 v[32:47], v[104:107], a[232:235], v[32:47]
    s_waitcnt vmcnt(9)
    s_barrier
    ds_read_b128 v[96:99], v1 offset:32768
    s_waitcnt lgkmcnt(5)
    v_mfma_f32_32x32x16_bf16 v[32:47], v[108:111], a[236:239], v[32:47]
    ds_read_b128 v[100:103], v1 offset:33792
    s_add_u32 m0, s54, 16384
    s_xor_b32 s36, s41, 40960
    buffer_load_dwordx4 v1, s[4:7], s36 offen offset:0 sc1 lds
    s_waitcnt lgkmcnt(5)
    v_mfma_f32_32x32x16_bf16 v[32:47], v[112:115], a[240:243], v[32:47]
    ds_read_b128 v[104:107], v1 offset:34816
    s_waitcnt lgkmcnt(5)
    v_mfma_f32_32x32x16_bf16 v[32:47], v[116:119], a[244:247], v[32:47]
    ds_read_b128 v[108:111], v1 offset:35840
    s_waitcnt lgkmcnt(5)
    v_mfma_f32_32x32x16_bf16 v[32:47], v[120:123], a[248:251], v[32:47]
    ds_read_b128 v[112:115], v1 offset:36864
    s_waitcnt lgkmcnt(5)
    v_mfma_f32_32x32x16_bf16 v[32:47], v[124:127], a[252:255], v[32:47]
    ds_read_b128 v[116:119], v1 offset:37888
    s_add_u32 m0, s54, 16384
    s_xor_b32 s36, s41, 40960
    buffer_load_dwordx4 v1, s[4:7], s36 offen offset:1024 sc1 lds
    s_waitcnt lgkmcnt(5)
    v_mfma_f32_32x32x16_bf16 v[48:63], v[96:99], a[0:3], 0
    ds_read_b128 v[120:123], v1 offset:38912
    s_waitcnt lgkmcnt(5)
    v_mfma_f32_32x32x16_bf16 v[48:63], v[100:103], a[4:7], v[48:63]
    ds_read_b128 v[124:127], v1 offset:39936
    s_nop 1
    v_cvt_pk_bf16_f32 v128, v32, v33
    v_cvt_pk_bf16_f32 v129, v34, v35
    v_cvt_pk_bf16_f32 v130, v36, v37
    v_cvt_pk_bf16_f32 v132, v38, v39
    s_waitcnt lgkmcnt(5)
    v_mfma_f32_32x32x16_bf16 v[48:63], v[104:107], a[8:11], v[48:63]
    s_waitcnt vmcnt(9)
    s_barrier
    ds_read_b128 v[96:99], v1 offset:40960
    v_cvt_pk_bf16_f32 v133, v40, v41
    v_cvt_pk_bf16_f32 v134, v42, v43
    s_waitcnt lgkmcnt(5)
    v_mfma_f32_32x32x16_bf16 v[48:63], v[108:111], a[12:15], v[48:63]
    ds_read_b128 v[100:103], v1 offset:41984
    s_add_u32 m0, s54, 24576
    s_xor_b32 s36, s41, 49152
    buffer_load_dwordx4 v1, s[4:7], s36 offen offset:0 sc1 lds
    v_cvt_pk_bf16_f32 v136, v44, v45
    s_waitcnt lgkmcnt(5)
    v_mfma_f32_32x32x16_bf16 v[48:63], v[112:115], a[16:19], v[48:63]
    ds_read_b128 v[104:107], v1 offset:43008
    v_cvt_pk_bf16_f32 v137, v46, v47
    s_waitcnt lgkmcnt(5)
    v_mfma_f32_32x32x16_bf16 v[48:63], v[116:119], a[20:23], v[48:63]
    ds_read_b128 v[108:111], v1 offset:44032
    buffer_store_dwordx4 v[128:131], v1, s[4:7], s44 offen offset:0 sc1
    s_waitcnt lgkmcnt(5)
    v_mfma_f32_32x32x16_bf16 v[48:63], v[120:123], a[24:27], v[48:63]
    ds_read_b128 v[112:115], v1 offset:45056
    s_waitcnt lgkmcnt(5)
    v_mfma_f32_32x32x16_bf16 v[48:63], v[124:127], a[28:31], v[48:63]
    ds_read_b128 v[116:119], v1 offset:46080
    s_add_u32 m0, s54, 24576
    s_xor_b32 s36, s41, 49152
    buffer_load_dwordx4 v1, s[4:7], s36 offen offset:1024 sc1 lds
    s_waitcnt lgkmcnt(5)
    v_mfma_f32_32x32x16_bf16 v[48:63], v[96:99], a[32:35], v[48:63]
    ds_read_b128 v[120:123], v1 offset:47104
    s_waitcnt lgkmcnt(5)
    v_mfma_f32_32x32x16_bf16 v[48:63], v[100:103], a[36:39], v[48:63]
    ds_read_b128 v[124:127], v1 offset:48128
    buffer_store_dwordx4 v[132:135], v1, s[4:7], s44 offen offset:1024 sc1
    s_waitcnt lgkmcnt(5)
    v_mfma_f32_32x32x16_bf16 v[48:63], v[104:107], a[40:43], v[48:63]
    s_waitcnt vmcnt(10)
    s_barrier
    ds_read_b128 v[96:99], v1 offset:49152
    s_waitcnt lgkmcnt(5)
    v_mfma_f32_32x32x16_bf16 v[48:63], v[108:111], a[44:47], v[48:63]
    ds_read_b128 v[100:103], v1 offset:50176
    s_add_u32 m0, s54, 32768
    s_xor_b32 s36, s41, 57344
    buffer_load_dwordx4 v1, s[4:7], s36 offen offset:0 sc1 lds
    s_waitcnt lgkmcnt(5)
    v_mfma_f32_32x32x16_bf16 v[48:63], v[112:115], a[48:51], v[48:63]
    ds_read_b128 v[104:107], v1 offset:51200
    s_waitcnt lgkmcnt(5)
    v_mfma_f32_32x32x16_bf16 v[48:63], v[116:119], a[52:55], v[48:63]
    ds_read_b128 v[108:111], v1 offset:52224
    s_waitcnt lgkmcnt(5)
    v_mfma_f32_32x32x16_bf16 v[48:63], v[120:123], a[56:59], v[48:63]
    ds_read_b128 v[112:115], v1 offset:53248
    buffer_store_dwordx4 v[136:139], v1, s[4:7], s44 offen offset:2048 sc1
    s_waitcnt lgkmcnt(5)
    v_mfma_f32_32x32x16_bf16 v[48:63], v[124:127], a[60:63], v[48:63]
    ds_read_b128 v[116:119], v1 offset:54272
    s_add_u32 m0, s54, 32768
    s_xor_b32 s36, s41, 57344
    buffer_load_dwordx4 v1, s[4:7], s36 offen offset:1024 sc1 lds
    s_waitcnt lgkmcnt(5)
    v_mfma_f32_32x32x16_bf16 v[48:63], v[96:99], a[64:67], v[48:63]
    ds_read_b128 v[120:123], v1 offset:55296
    s_waitcnt lgkmcnt(5)
    v_mfma_f32_32x32x16_bf16 v[48:63], v[100:103], a[68:71], v[48:63]
    ds_read_b128 v[124:127], v1 offset:56320
    s_waitcnt lgkmcnt(5)
    v_mfma_f32_32x32x16_bf16 v[48:63], v[104:107], a[72:75], v[48:63]
    s_waitcnt vmcnt(11)
    s_barrier
    ds_read_b128 v[96:99], v1 offset:0
    s_waitcnt lgkmcnt(5)
    v_mfma_f32_32x32x16_bf16 v[48:63], v[108:111], a[76:79], v[48:63]
    ds_read_b128 v[100:103], v1 offset:1024
    s_add_u32 m0, s54, 40960
    s_xor_b32 s36, s42, 0
    buffer_load_dwordx4 v1, s[4:7], s36 offen offset:0 sc1 lds
    s_waitcnt lgkmcnt(5)
    v_mfma_f32_32x32x16_bf16 v[48:63], v[112:115], a[80:83], v[48:63]
    ds_read_b128 v[104:107], v1 offset:2048
    s_waitcnt lgkmcnt(5)
    v_mfma_f32_32x32x16_bf16 v[48:63], v[116:119], a[84:87], v[48:63]
    ds_read_b128 v[108:111], v1 offset:3072
    s_add_u32 s36, s54, 25694208
    buffer_load_dwordx4 v[140:143], v1, s[4:7], s36 offen offset:0 sc1
    s_waitcnt lgkmcnt(5)
    v_mfma_f32_32x32x16_bf16 v[48:63], v[120:123], a[88:91], v[48:63]
    ds_read_b128 v[112:115], v1 offset:4096
    s_waitcnt lgkmcnt(5)
    v_mfma_f32_32x32x16_bf16 v[48:63], v[124:127], a[92:95], v[48:63]
    ds_read_b128 v[116:119], v1 offset:5120
    s_add_u32 m0, s54, 40960
    s_xor_b32 s36, s42, 0
    buffer_load_dwordx4 v1, s[4:7], s36 offen offset:1024 sc1 lds
    s_waitcnt lgkmcnt(5)
    v_mfma_f32_32x32x16_bf16 v[48:63], v[96:99], a[96:99], v[48:63]
    ds_read_b128 v[120:123], v1 offset:6144
    s_waitcnt lgkmcnt(5)
    v_mfma_f32_32x32x16_bf16 v[48:63], v[100:103], a[100:103], v[48:63]
    ds_read_b128 v[124:127], v1 offset:7168
    s_add_u32 s36, s54, 25694208
    buffer_load_dwordx4 v[156:159], v1, s[4:7], s36 offen offset:1024 sc1
    s_waitcnt lgkmcnt(5)
    v_mfma_f32_32x32x16_bf16 v[48:63], v[104:107], a[104:107], v[48:63]
    s_waitcnt vmcnt(13)
    s_barrier
    ds_read_b128 v[96:99], v1 offset:8192
    s_waitcnt lgkmcnt(5)
    v_mfma_f32_32x32x16_bf16 v[48:63], v[108:111], a[108:111], v[48:63]
    ds_read_b128 v[100:103], v1 offset:9216
    s_add_u32 m0, s54, 49152
    s_xor_b32 s36, s42, 8192
    buffer_load_dwordx4 v1, s[4:7], s36 offen offset:0 sc1 lds
    s_waitcnt lgkmcnt(5)
    v_mfma_f32_32x32x16_bf16 v[48:63], v[112:115], a[112:115], v[48:63]
    ds_read_b128 v[104:107], v1 offset:10240
    s_waitcnt lgkmcnt(5)
    v_mfma_f32_32x32x16_bf16 v[48:63], v[116:119], a[116:119], v[48:63]
    ds_read_b128 v[108:111], v1 offset:11264
    s_waitcnt lgkmcnt(5)
    v_mfma_f32_32x32x16_bf16 v[48:63], v[120:123], a[120:123], v[48:63]
    ds_read_b128 v[112:115], v1 offset:12288
    s_add_u32 s36, s54, 25706496
    buffer_load_dwordx4 v[144:147], v1, s[4:7], s36 offen offset:0 sc1
    s_waitcnt lgkmcnt(5)
    v_mfma_f32_32x32x16_bf16 v[48:63], v[124:127], a[124:127], v[48:63]
    ds_read_b128 v[116:119], v1 offset:13312
    s_add_u32 m0, s54, 49152
    s_xor_b32 s36, s42, 8192
    buffer_load_dwordx4 v1, s[4:7], s36 offen offset:1024 sc1 lds
    s_waitcnt lgkmcnt(5)
    v_mfma_f32_32x32x16_bf16 v[48:63], v[96:99], a[128:131], v[48:63]
    ds_read_b128 v[120:123], v1 offset:14336
    s_waitcnt lgkmcnt(5)
    v_mfma_f32_32x32x16_bf16 v[48:63], v[100:103], a[132:135], v[48:63]
    ds_read_b128 v[124:127], v1 offset:15360
    s_waitcnt lgkmcnt(5)
    v_mfma_f32_32x32x16_bf16 v[48:63], v[104:107], a[136:139], v[48:63]
    s_waitcnt vmcnt(14)
    s_barrier
    ds_read_b128 v[96:99], v1 offset:16384
    s_waitcnt lgkmcnt(5)
    v_mfma_f32_32x32x16_bf16 v[48:63], v[108:111], a[140:143], v[48:63]
    ds_read_b128 v[100:103], v1 offset:17408
    s_add_u32 m0, s54, 0
    s_xor_b32 s36, s42, 16384
    buffer_load_dwordx4 v1, s[4:7], s36 offen offset:0 sc1 lds
    s_waitcnt lgkmcnt(5)
    v_mfma_f32_32x32x16_bf16 v[48:63], v[112:115], a[144:147], v[48:63]
    ds_read_b128 v[104:107], v1 offset:18432
    s_waitcnt lgkmcnt(5)
    v_mfma_f32_32x32x16_bf16 v[48:63], v[116:119], a[148:151], v[48:63]
    ds_read_b128 v[108:111], v1 offset:19456
    s_add_u32 s36, s54, 25706496
    buffer_load_dwordx4 v[160:163], v1, s[4:7], s36 offen offset:1024 sc1
    s_waitcnt lgkmcnt(5)
    v_mfma_f32_32x32x16_bf16 v[48:63], v[120:123], a[152:155], v[48:63]
    ds_read_b128 v[112:115], v1 offset:20480
    s_waitcnt lgkmcnt(5)
    v_mfma_f32_32x32x16_bf16 v[48:63], v[124:127], a[156:159], v[48:63]
    ds_read_b128 v[116:119], v1 offset:21504
    s_add_u32 m0, s54, 0
    s_xor_b32 s36, s42, 16384
    buffer_load_dwordx4 v1, s[4:7], s36 offen offset:1024 sc1 lds
    s_waitcnt lgkmcnt(5)
    v_mfma_f32_32x32x16_bf16 v[48:63], v[96:99], a[160:163], v[48:63]
    ds_read_b128 v[120:123], v1 offset:22528
    s_waitcnt lgkmcnt(5)
    v_mfma_f32_32x32x16_bf16 v[48:63], v[100:103], a[164:167], v[48:63]
    ds_read_b128 v[124:127], v1 offset:23552
    s_add_u32 s36, s54, 25718784
    buffer_load_dwordx4 v[148:151], v1, s[4:7], s36 offen offset:0 sc1
    s_waitcnt lgkmcnt(5)
    v_mfma_f32_32x32x16_bf16 v[48:63], v[104:107], a[168:171], v[48:63]
    s_waitcnt vmcnt(15)
    s_barrier
    ds_read_b128 v[96:99], v1 offset:24576
    s_waitcnt lgkmcnt(5)
    v_mfma_f32_32x32x16_bf16 v[48:63], v[108:111], a[172:175], v[48:63]
    ds_read_b128 v[100:103], v1 offset:25600
    s_add_u32 m0, s54, 8192
    s_xor_b32 s36, s42, 24576
    buffer_load_dwordx4 v1, s[4:7], s36 offen offset:0 sc1 lds
    s_waitcnt lgkmcnt(5)
    v_mfma_f32_32x32x16_bf16 v[48:63], v[112:115], a[176:179], v[48:63]
    ds_read_b128 v[104:107], v1 offset:26624
    s_waitcnt lgkmcnt(5)
    v_mfma_f32_32x32x16_bf16 v[48:63], v[116:119], a[180:183], v[48:63]
    ds_read_b128 v[108:111], v1 offset:27648
    s_waitcnt lgkmcnt(5)
    v_mfma_f32_32x32x16_bf16 v[48:63], v[120:123], a[184:187], v[48:63]
    ds_read_b128 v[112:115], v1 offset:28672
    s_add_u32 s36, s54, 25718784
    buffer_load_dwordx4 v[164:167], v1, s[4:7], s36 offen offset:1024 sc1
    s_waitcnt lgkmcnt(5)
    v_mfma_f32_32x32x16_bf16 v[48:63], v[124:127], a[188:191], v[48:63]
    ds_read_b128 v[116:119], v1 offset:29696
    s_add_u32 m0, s54, 8192
    s_xor_b32 s36, s42, 24576
    buffer_load_dwordx4 v1, s[4:7], s36 offen offset:1024 sc1 lds
    s_waitcnt lgkmcnt(5)
    v_mfma_f32_32x32x16_bf16 v[48:63], v[96:99], a[192:195], v[48:63]
    ds_read_b128 v[120:123], v1 offset:30720
    s_waitcnt lgkmcnt(5)
    v_mfma_f32_32x32x16_bf16 v[48:63], v[100:103], a[196:199], v[48:63]
    ds_read_b128 v[124:127], v1 offset:31744
    s_waitcnt lgkmcnt(5)
    v_mfma_f32_32x32x16_bf16 v[48:63], v[104:107], a[200:203], v[48:63]
    s_waitcnt vmcnt(14)
    s_barrier
    ds_read_b128 v[96:99], v1 offset:32768
    s_waitcnt lgkmcnt(5)
    v_mfma_f32_32x32x16_bf16 v[48:63], v[108:111], a[204:207], v[48:63]
    ds_read_b128 v[100:103], v1 offset:33792
    s_add_u32 m0, s54, 16384
    s_xor_b32 s36, s42, 32768
    buffer_load_dwordx4 v1, s[4:7], s36 offen offset:0 sc1 lds
    s_waitcnt lgkmcnt(5)
    v_mfma_f32_32x32x16_bf16 v[48:63], v[112:115], a[208:211], v[48:63]
    ds_read_b128 v[104:107], v1 offset:34816
    s_waitcnt lgkmcnt(5)
    v_mfma_f32_32x32x16_bf16 v[48:63], v[116:119], a[212:215], v[48:63]
    ds_read_b128 v[108:111], v1 offset:35840
    s_add_u32 s36, s54, 25731072
    buffer_load_dwordx4 v[152:155], v1, s[4:7], s36 offen offset:0 sc1
    s_waitcnt lgkmcnt(5)
    v_mfma_f32_32x32x16_bf16 v[48:63], v[120:123], a[216:219], v[48:63]
    ds_read_b128 v[112:115], v1 offset:36864
    s_waitcnt lgkmcnt(5)
    v_mfma_f32_32x32x16_bf16 v[48:63], v[124:127], a[220:223], v[48:63]
    ds_read_b128 v[116:119], v1 offset:37888
    s_add_u32 m0, s54, 16384
    s_xor_b32 s36, s42, 32768
    buffer_load_dwordx4 v1, s[4:7], s36 offen offset:1024 sc1 lds
    s_waitcnt lgkmcnt(5)
    v_mfma_f32_32x32x16_bf16 v[48:63], v[96:99], a[224:227], v[48:63]
    ds_read_b128 v[120:123], v1 offset:38912
    s_waitcnt lgkmcnt(5)
    v_mfma_f32_32x32x16_bf16 v[48:63], v[100:103], a[228:231], v[48:63]
    ds_read_b128 v[124:127], v1 offset:39936
    s_waitcnt lgkmcnt(5)
    v_mfma_f32_32x32x16_bf16 v[48:63], v[104:107], a[232:235], v[48:63]
    s_waitcnt vmcnt(14)
    s_barrier
    ds_read_b128 v[96:99], v1 offset:40960
    s_waitcnt lgkmcnt(5)
    v_mfma_f32_32x32x16_bf16 v[48:63], v[108:111], a[236:239], v[48:63]
    ds_read_b128 v[100:103], v1 offset:41984
    s_add_u32 m0, s54, 24576
    s_xor_b32 s36, s42, 40960
    buffer_load_dwordx4 v1, s[4:7], s36 offen offset:0 sc1 lds
    s_waitcnt lgkmcnt(5)
    v_mfma_f32_32x32x16_bf16 v[48:63], v[112:115], a[240:243], v[48:63]
    ds_read_b128 v[104:107], v1 offset:43008
    s_waitcnt lgkmcnt(5)
    v_mfma_f32_32x32x16_bf16 v[48:63], v[116:119], a[244:247], v[48:63]
    ds_read_b128 v[108:111], v1 offset:44032
    s_add_u32 s36, s54, 25731072
    buffer_load_dwordx4 v[168:171], v1, s[4:7], s36 offen offset:1024 sc1
    s_waitcnt vmcnt(0)
    v_xor_b32 v172, v30, v143
    v_xor_b32 v173, v30, v147
    v_xor_b32 v174, v30, v151
    v_xor_b32 v175, v30, v155
    v_xor_b32 v176, v30, v159
    v_xor_b32 v177, v30, v163
    v_xor_b32 v178, v30, v167
    v_xor_b32 v179, v30, v171
    v_or3_b32 v172, v172, v173, v174
    v_or3_b32 v175, v175, v176, v177
    v_or3_b32 v172, v172, v178, v179
    v_or_b32 v172, v172, v175
    v_cmp_ne_u32 vcc, 0, v172
    s_nop 3
    s_cbranch_vccnz LM_10
LMD_11:
    s_mov_b32 s60, 0x04000c0c
    s_mov_b32 s61, 0x0706000c
    s_cmp_eq_u32 s3, 2
    s_cselect_b32 s62, 1.0, 0
    s_lshl_b32 s63, s3, 10
    s_add_u32 s63, s63, 57344
    s_waitcnt lgkmcnt(5)
    v_mfma_f32_32x32x16_bf16 v[48:63], v[120:123], a[248:251], v[48:63]
    ds_read_b128 v[112:115], v1 offset:45056
    v_perm_b32 v172, v142, v141, s60
    v_perm_b32 v173, v146, v145, s60
    v_perm_b32 v174, v150, v149, s60
    v_perm_b32 v175, v154, v153, s60
    s_waitcnt lgkmcnt(5)
    v_mfma_f32_32x32x16_bf16 v[48:63], v[124:127], a[252:255], v[48:63]
    ds_read_b128 v[116:119], v1 offset:46080
    s_add_u32 m0, s54, 24576
    s_xor_b32 s36, s42, 40960
    buffer_load_dwordx4 v1, s[4:7], s36 offen offset:1024 sc1 lds
    v_perm_b32 v143, v172, v140, s61
    s_waitcnt lgkmcnt(5)
    v_mfma_f32_32x32x16_bf16 v[64:79], v[96:99], a[0:3], 0
    ds_read_b128 v[120:123], v1 offset:47104
    v_perm_b32 v147, v173, v144, s61
    v_perm_b32 v151, v174, v148, s61
    v_perm_b32 v155, v175, v152, s61
    v_add_f32 v140, v140, v144
    s_waitcnt lgkmcnt(5)
    v_mfma_f32_32x32x16_bf16 v[64:79], v[100:103], a[4:7], v[64:79]
    ds_read_b128 v[124:127], v1 offset:48128
    s_xor_b32 m0, s53, 2048
    s_xor_b32 s36, s52, 2
    s_mul_i32 s36, s36, 44032
    buffer_load_dwordx4 v14, s[16:19], s36 offen lds
    v_cvt_pk_bf16_f32 v128, v48, v49
    s_waitcnt lgkmcnt(5)
    v_mfma_f32_32x32x16_bf16 v[64:79], v[104:107], a[8:11], v[64:79]
    s_barrier
    ds_read_b128 v[96:99], v1 offset:49152
    v_cvt_pk_bf16_f32 v129, v50, v51
    v_cvt_pk_bf16_f32 v130, v52, v53
    s_waitcnt lgkmcnt(5)
    v_mfma_f32_32x32x16_bf16 v[64:79], v[108:111], a[12:15], v[64:79]
    ds_read_b128 v[100:103], v1 offset:50176
    s_add_u32 m0, s54, 32768
    s_xor_b32 s36, s42, 49152
    buffer_load_dwordx4 v1, s[4:7], s36 offen offset:0 sc1 lds
    v_cvt_pk_bf16_f32 v132, v54, v55
    s_waitcnt lgkmcnt(5)
    v_mfma_f32_32x32x16_bf16 v[64:79], v[112:115], a[16:19], v[64:79]
    ds_read_b128 v[104:107], v1 offset:51200
    v_cvt_pk_bf16_f32 v133, v56, v57
    v_cvt_pk_bf16_f32 v134, v58, v59
    v_cvt_pk_bf16_f32 v136, v60, v61
    v_cvt_pk_bf16_f32 v137, v62, v63
    s_waitcnt lgkmcnt(5)
    v_mfma_f32_32x32x16_bf16 v[64:79], v[116:119], a[20:23], v[64:79]
    ds_read_b128 v[108:111], v1 offset:52224
    v_add_f32 v141, v141, v145
    v_add_f32 v142, v142, v146
    v_add_f32 v143, v143, v147
    v_add_f32 v148, v148, v152
    s_waitcnt lgkmcnt(5)
    v_mfma_f32_32x32x16_bf16 v[64:79], v[120:123], a[24:27], v[64:79]
    ds_read_b128 v[112:115], v1 offset:53248
    buffer_store_dwordx4 v[128:131], v1, s[4:7], s45 offen offset:0 sc1
    v_add_f32 v149, v149, v153
    s_waitcnt lgkmcnt(5)
    v_mfma_f32_32x32x16_bf16 v[64:79], v[124:127], a[28:31], v[64:79]
    ds_read_b128 v[116:119], v1 offset:54272
    s_add_u32 m0, s54, 32768
    s_xor_b32 s36, s42, 49152
    buffer_load_dwordx4 v1, s[4:7], s36 offen offset:1024 sc1 lds
    v_add_f32 v150, v150, v154
    s_waitcnt lgkmcnt(5)
    v_mfma_f32_32x32x16_bf16 v[64:79], v[96:99], a[32:35], v[64:79]
    ds_read_b128 v[120:123], v1 offset:55296
    v_add_f32 v151, v151, v155
    v_add_f32 v140, v140, v148
    v_add_f32 v141, v141, v149
    v_add_f32 v142, v142, v150
    s_waitcnt lgkmcnt(5)
    v_mfma_f32_32x32x16_bf16 v[64:79], v[100:103], a[36:39], v[64:79]
    ds_read_b128 v[124:127], v1 offset:56320
    v_add_f32 v143, v143, v151
    v_cvt_pk_bf16_f32 v144, v140, v141
    v_cvt_pk_bf16_f32 v145, v142, v143
    v_lshlrev_b32 v140, 16, v144
    s_waitcnt lgkmcnt(5)
    v_mfma_f32_32x32x16_bf16 v[64:79], v[104:107], a[40:43], v[64:79]
    s_barrier
    ds_read_b128 v[96:99], v1 offset:0
    v_and_b32 v141, 0xffff0000, v144
    v_lshlrev_b32 v142, 16, v145
    s_waitcnt lgkmcnt(5)
    v_mfma_f32_32x32x16_bf16 v[64:79], v[108:111], a[44:47], v[64:79]
    ds_read_b128 v[100:103], v1 offset:1024
    s_add_u32 m0, s54, 40960
    s_xor_b32 s36, s42, 57344
    buffer_load_dwordx4 v1, s[4:7], s36 offen offset:0 sc1 lds
    v_and_b32 v143, 0xffff0000, v145
    s_waitcnt lgkmcnt(5)
    v_mfma_f32_32x32x16_bf16 v[64:79], v[112:115], a[48:51], v[64:79]
    ds_read_b128 v[104:107], v1 offset:2048
    v_add_f32 v140, s62, v140
    v_add_f32 v141, s62, v141
    v_add_f32 v142, s62, v142
    v_add_f32 v143, s62, v143
    s_waitcnt lgkmcnt(5)
    v_mfma_f32_32x32x16_bf16 v[64:79], v[116:119], a[52:55], v[64:79]
    ds_read_b128 v[108:111], v1 offset:3072
    buffer_store_dwordx4 v[132:135], v1, s[4:7], s45 offen offset:1024 sc1
    v_cvt_pk_bf16_f32 v144, v140, v141
    s_waitcnt lgkmcnt(5)
    v_mfma_f32_32x32x16_bf16 v[64:79], v[120:123], a[56:59], v[64:79]
    ds_read_b128 v[112:115], v1 offset:4096
    v_cvt_pk_bf16_f32 v145, v142, v143
    v_lshl_add_u32 v176, v0, 3, s63
    ds_write_b64 v176, v[144:145] offset:0
    v_perm_b32 v172, v158, v157, s60
    s_waitcnt lgkmcnt(6)
    v_mfma_f32_32x32x16_bf16 v[64:79], v[124:127], a[60:63], v[64:79]
    ds_read_b128 v[116:119], v1 offset:5120
    s_add_u32 m0, s54, 40960
    s_xor_b32 s36, s42, 57344
    buffer_load_dwordx4 v1, s[4:7], s36 offen offset:1024 sc1 lds
    v_perm_b32 v173, v162, v161, s60
    s_waitcnt lgkmcnt(6)
    v_mfma_f32_32x32x16_bf16 v[64:79], v[96:99], a[64:67], v[64:79]
    ds_read_b128 v[120:123], v1 offset:6144
    v_perm_b32 v174, v166, v165, s60
    v_perm_b32 v175, v170, v169, s60
    v_perm_b32 v159, v172, v156, s61
    v_perm_b32 v163, v173, v160, s61
    s_waitcnt lgkmcnt(6)
    v_mfma_f32_32x32x16_bf16 v[64:79], v[100:103], a[68:71], v[64:79]
    ds_read_b128 v[124:127], v1 offset:7168
    buffer_store_dwordx4 v[136:139], v1, s[4:7], s45 offen offset:2048 sc1
    v_perm_b32 v167, v174, v164, s61
    s_waitcnt lgkmcnt(6)
    v_mfma_f32_32x32x16_bf16 v[64:79], v[104:107], a[72:75], v[64:79]
    s_waitcnt lgkmcnt(3)
    s_barrier
    ds_read_b128 v[96:99], v1 offset:8192
    v_perm_b32 v171, v175, v168, s61
    v_add_f32 v156, v156, v160
    v_mfma_f32_32x32x16_bf16 v[64:79], v[108:111], a[76:79], v[64:79]
    ds_read_b128 v[100:103], v1 offset:9216
    s_add_u32 m0, s54, 49152
    s_xor_b32 s36, s43, 0
    buffer_load_dwordx4 v1, s[4:7], s36 offen offset:0 sc1 lds
    v_add_f32 v157, v157, v161
    v_mfma_f32_32x32x16_bf16 v[64:79], v[112:115], a[80:83], v[64:79]
    ds_read_b128 v[104:107], v1 offset:10240
    v_add_f32 v158, v158, v162
    v_add_f32 v159, v159, v163
    v_add_f32 v164, v164, v168
    v_add_f32 v165, v165, v169
    s_waitcnt lgkmcnt(5)
    v_mfma_f32_32x32x16_bf16 v[64:79], v[116:119], a[84:87], v[64:79]
    ds_read_b128 v[108:111], v1 offset:11264
    v_add_f32 v166, v166, v170
    v_add_f32 v167, v167, v171
    v_add_f32 v156, v156, v164
    v_add_f32 v157, v157, v165
    s_waitcnt lgkmcnt(5)
    v_mfma_f32_32x32x16_bf16 v[64:79], v[120:123], a[88:91], v[64:79]
    ds_read_b128 v[112:115], v1 offset:12288
    s_xor_b32 m0, s53, 34816
    s_xor_b32 s36, s52, 2
    s_mul_i32 s36, s36, 44032
    buffer_load_dwordx4 v15, s[16:19], s36 offen lds
    v_add_f32 v158, v158, v166
    s_waitcnt lgkmcnt(5)
    v_mfma_f32_32x32x16_bf16 v[64:79], v[124:127], a[92:95], v[64:79]
    ds_read_b128 v[116:119], v1 offset:13312
    s_add_u32 m0, s54, 49152
    s_xor_b32 s36, s43, 0
    buffer_load_dwordx4 v1, s[4:7], s36 offen offset:1024 sc1 lds
    v_add_f32 v159, v159, v167
    s_waitcnt lgkmcnt(5)
    v_mfma_f32_32x32x16_bf16 v[64:79], v[96:99], a[96:99], v[64:79]
    ds_read_b128 v[120:123], v1 offset:14336
    v_cvt_pk_bf16_f32 v160, v156, v157
    v_cvt_pk_bf16_f32 v161, v158, v159
    v_lshlrev_b32 v156, 16, v160
    v_and_b32 v157, 0xffff0000, v160
    s_waitcnt lgkmcnt(5)
    v_mfma_f32_32x32x16_bf16 v[64:79], v[100:103], a[100:103], v[64:79]
    ds_read_b128 v[124:127], v1 offset:15360
    v_lshlrev_b32 v158, 16, v161
    v_and_b32 v159, 0xffff0000, v161
    v_add_f32 v156, s62, v156
    v_add_f32 v157, s62, v157
    s_waitcnt lgkmcnt(5)
    v_mfma_f32_32x32x16_bf16 v[64:79], v[104:107], a[104:107], v[64:79]
    s_barrier
    ds_read_b128 v[96:99], v1 offset:16384
    v_add_f32 v158, s62, v158
    v_add_f32 v159, s62, v159
    s_waitcnt lgkmcnt(5)
    v_mfma_f32_32x32x16_bf16 v[64:79], v[108:111], a[108:111], v[64:79]
    ds_read_b128 v[100:103], v1 offset:17408
    s_add_u32 m0, s54, 0
    s_xor_b32 s36, s43, 8192
    buffer_load_dwordx4 v1, s[4:7], s36 offen offset:0 sc1 lds
    v_cvt_pk_bf16_f32 v160, v156, v157
    s_waitcnt lgkmcnt(5)
    v_mfma_f32_32x32x16_bf16 v[64:79], v[112:115], a[112:115], v[64:79]
    ds_read_b128 v[104:107], v1 offset:18432
    v_cvt_pk_bf16_f32 v161, v158, v159
    ds_write_b64 v176, v[160:161] offset:512
    s_waitcnt lgkmcnt(6)
    v_mfma_f32_32x32x16_bf16 v[64:79], v[116:119], a[116:119], v[64:79]
    ds_read_b128 v[108:111], v1 offset:19456
    s_xor_b32 m0, s53, 198656
    s_xor_b32 s36, s52, 2
    s_mul_i32 s36, s36, 44032
    buffer_load_dwordx4 v16, s[16:19], s36 offen lds
    s_waitcnt lgkmcnt(6)
    v_mfma_f32_32x32x16_bf16 v[64:79], v[120:123], a[120:123], v[64:79]
    ds_read_b128 v[112:115], v1 offset:20480
    s_waitcnt lgkmcnt(6)
    v_mfma_f32_32x32x16_bf16 v[64:79], v[124:127], a[124:127], v[64:79]
    ds_read_b128 v[116:119], v1 offset:21504
    s_add_u32 m0, s54, 0
    s_xor_b32 s36, s43, 8192
    buffer_load_dwordx4 v1, s[4:7], s36 offen offset:1024 sc1 lds
    s_waitcnt lgkmcnt(6)
    v_mfma_f32_32x32x16_bf16 v[64:79], v[96:99], a[128:131], v[64:79]
    ds_read_b128 v[120:123], v1 offset:22528
    s_waitcnt lgkmcnt(6)
    v_mfma_f32_32x32x16_bf16 v[64:79], v[100:103], a[132:135], v[64:79]
    ds_read_b128 v[124:127], v1 offset:23552
    s_add_u32 s36, s47, 0
    buffer_load_dwordx4 v[140:143], v1, s[4:7], s36 offen offset:0 sc1
    s_waitcnt lgkmcnt(6)
    v_mfma_f32_32x32x16_bf16 v[64:79], v[104:107], a[136:139], v[64:79]
    s_waitcnt vmcnt(15) lgkmcnt(5)
    s_barrier
    ds_read_b128 v[96:99], v1 offset:24576
    ds_read_b128 v[236:239], v8 offset:0
    ds_read_b128 v[240:243], v8 offset:32
    s_waitcnt lgkmcnt(7)
    v_mfma_f32_32x32x16_bf16 v[64:79], v[108:111], a[140:143], v[64:79]
    ds_read_b128 v[100:103], v1 offset:25600
    s_add_u32 m0, s54, 8192
    s_xor_b32 s36, s43, 16384
    buffer_load_dwordx4 v1, s[4:7], s36 offen offset:0 sc1 lds
    ds_read_b128 v[244:247], v8 offset:2048
    s_waitcnt lgkmcnt(8)
    v_mfma_f32_32x32x16_bf16 v[64:79], v[112:115], a[144:147], v[64:79]
    ds_read_b128 v[104:107], v1 offset:26624
    ds_read_b128 v[248:251], v8 offset:2080
    s_nop 0
    s_nop 0
    s_nop 0
    s_waitcnt lgkmcnt(9)
    v_mfma_f32_32x32x16_bf16 v[64:79], v[116:119], a[148:151], v[64:79]
    ds_read_b128 v[108:111], v1 offset:27648
    s_nop 0
    s_nop 0
    s_nop 0
    s_waitcnt lgkmcnt(1)
    v_mfma_f32_32x32x16_bf16 v[64:79], v[120:123], a[152:155], v[64:79]
    ds_read_b128 v[112:115], v1 offset:28672
    s_add_u32 s36, s47, 0
    buffer_load_dwordx4 v[144:147], v1, s[4:7], s36 offen offset:1024 sc1
    v_lshlrev_b32 v188, 16, v236
    v_mfma_f32_32x32x16_bf16 v[64:79], v[124:127], a[156:159], v[64:79]
    ds_read_b128 v[116:119], v1 offset:29696
    s_add_u32 m0, s54, 8192
    s_xor_b32 s36, s43, 16384
    buffer_load_dwordx4 v1, s[4:7], s36 offen offset:1024 sc1 lds
    v_and_b32 v189, 0xffff0000, v236
    v_mfma_f32_32x32x16_bf16 v[64:79], v[96:99], a[160:163], v[64:79]
    ds_read_b128 v[120:123], v1 offset:30720
    v_lshlrev_b32 v190, 16, v237
    v_and_b32 v191, 0xffff0000, v237
    v_lshlrev_b32 v192, 16, v238
    v_and_b32 v193, 0xffff0000, v238
    v_mfma_f32_32x32x16_bf16 v[64:79], v[100:103], a[164:167], v[64:79]
    ds_read_b128 v[124:127], v1 offset:31744
    v_lshlrev_b32 v194, 16, v239
    v_and_b32 v195, 0xffff0000, v239
    v_lshlrev_b32 v196, 16, v240
    v_and_b32 v197, 0xffff0000, v240
    v_mfma_f32_32x32x16_bf16 v[64:79], v[104:107], a[168:171], v[64:79]
    s_waitcnt vmcnt(14)
    s_barrier
    ds_read_b128 v[96:99], v1 offset:32768
    v_lshlrev_b32 v198, 16, v241
    v_and_b32 v199, 0xffff0000, v241
    s_waitcnt lgkmcnt(5)
    v_mfma_f32_32x32x16_bf16 v[64:79], v[108:111], a[172:175], v[64:79]
    ds_read_b128 v[100:103], v1 offset:33792
    s_add_u32 m0, s54, 16384
    s_xor_b32 s36, s43, 24576
    buffer_load_dwordx4 v1, s[4:7], s36 offen offset:0 sc1 lds
    v_lshlrev_b32 v200, 16, v242
    s_waitcnt lgkmcnt(5)
    v_mfma_f32_32x32x16_bf16 v[64:79], v[112:115], a[176:179], v[64:79]
    ds_read_b128 v[104:107], v1 offset:34816
    v_and_b32 v201, 0xffff0000, v242
    v_lshlrev_b32 v202, 16, v243
    v_and_b32 v203, 0xffff0000, v243
    v_lshlrev_b32 v204, 16, v244
    s_waitcnt lgkmcnt(5)
    v_mfma_f32_32x32x16_bf16 v[64:79], v[116:119], a[180:183], v[64:79]
    ds_read_b128 v[108:111], v1 offset:35840
    s_add_u32 s36, s47, 0
    buffer_load_dwordx4 v[148:151], v1, s[4:7], s36 offen offset:2048 sc1
    v_and_b32 v205, 0xffff0000, v244
    s_waitcnt lgkmcnt(5)
    v_mfma_f32_32x32x16_bf16 v[64:79], v[120:123], a[184:187], v[64:79]
    ds_read_b128 v[112:115], v1 offset:36864
    v_lshlrev_b32 v206, 16, v245
    v_and_b32 v207, 0xffff0000, v245
    v_lshlrev_b32 v208, 16, v246
    v_and_b32 v209, 0xffff0000, v246
    s_waitcnt lgkmcnt(5)
    v_mfma_f32_32x32x16_bf16 v[64:79], v[124:127], a[188:191], v[64:79]
    ds_read_b128 v[116:119], v1 offset:37888
    s_add_u32 m0, s54, 16384
    s_xor_b32 s36, s43, 24576
    buffer_load_dwordx4 v1, s[4:7], s36 offen offset:1024 sc1 lds
    v_lshlrev_b32 v210, 16, v247
    s_waitcnt lgkmcnt(5)
    v_mfma_f32_32x32x16_bf16 v[64:79], v[96:99], a[192:195], v[64:79]
    ds_read_b128 v[120:123], v1 offset:38912
    v_and_b32 v211, 0xffff0000, v247
    v_lshlrev_b32 v212, 16, v248
    v_and_b32 v213, 0xffff0000, v248
    v_lshlrev_b32 v214, 16, v249
    s_waitcnt lgkmcnt(5)
    v_mfma_f32_32x32x16_bf16 v[64:79], v[100:103], a[196:199], v[64:79]
    ds_read_b128 v[124:127], v1 offset:39936
    v_and_b32 v215, 0xffff0000, v249
    v_lshlrev_b32 v216, 16, v250
    v_and_b32 v217, 0xffff0000, v250
    v_lshlrev_b32 v218, 16, v251
    s_waitcnt lgkmcnt(5)
    v_mfma_f32_32x32x16_bf16 v[64:79], v[104:107], a[200:203], v[64:79]
    s_waitcnt vmcnt(14)
    s_barrier
    ds_read_b128 v[96:99], v1 offset:40960
    v_and_b32 v219, 0xffff0000, v251
    s_waitcnt lgkmcnt(5)
    v_mfma_f32_32x32x16_bf16 v[64:79], v[108:111], a[204:207], v[64:79]
    ds_read_b128 v[100:103], v1 offset:41984
    s_add_u32 m0, s54, 24576
    s_xor_b32 s36, s43, 32768
    buffer_load_dwordx4 v1, s[4:7], s36 offen offset:0 sc1 lds
    v_lshlrev_b32 v220, 16, v180
    s_waitcnt lgkmcnt(5)
    v_mfma_f32_32x32x16_bf16 v[64:79], v[112:115], a[208:211], v[64:79]
    ds_read_b128 v[104:107], v1 offset:43008
    v_and_b32 v221, 0xffff0000, v180
    v_lshlrev_b32 v222, 16, v181
    v_and_b32 v223, 0xffff0000, v181
    v_lshlrev_b32 v224, 16, v182
    s_waitcnt lgkmcnt(5)
    v_mfma_f32_32x32x16_bf16 v[64:79], v[116:119], a[212:215], v[64:79]
    ds_read_b128 v[108:111], v1 offset:44032
    s_add_u32 s36, s47, 3072
    buffer_load_dwordx4 v[152:155], v1, s[4:7], s36 offen offset:0 sc1
    v_and_b32 v225, 0xffff0000, v182
    s_waitcnt lgkmcnt(5)
    v_mfma_f32_32x32x16_bf16 v[64:79], v[120:123], a[216:219], v[64:79]
    ds_read_b128 v[112:115], v1 offset:45056
    v_lshlrev_b32 v226, 16, v183
    v_and_b32 v227, 0xffff0000, v183
    v_lshlrev_b32 v228, 16, v184
    v_and_b32 v229, 0xffff0000, v184
    s_waitcnt lgkmcnt(5)
    v_mfma_f32_32x32x16_bf16 v[64:79], v[124:127], a[220:223], v[64:79]
    ds_read_b128 v[116:119], v1 offset:46080
    s_add_u32 m0, s54, 24576
    s_xor_b32 s36, s43, 32768
    buffer_load_dwordx4 v1, s[4:7], s36 offen offset:1024 sc1 lds
    v_lshlrev_b32 v230, 16, v185
    s_waitcnt lgkmcnt(5)
    v_mfma_f32_32x32x16_bf16 v[64:79], v[96:99], a[224:227], v[64:79]
    ds_read_b128 v[120:123], v1 offset:47104
    v_and_b32 v231, 0xffff0000, v185
    v_lshlrev_b32 v232, 16, v186
    v_and_b32 v233, 0xffff0000, v186
    v_lshlrev_b32 v234, 16, v187
    s_waitcnt lgkmcnt(5)
    v_mfma_f32_32x32x16_bf16 v[64:79], v[100:103], a[228:231], v[64:79]
    ds_read_b128 v[124:127], v1 offset:48128
    s_add_u32 s36, s47, 3072
    buffer_load_dwordx4 v[156:159], v1, s[4:7], s36 offen offset:1024 sc1
    v_and_b32 v235, 0xffff0000, v187
    s_waitcnt lgkmcnt(5)
    v_mfma_f32_32x32x16_bf16 v[64:79], v[104:107], a[232:235], v[64:79]
    s_waitcnt vmcnt(14)
    s_barrier
    ds_read_b128 v[96:99], v1 offset:49152
    s_waitcnt lgkmcnt(5)
    v_mfma_f32_32x32x16_bf16 v[64:79], v[108:111], a[236:239], v[64:79]
    ds_read_b128 v[100:103], v1 offset:50176
    s_add_u32 m0, s54, 32768
    s_xor_b32 s36, s43, 40960
    buffer_load_dwordx4 v1, s[4:7], s36 offen offset:0 sc1 lds
    s_waitcnt lgkmcnt(5)
    v_mfma_f32_32x32x16_bf16 v[64:79], v[112:115], a[240:243], v[64:79]
    ds_read_b128 v[104:107], v1 offset:51200
    s_waitcnt lgkmcnt(5)
    v_mfma_f32_32x32x16_bf16 v[64:79], v[116:119], a[244:247], v[64:79]
    ds_read_b128 v[108:111], v1 offset:52224
    s_waitcnt lgkmcnt(5)
    v_mfma_f32_32x32x16_bf16 v[64:79], v[120:123], a[248:251], v[64:79]
    ds_read_b128 v[112:115], v1 offset:53248
    s_add_u32 s36, s47, 3072
    buffer_load_dwordx4 v[160:163], v1, s[4:7], s36 offen offset:2048 sc1
    s_waitcnt lgkmcnt(5)
    v_mfma_f32_32x32x16_bf16 v[64:79], v[124:127], a[252:255], v[64:79]
    ds_read_b128 v[116:119], v1 offset:54272
    s_add_u32 m0, s54, 32768
    s_xor_b32 s36, s43, 40960
    buffer_load_dwordx4 v1, s[4:7], s36 offen offset:1024 sc1 lds
    s_waitcnt lgkmcnt(5)
    v_mfma_f32_32x32x16_bf16 v[80:95], v[96:99], a[0:3], 0
    ds_read_b128 v[120:123], v1 offset:55296
    s_waitcnt lgkmcnt(5)
    v_mfma_f32_32x32x16_bf16 v[80:95], v[100:103], a[4:7], v[80:95]
    ds_read_b128 v[124:127], v1 offset:56320
    s_nop 1
    v_cvt_pk_bf16_f32 v128, v64, v65
    v_cvt_pk_bf16_f32 v129, v66, v67
    v_cvt_pk_bf16_f32 v130, v68, v69
    v_cvt_pk_bf16_f32 v132, v70, v71
    s_waitcnt lgkmcnt(5)
    v_mfma_f32_32x32x16_bf16 v[80:95], v[104:107], a[8:11], v[80:95]
    s_waitcnt vmcnt(14)
    s_barrier
    ds_read_b128 v[96:99], v1 offset:0
    v_cvt_pk_bf16_f32 v133, v72, v73
    v_cvt_pk_bf16_f32 v134, v74, v75
    s_waitcnt lgkmcnt(5)
    v_mfma_f32_32x32x16_bf16 v[80:95], v[108:111], a[12:15], v[80:95]
    ds_read_b128 v[100:103], v1 offset:1024
    s_add_u32 m0, s54, 40960
    s_xor_b32 s36, s43, 49152
    buffer_load_dwordx4 v1, s[4:7], s36 offen offset:0 sc1 lds
    v_cvt_pk_bf16_f32 v136, v76, v77
    s_waitcnt lgkmcnt(5)
    v_mfma_f32_32x32x16_bf16 v[80:95], v[112:115], a[16:19], v[80:95]
    ds_read_b128 v[104:107], v1 offset:2048
    v_cvt_pk_bf16_f32 v137, v78, v79
    s_waitcnt lgkmcnt(5)
    v_mfma_f32_32x32x16_bf16 v[80:95], v[116:119], a[20:23], v[80:95]
    ds_read_b128 v[108:111], v1 offset:3072
    buffer_store_dwordx4 v[128:131], v1, s[4:7], s46 offen offset:0 sc1
    s_waitcnt lgkmcnt(5)
    v_mfma_f32_32x32x16_bf16 v[80:95], v[120:123], a[24:27], v[80:95]
    ds_read_b128 v[112:115], v1 offset:4096
    s_waitcnt lgkmcnt(5)
    v_mfma_f32_32x32x16_bf16 v[80:95], v[124:127], a[28:31], v[80:95]
    ds_read_b128 v[116:119], v1 offset:5120
    s_add_u32 m0, s54, 40960
    s_xor_b32 s36, s43, 49152
    buffer_load_dwordx4 v1, s[4:7], s36 offen offset:1024 sc1 lds
    s_waitcnt lgkmcnt(5)
    v_mfma_f32_32x32x16_bf16 v[80:95], v[96:99], a[32:35], v[80:95]
    ds_read_b128 v[120:123], v1 offset:6144
    s_waitcnt vmcnt(11)
    v_xor_b32 v236, v30, v143
    v_xor_b32 v237, v30, v147
    v_xor_b32 v238, v30, v151
    v_or3_b32 v236, v236, v237, v238
    v_cmp_ne_u32 vcc, 0, v236
    s_nop 3
    s_cbranch_vccnz PI_12
PID_13:
    v_lshlrev_b32 v240, 16, v140
    v_and_b32 v241, 0xffff0000, v140
    v_fma_f32 v220, v240, v188, v220
    s_waitcnt lgkmcnt(5)
    v_mfma_f32_32x32x16_bf16 v[80:95], v[100:103], a[36:39], v[80:95]
    ds_read_b128 v[124:127], v1 offset:7168
    buffer_store_dwordx4 v[132:135], v1, s[4:7], s46 offen offset:1024 sc1
    v_fma_f32 v221, v241, v189, v221
    s_waitcnt lgkmcnt(5)
    v_mfma_f32_32x32x16_bf16 v[80:95], v[104:107], a[40:43], v[80:95]
    s_barrier
    ds_read_b128 v[96:99], v1 offset:8192
    v_lshlrev_b32 v242, 16, v141
    v_and_b32 v243, 0xffff0000, v141
    s_waitcnt lgkmcnt(5)
    v_mfma_f32_32x32x16_bf16 v[80:95], v[108:111], a[44:47], v[80:95]
    ds_read_b128 v[100:103], v1 offset:9216
    s_add_u32 m0, s54, 49152
    s_xor_b32 s36, s43, 57344
    buffer_load_dwordx4 v1, s[4:7], s36 offen offset:0 sc1 lds
    v_fma_f32 v222, v242, v190, v222
    s_waitcnt lgkmcnt(5)
    v_mfma_f32_32x32x16_bf16 v[80:95], v[112:115], a[48:51], v[80:95]
    ds_read_b128 v[104:107], v1 offset:10240
    v_fma_f32 v223, v243, v191, v223
    v_lshlrev_b32 v244, 16, v142
    v_and_b32 v245, 0xffff0000, v142
    v_fma_f32 v224, v244, v192, v224
    s_waitcnt lgkmcnt(5)
    v_mfma_f32_32x32x16_bf16 v[80:95], v[116:119], a[52:55], v[80:95]
    ds_read_b128 v[108:111], v1 offset:11264
    v_fma_f32 v225, v245, v193, v225
    v_lshlrev_b32 v246, 16, v144
    v_and_b32 v247, 0xffff0000, v144
    v_fma_f32 v226, v246, v194, v226
    s_waitcnt lgkmcnt(5)
    v_mfma_f32_32x32x16_bf16 v[80:95], v[120:123], a[56:59], v[80:95]
    ds_read_b128 v[112:115], v1 offset:12288
    buffer_store_dwordx4 v[136:139], v1, s[4:7], s46 offen offset:2048 sc1
    v_fma_f32 v227, v247, v195, v227
    s_waitcnt lgkmcnt(5)
    v_mfma_f32_32x32x16_bf16 v[80:95], v[124:127], a[60:63], v[80:95]
    ds_read_b128 v[116:119], v1 offset:13312
    s_add_u32 m0, s54, 49152
    s_xor_b32 s36, s43, 57344
    buffer_load_dwordx4 v1, s[4:7], s36 offen offset:1024 sc1 lds
    v_lshlrev_b32 v240, 16, v145
    s_waitcnt lgkmcnt(5)
    v_mfma_f32_32x32x16_bf16 v[80:95], v[96:99], a[64:67], v[80:95]
    ds_read_b128 v[120:123], v1 offset:14336
    v_and_b32 v241, 0xffff0000, v145
    v_fma_f32 v228, v240, v196, v228
    v_fma_f32 v229, v241, v197, v229
    v_lshlrev_b32 v242, 16, v146
    s_waitcnt lgkmcnt(5)
    v_mfma_f32_32x32x16_bf16 v[80:95], v[100:103], a[68:71], v[80:95]
    ds_read_b128 v[124:127], v1 offset:15360
    v_and_b32 v243, 0xffff0000, v146
    v_fma_f32 v230, v242, v198, v230
    v_fma_f32 v231, v243, v199, v231
    v_lshlrev_b32 v244, 16, v148
    s_waitcnt lgkmcnt(5)
    v_mfma_f32_32x32x16_bf16 v[80:95], v[104:107], a[72:75], v[80:95]
    s_waitcnt vmcnt(14)
    s_barrier
    ds_read_b128 v[96:99], v1 offset:16384
    v_and_b32 v245, 0xffff0000, v148
    v_fma_f32 v232, v244, v200, v232
    s_waitcnt lgkmcnt(5)
    v_mfma_f32_32x32x16_bf16 v[80:95], v[108:111], a[76:79], v[80:95]
    ds_read_b128 v[100:103], v1 offset:17408
    s_xor_b32 m0, s53, 3072
    s_xor_b32 s36, s52, 3
    s_mul_i32 s36, s36, 44032
    buffer_load_dwordx4 v14, s[16:19], s36 offen lds
    v_fma_f32 v233, v245, v201, v233
    s_waitcnt lgkmcnt(5)
    v_mfma_f32_32x32x16_bf16 v[80:95], v[112:115], a[80:83], v[80:95]
    ds_read_b128 v[104:107], v1 offset:18432
    v_lshlrev_b32 v246, 16, v149
    v_and_b32 v247, 0xffff0000, v149
    v_fma_f32 v234, v246, v202, v234
    v_fma_f32 v235, v247, v203, v235
    s_waitcnt lgkmcnt(5)
    v_mfma_f32_32x32x16_bf16 v[80:95], v[116:119], a[84:87], v[80:95]
    ds_read_b128 v[108:111], v1 offset:19456
    s_xor_b32 m0, s53, 35840
    s_xor_b32 s36, s52, 3
    s_mul_i32 s36, s36, 44032
    buffer_load_dwordx4 v15, s[16:19], s36 offen lds
    s_waitcnt vmcnt(10)
    v_xor_b32 v236, v30, v155
    v_xor_b32 v237, v30, v159
    v_xor_b32 v238, v30, v163
    v_or3_b32 v236, v236, v237, v238
    v_cmp_ne_u32 vcc, 0, v236
    s_nop 3
    s_cbranch_vccnz PI_14
PID_15:
    s_waitcnt lgkmcnt(5)
    v_mfma_f32_32x32x16_bf16 v[80:95], v[120:123], a[88:91], v[80:95]
    ds_read_b128 v[112:115], v1 offset:20480
    v_lshlrev_b32 v240, 16, v152
    v_and_b32 v241, 0xffff0000, v152
    v_fma_f32 v220, v240, v188, v220
    v_fma_f32 v221, v241, v189, v221
    s_waitcnt lgkmcnt(5)
    v_mfma_f32_32x32x16_bf16 v[80:95], v[124:127], a[92:95], v[80:95]
    ds_read_b128 v[116:119], v1 offset:21504
    s_xor_b32 m0, s53, 199680
    s_xor_b32 s36, s52, 3
    s_mul_i32 s36, s36, 44032
    buffer_load_dwordx4 v16, s[16:19], s36 offen lds
    v_lshlrev_b32 v242, 16, v153
    s_waitcnt lgkmcnt(5)
    v_mfma_f32_32x32x16_bf16 v[80:95], v[96:99], a[96:99], v[80:95]
    ds_read_b128 v[120:123], v1 offset:22528
    v_and_b32 v243, 0xffff0000, v153
    v_fma_f32 v222, v242, v190, v222
    v_fma_f32 v223, v243, v191, v223
    v_lshlrev_b32 v244, 16, v154
    s_waitcnt lgkmcnt(5)
    v_mfma_f32_32x32x16_bf16 v[80:95], v[100:103], a[100:103], v[80:95]
    ds_read_b128 v[124:127], v1 offset:23552
    s_xor_b32 m0, s53, 4096
    s_xor_b32 s36, s52, 4
    s_mul_i32 s36, s36, 44032
    buffer_load_dwordx4 v14, s[16:19], s36 offen lds
    v_and_b32 v245, 0xffff0000, v154
    s_waitcnt lgkmcnt(5)
    v_mfma_f32_32x32x16_bf16 v[80:95], v[104:107], a[104:107], v[80:95]
    s_barrier
    ds_read_b128 v[96:99], v1 offset:24576
    v_fma_f32 v224, v244, v192, v224
    v_fma_f32 v225, v245, v193, v225
    s_waitcnt lgkmcnt(5)
    v_mfma_f32_32x32x16_bf16 v[80:95], v[108:111], a[108:111], v[80:95]
    ds_read_b128 v[100:103], v1 offset:25600
    v_lshlrev_b32 v246, 16, v156
    v_and_b32 v247, 0xffff0000, v156
    v_fma_f32 v226, v246, v194, v226
    v_fma_f32 v227, v247, v195, v227
    s_waitcnt lgkmcnt(5)
    v_mfma_f32_32x32x16_bf16 v[80:95], v[112:115], a[112:115], v[80:95]
    ds_read_b128 v[104:107], v1 offset:26624
    s_xor_b32 m0, s53, 36864
    s_xor_b32 s36, s52, 4
    s_mul_i32 s36, s36, 44032
    buffer_load_dwordx4 v15, s[16:19], s36 offen lds
    v_lshlrev_b32 v240, 16, v157
    s_waitcnt lgkmcnt(5)
    v_mfma_f32_32x32x16_bf16 v[80:95], v[116:119], a[116:119], v[80:95]
    ds_read_b128 v[108:111], v1 offset:27648
    v_and_b32 v241, 0xffff0000, v157
    v_fma_f32 v228, v240, v196, v228
    v_fma_f32 v229, v241, v197, v229
    v_lshlrev_b32 v242, 16, v158
    s_waitcnt lgkmcnt(5)
    v_mfma_f32_32x32x16_bf16 v[80:95], v[120:123], a[120:123], v[80:95]
    ds_read_b128 v[112:115], v1 offset:28672
    s_xor_b32 m0, s53, 200704
    s_xor_b32 s36, s52, 4
    s_mul_i32 s36, s36, 44032
    buffer_load_dwordx4 v16, s[16:19], s36 offen lds
    v_and_b32 v243, 0xffff0000, v158
    s_waitcnt lgkmcnt(5)
    v_mfma_f32_32x32x16_bf16 v[80:95], v[124:127], a[124:127], v[80:95]
    ds_read_b128 v[116:119], v1 offset:29696
    v_fma_f32 v230, v242, v198, v230
    v_fma_f32 v231, v243, v199, v231
    v_lshlrev_b32 v244, 16, v160
    v_and_b32 v245, 0xffff0000, v160
    s_waitcnt lgkmcnt(5)
    v_mfma_f32_32x32x16_bf16 v[80:95], v[96:99], a[128:131], v[80:95]
    ds_read_b128 v[120:123], v1 offset:30720
    s_xor_b32 m0, s53, 5120
    s_xor_b32 s36, s52, 5
    s_mul_i32 s36, s36, 44032
    buffer_load_dwordx4 v14, s[16:19], s36 offen lds
    v_fma_f32 v232, v244, v200, v232
    s_waitcnt lgkmcnt(5)
    v_mfma_f32_32x32x16_bf16 v[80:95], v[100:103], a[132:135], v[80:95]
    ds_read_b128 v[124:127], v1 offset:31744
    v_fma_f32 v233, v245, v201, v233
    v_lshlrev_b32 v246, 16, v161
    v_and_b32 v247, 0xffff0000, v161
    v_fma_f32 v234, v246, v202, v234
    s_waitcnt lgkmcnt(5)
    v_mfma_f32_32x32x16_bf16 v[80:95], v[104:107], a[136:139], v[80:95]
    s_waitcnt vmcnt(14)
    s_barrier
    ds_read_b128 v[96:99], v1 offset:32768
    v_fma_f32 v235, v247, v203, v235
    s_waitcnt lgkmcnt(5)
    v_mfma_f32_32x32x16_bf16 v[80:95], v[108:111], a[140:143], v[80:95]
    ds_read_b128 v[100:103], v1 offset:33792
    s_add_u32 s36, s47, 6144
    buffer_load_dwordx4 v[164:167], v1, s[4:7], s36 offen offset:0 sc1
    s_waitcnt lgkmcnt(5)
    v_mfma_f32_32x32x16_bf16 v[80:95], v[112:115], a[144:147], v[80:95]
    ds_read_b128 v[104:107], v1 offset:34816
    s_waitcnt lgkmcnt(5)
    v_mfma_f32_32x32x16_bf16 v[80:95], v[116:119], a[148:151], v[80:95]
    ds_read_b128 v[108:111], v1 offset:35840
    s_add_u32 s36, s47, 6144
    buffer_load_dwordx4 v[168:171], v1, s[4:7], s36 offen offset:1024 sc1
    s_waitcnt lgkmcnt(5)
    v_mfma_f32_32x32x16_bf16 v[80:95], v[120:123], a[152:155], v[80:95]
    ds_read_b128 v[112:115], v1 offset:36864
    s_waitcnt lgkmcnt(5)
    v_mfma_f32_32x32x16_bf16 v[80:95], v[124:127], a[156:159], v[80:95]
    ds_read_b128 v[116:119], v1 offset:37888
    s_add_u32 s36, s47, 6144
    buffer_load_dwordx4 v[172:175], v1, s[4:7], s36 offen offset:2048 sc1
    s_waitcnt lgkmcnt(5)
    v_mfma_f32_32x32x16_bf16 v[80:95], v[96:99], a[160:163], v[80:95]
    ds_read_b128 v[120:123], v1 offset:38912
    s_waitcnt lgkmcnt(5)
    v_mfma_f32_32x32x16_bf16 v[80:95], v[100:103], a[164:167], v[80:95]
    ds_read_b128 v[124:127], v1 offset:39936
    s_waitcnt lgkmcnt(5)
    v_mfma_f32_32x32x16_bf16 v[80:95], v[104:107], a[168:171], v[80:95]
    s_waitcnt vmcnt(14)
    s_barrier
    ds_read_b128 v[96:99], v1 offset:40960
    s_waitcnt lgkmcnt(5)
    v_mfma_f32_32x32x16_bf16 v[80:95], v[108:111], a[172:175], v[80:95]
    ds_read_b128 v[100:103], v1 offset:41984
    s_xor_b32 m0, s53, 37888
    s_xor_b32 s36, s52, 5
    s_mul_i32 s36, s36, 44032
    buffer_load_dwordx4 v15, s[16:19], s36 offen lds
    s_waitcnt lgkmcnt(5)
    v_mfma_f32_32x32x16_bf16 v[80:95], v[112:115], a[176:179], v[80:95]
    ds_read_b128 v[104:107], v1 offset:43008
    s_waitcnt lgkmcnt(5)
    v_mfma_f32_32x32x16_bf16 v[80:95], v[116:119], a[180:183], v[80:95]
    ds_read_b128 v[108:111], v1 offset:44032
    s_xor_b32 m0, s53, 201728
    s_xor_b32 s36, s52, 5
    s_mul_i32 s36, s36, 44032
    buffer_load_dwordx4 v16, s[16:19], s36 offen lds
    s_waitcnt lgkmcnt(5)
    v_mfma_f32_32x32x16_bf16 v[80:95], v[120:123], a[184:187], v[80:95]
    ds_read_b128 v[112:115], v1 offset:45056
    s_waitcnt lgkmcnt(5)
    v_mfma_f32_32x32x16_bf16 v[80:95], v[124:127], a[188:191], v[80:95]
    ds_read_b128 v[116:119], v1 offset:46080
    s_xor_b32 m0, s53, 6144
    s_xor_b32 s36, s52, 6
    s_mul_i32 s36, s36, 44032
    buffer_load_dwordx4 v14, s[16:19], s36 offen lds
    s_waitcnt lgkmcnt(5)
    v_mfma_f32_32x32x16_bf16 v[80:95], v[96:99], a[192:195], v[80:95]
    ds_read_b128 v[120:123], v1 offset:47104
    s_waitcnt lgkmcnt(5)
    v_mfma_f32_32x32x16_bf16 v[80:95], v[100:103], a[196:199], v[80:95]
    ds_read_b128 v[124:127], v1 offset:48128
    s_xor_b32 m0, s53, 38912
    s_xor_b32 s36, s52, 6
    s_mul_i32 s36, s36, 44032
    buffer_load_dwordx4 v15, s[16:19], s36 offen lds
    s_waitcnt lgkmcnt(5)
    v_mfma_f32_32x32x16_bf16 v[80:95], v[104:107], a[200:203], v[80:95]
    s_waitcnt vmcnt(14)
    s_barrier
    ds_read_b128 v[96:99], v1 offset:49152
    s_waitcnt lgkmcnt(5)
    v_mfma_f32_32x32x16_bf16 v[80:95], v[108:111], a[204:207], v[80:95]
    ds_read_b128 v[100:103], v1 offset:50176
    s_waitcnt lgkmcnt(5)
    v_mfma_f32_32x32x16_bf16 v[80:95], v[112:115], a[208:211], v[80:95]
    ds_read_b128 v[104:107], v1 offset:51200
    s_xor_b32 m0, s53, 202752
    s_xor_b32 s36, s52, 6
    s_mul_i32 s36, s36, 44032
    buffer_load_dwordx4 v16, s[16:19], s36 offen lds
    s_waitcnt lgkmcnt(5)
    v_mfma_f32_32x32x16_bf16 v[80:95], v[116:119], a[212:215], v[80:95]
    ds_read_b128 v[108:111], v1 offset:52224
    s_waitcnt lgkmcnt(5)
    v_mfma_f32_32x32x16_bf16 v[80:95], v[120:123], a[216:219], v[80:95]
    ds_read_b128 v[112:115], v1 offset:53248
    s_xor_b32 m0, s53, 7168
    s_xor_b32 s36, s52, 7
    s_mul_i32 s36, s36, 44032
    buffer_load_dwordx4 v14, s[16:19], s36 offen lds
    s_waitcnt lgkmcnt(5)
    v_mfma_f32_32x32x16_bf16 v[80:95], v[124:127], a[220:223], v[80:95]
    ds_read_b128 v[116:119], v1 offset:54272
    s_waitcnt lgkmcnt(5)
    v_mfma_f32_32x32x16_bf16 v[80:95], v[96:99], a[224:227], v[80:95]
    ds_read_b128 v[120:123], v1 offset:55296
    s_xor_b32 m0, s53, 39936
    s_xor_b32 s36, s52, 7
    s_mul_i32 s36, s36, 44032
    buffer_load_dwordx4 v15, s[16:19], s36 offen lds
    s_waitcnt lgkmcnt(5)
    v_mfma_f32_32x32x16_bf16 v[80:95], v[100:103], a[228:231], v[80:95]
    ds_read_b128 v[124:127], v1 offset:56320
    s_waitcnt lgkmcnt(5)
    v_mfma_f32_32x32x16_bf16 v[80:95], v[104:107], a[232:235], v[80:95]
    s_xor_b32 m0, s53, 203776
    s_xor_b32 s36, s52, 7
    s_mul_i32 s36, s36, 44032
    buffer_load_dwordx4 v16, s[16:19], s36 offen lds
    s_waitcnt lgkmcnt(4)
    v_mfma_f32_32x32x16_bf16 v[80:95], v[108:111], a[236:239], v[80:95]
    s_waitcnt lgkmcnt(3)
    v_mfma_f32_32x32x16_bf16 v[80:95], v[112:115], a[240:243], v[80:95]
    s_waitcnt lgkmcnt(2)
    v_mfma_f32_32x32x16_bf16 v[80:95], v[116:119], a[244:247], v[80:95]
    s_waitcnt lgkmcnt(1)
    v_mfma_f32_32x32x16_bf16 v[80:95], v[120:123], a[248:251], v[80:95]
    s_waitcnt lgkmcnt(0)
    v_mfma_f32_32x32x16_bf16 v[80:95], v[124:127], a[252:255], v[80:95]
    s_waitcnt vmcnt(8)
    v_xor_b32 v236, v30, v167
    v_xor_b32 v237, v30, v171
    v_xor_b32 v238, v30, v175
    v_or3_b32 v236, v236, v237, v238
    v_cmp_ne_u32 vcc, 0, v236
    s_nop 3
    s_cbranch_vccnz PK_16
PKD_17:
    v_lshlrev_b32 v240, 16, v164
    v_and_b32 v241, 0xffff0000, v164
    v_fma_f32 v220, v240, v188, v220
    v_fma_f32 v221, v241, v189, v221
    v_lshlrev_b32 v242, 16, v165
    v_and_b32 v243, 0xffff0000, v165
    v_fma_f32 v222, v242, v190, v222
    v_fma_f32 v223, v243, v191, v223
    v_lshlrev_b32 v244, 16, v166
    v_and_b32 v245, 0xffff0000, v166
    v_fma_f32 v224, v244, v192, v224
    v_fma_f32 v225, v245, v193, v225
    v_lshlrev_b32 v246, 16, v168
    v_and_b32 v247, 0xffff0000, v168
    v_fma_f32 v226, v246, v194, v226
    v_fma_f32 v227, v247, v195, v227
    v_lshlrev_b32 v240, 16, v169
    v_and_b32 v241, 0xffff0000, v169
    v_fma_f32 v228, v240, v196, v228
    v_fma_f32 v229, v241, v197, v229
    v_lshlrev_b32 v242, 16, v170
    v_and_b32 v243, 0xffff0000, v170
    v_fma_f32 v230, v242, v198, v230
    v_fma_f32 v231, v243, v199, v231
    v_lshlrev_b32 v244, 16, v172
    v_and_b32 v245, 0xffff0000, v172
    v_fma_f32 v232, v244, v200, v232
    v_fma_f32 v233, v245, v201, v233
    v_lshlrev_b32 v246, 16, v173
    v_and_b32 v247, 0xffff0000, v173
    v_fma_f32 v234, v246, v202, v234
    v_fma_f32 v235, v247, v203, v235
    v_fma_f32 v220, v80, v188, v220
    v_fma_f32 v221, v81, v189, v221
    v_fma_f32 v222, v82, v190, v222
    v_fma_f32 v223, v83, v191, v223
    v_fma_f32 v224, v84, v192, v224
    v_fma_f32 v225, v85, v193, v225
    v_fma_f32 v226, v86, v194, v226
    v_fma_f32 v227, v87, v195, v227
    v_fma_f32 v228, v88, v196, v228
    v_fma_f32 v229, v89, v197, v229
    v_fma_f32 v230, v90, v198, v230
    v_fma_f32 v231, v91, v199, v231
    v_fma_f32 v232, v92, v200, v232
    v_fma_f32 v233, v93, v201, v233
    v_fma_f32 v234, v94, v202, v234
    v_fma_f32 v235, v95, v203, v235
    v_mul_f32 v204, v220, v204
    v_mul_f32 v205, v221, v205
    v_mul_f32 v206, v222, v206
    v_mul_f32 v207, v223, v207
    v_mul_f32 v208, v224, v208
    v_mul_f32 v209, v225, v209
    v_mul_f32 v210, v226, v210
    v_mul_f32 v211, v227, v211
    v_mul_f32 v212, v228, v212
    v_mul_f32 v213, v229, v213
    v_mul_f32 v214, v230, v214
    v_mul_f32 v215, v231, v215
    v_mul_f32 v216, v232, v216
    v_mul_f32 v217, v233, v217
    v_mul_f32 v218, v234, v218
    v_mul_f32 v219, v235, v219
    v_cvt_pk_bf16_f32 v204, v204, v205
    v_cvt_pk_bf16_f32 v205, v206, v207
    v_cvt_pk_bf16_f32 v206, v208, v209
    v_cvt_pk_bf16_f32 v207, v210, v211
    v_cvt_pk_bf16_f32 v208, v212, v213
    v_cvt_pk_bf16_f32 v209, v214, v215
    v_cvt_pk_bf16_f32 v210, v216, v217
    v_cvt_pk_bf16_f32 v211, v218, v219
    buffer_store_dwordx4 v[204:207], v1, s[4:7], s49 offen offset:0 sc1
    buffer_store_dwordx4 v[208:211], v1, s[4:7], s49 offen offset:1024 sc1
    s_add_u32 s49, s49, 2097152
    s_mov_b32 s36, 0x3f803f80
    v_cvt_pk_bf16_f32 v220, v220, v221
    v_cvt_pk_bf16_f32 v221, v222, v223
    v_cvt_pk_bf16_f32 v222, v224, v225
    v_cvt_pk_bf16_f32 v223, v226, v227
    v_cvt_pk_bf16_f32 v224, v228, v229
    v_cvt_pk_bf16_f32 v225, v230, v231
    v_cvt_pk_bf16_f32 v226, v232, v233
    v_cvt_pk_bf16_f32 v227, v234, v235
    buffer_store_dwordx4 v[220:223], v1, s[4:7], s49 offen offset:0 sc1
    buffer_store_dwordx4 v[224:227], v1, s[4:7], s49 offen offset:1024 sc1
    v_dot2_f32_bf16 v236, v220, s36, 0
    v_dot2_f32_bf16 v237, v220, v220, 0
    v_dot2_f32_bf16 v238, v221, s36, 0
    v_dot2_f32_bf16 v239, v221, v221, 0
    v_dot2c_f32_bf16 v236, s36, v222
    v_dot2c_f32_bf16 v237, v222, v222
    v_dot2c_f32_bf16 v238, s36, v223
    v_dot2c_f32_bf16 v239, v223, v223
    v_dot2c_f32_bf16 v236, s36, v224
    v_dot2c_f32_bf16 v237, v224, v224
    v_dot2c_f32_bf16 v238, s36, v225
    v_dot2c_f32_bf16 v239, v225, v225
    v_dot2c_f32_bf16 v236, s36, v226
    v_dot2c_f32_bf16 v237, v226, v226
    v_dot2c_f32_bf16 v238, s36, v227
    v_dot2c_f32_bf16 v239, v227, v227
    v_lshlrev_b32 v240, 2, v0
    s_nop 0
    v_add_f32 v236, v236, v238
    v_add_f32 v237, v237, v239
    s_nop 1
    v_permlane32_swap_b32 v236, v237
    v_add_f32 v236, v236, v237
    buffer_store_dword v236, v240, s[4:7], s50 offen sc1
    s_waitcnt vmcnt(5)
    s_barrier
    s_branch K_JOIN
K_CL1:
    s_xor_b32 s36, s22, 4096
    buffer_load_dwordx4 v[100:103], v1, s[8:11], s36 offen offset:0
    buffer_load_dwordx4 v[108:111], v1, s[8:11], s36 offen offset:1024
    buffer_load_dwordx4 v[116:119], v1, s[8:11], s36 offen offset:2048
    buffer_load_dwordx4 v[124:127], v1, s[8:11], s36 offen offset:3072
    s_xor_b32 s36, s22, 32768
    buffer_load_dwordx4 v[132:135], v1, s[8:11], s36 offen offset:0
    buffer_load_dwordx4 v[140:143], v1, s[8:11], s36 offen offset:1024
    buffer_load_dwordx4 v[148:151], v1, s[8:11], s36 offen offset:2048
    buffer_load_dwordx4 v[156:159], v1, s[8:11], s36 offen offset:3072
    s_xor_b32 s36, s22, 36864
    buffer_load_dwordx4 v[164:167], v1, s[8:11], s36 offen offset:0
    buffer_load_dwordx4 v[172:175], v1, s[8:11], s36 offen offset:1024
    buffer_load_dwordx4 v[180:183], v1, s[8:11], s36 offen offset:2048
    buffer_load_dwordx4 v[188:191], v1, s[8:11], s36 offen offset:3072
    s_mov_b32 s38, 0x3f803f80
    s_waitcnt vmcnt(19)
    v_dot2_f32_bf16 v224, v68, s38, 0
    v_dot2_f32_bf16 v240, v68, v68, 0
    v_lshlrev_b32 v64, 16, v68
    v_and_b32 v65, 0xffff0000, v68
    v_lshlrev_b32 v66, 16, v69
    v_and_b32 v67, 0xffff0000, v69
    v_dot2c_f32_bf16 v224, s38, v69
    v_dot2c_f32_bf16 v240, v69, v69
    v_dot2c_f32_bf16 v224, s38, v70
    v_dot2c_f32_bf16 v240, v70, v70
    v_dot2c_f32_bf16 v224, s38, v71
    s_add_u32 m0, s30, 4096
    s_xor_b32 s36, s21, 128
    buffer_load_dwordx4 v6, s[16:19], s36 offen offset:0  lds
    v_dot2c_f32_bf16 v240, v71, v71
    v_lshlrev_b32 v68, 16, v70
    v_and_b32 v69, 0xffff0000, v70
    v_lshlrev_b32 v70, 16, v71
    v_and_b32 v71, 0xffff0000, v71
    s_waitcnt vmcnt(19)
    v_dot2_f32_bf16 v225, v76, s38, 0
    v_dot2_f32_bf16 v241, v76, v76, 0
    v_lshlrev_b32 v72, 16, v76
    v_and_b32 v73, 0xffff0000, v76
    v_lshlrev_b32 v74, 16, v77
    v_and_b32 v75, 0xffff0000, v77
    v_dot2c_f32_bf16 v225, s38, v77
    s_add_u32 m0, s30, 4096
    s_xor_b32 s36, s21, 128
    buffer_load_dwordx4 v7, s[16:19], s36 offen offset:1024  lds
    v_dot2c_f32_bf16 v241, v77, v77
    v_dot2c_f32_bf16 v225, s38, v78
    v_dot2c_f32_bf16 v241, v78, v78
    v_dot2c_f32_bf16 v225, s38, v79
    v_dot2c_f32_bf16 v241, v79, v79
    v_lshlrev_b32 v76, 16, v78
    v_and_b32 v77, 0xffff0000, v78
    v_lshlrev_b32 v78, 16, v79
    v_and_b32 v79, 0xffff0000, v79
    s_waitcnt vmcnt(19)
    v_dot2_f32_bf16 v226, v84, s38, 0
    v_dot2_f32_bf16 v242, v84, v84, 0
    v_lshlrev_b32 v80, 16, v84
    s_add_u32 m0, s30, 4096
    s_xor_b32 s36, s21, 128
    buffer_load_dwordx4 v8, s[16:19], s36 offen offset:2048  lds
    v_and_b32 v81, 0xffff0000, v84
    v_lshlrev_b32 v82, 16, v85
    v_and_b32 v83, 0xffff0000, v85
    v_dot2c_f32_bf16 v226, s38, v85
    v_dot2c_f32_bf16 v242, v85, v85
    v_dot2c_f32_bf16 v226, s38, v86
    v_dot2c_f32_bf16 v242, v86, v86
    v_dot2c_f32_bf16 v226, s38, v87
    v_dot2c_f32_bf16 v242, v87, v87
    v_lshlrev_b32 v84, 16, v86
    v_and_b32 v85, 0xffff0000, v86
    v_lshlrev_b32 v86, 16, v87
    v_and_b32 v87, 0xffff0000, v87
    s_add_u32 m0, s30, 4096
    s_xor_b32 s36, s21, 128
    buffer_load_dwordx4 v9, s[16:19], s36 offen offset:3072  lds
    s_waitcnt vmcnt(20)
    v_dot2_f32_bf16 v227, v92, s38, 0
    v_dot2_f32_bf16 v243, v92, v92, 0
    v_lshlrev_b32 v88, 16, v92
    v_and_b32 v89, 0xffff0000, v92
    v_lshlrev_b32 v90, 16, v93
    v_and_b32 v91, 0xffff0000, v93
    v_dot2c_f32_bf16 v227, s38, v93
    v_dot2c_f32_bf16 v243, v93, v93
    v_dot2c_f32_bf16 v227, s38, v94
    v_dot2c_f32_bf16 v243, v94, v94
    v_dot2c_f32_bf16 v227, s38, v95
    v_dot2c_f32_bf16 v243, v95, v95
    v_lshlrev_b32 v92, 16, v94
    v_and_b32 v93, 0xffff0000, v94
    v_lshlrev_b32 v94, 16, v95
    v_and_b32 v95, 0xffff0000, v95
    s_mov_b32 s38, 0x3f803f80
    s_waitcnt vmcnt(15)
    v_dot2_f32_bf16 v228, v100, s38, 0
    v_dot2_f32_bf16 v244, v100, v100, 0
    v_lshlrev_b32 v96, 16, v100
    v_and_b32 v97, 0xffff0000, v100
    v_lshlrev_b32 v98, 16, v101
    v_and_b32 v99, 0xffff0000, v101
    s_add_u32 m0, s30, 8192
    s_xor_b32 s36, s21, 256
    buffer_load_dwordx4 v6, s[16:19], s36 offen offset:0  lds
    v_dot2c_f32_bf16 v228, s38, v101
    v_dot2c_f32_bf16 v244, v101, v101
    v_dot2c_f32_bf16 v228, s38, v102
    v_dot2c_f32_bf16 v244, v102, v102
    v_dot2c_f32_bf16 v228, s38, v103
    v_dot2c_f32_bf16 v244, v103, v103
    v_lshlrev_b32 v100, 16, v102
    s_add_u32 m0, s30, 8192
    s_xor_b32 s36, s21, 256
    buffer_load_dwordx4 v7, s[16:19], s36 offen offset:1024  lds
    v_and_b32 v101, 0xffff0000, v102
    v_lshlrev_b32 v102, 16, v103
    v_and_b32 v103, 0xffff0000, v103
    s_waitcnt vmcnt(16)
    v_dot2_f32_bf16 v229, v108, s38, 0
    v_dot2_f32_bf16 v245, v108, v108, 0
    v_lshlrev_b32 v104, 16, v108
    s_add_u32 m0, s30, 8192
    s_xor_b32 s36, s21, 256
    buffer_load_dwordx4 v8, s[16:19], s36 offen offset:2048  lds
    v_and_b32 v105, 0xffff0000, v108
    v_lshlrev_b32 v106, 16, v109
    v_and_b32 v107, 0xffff0000, v109
    v_dot2c_f32_bf16 v229, s38, v109
    v_dot2c_f32_bf16 v245, v109, v109
    v_dot2c_f32_bf16 v229, s38, v110
    v_dot2c_f32_bf16 v245, v110, v110
    s_add_u32 m0, s30, 8192
    s_xor_b32 s36, s21, 256
    buffer_load_dwordx4 v9, s[16:19], s36 offen offset:3072  lds
    v_dot2c_f32_bf16 v229, s38, v111
    v_dot2c_f32_bf16 v245, v111, v111
    v_lshlrev_b32 v108, 16, v110
    v_and_b32 v109, 0xffff0000, v110
    v_lshlrev_b32 v110, 16, v111
    v_and_b32 v111, 0xffff0000, v111
    s_waitcnt vmcnt(17)
    s_add_u32 m0, s30, 12288
    s_xor_b32 s36, s21, 384
    buffer_load_dwordx4 v6, s[16:19], s36 offen offset:0  lds
    v_dot2_f32_bf16 v230, v116, s38, 0
    v_dot2_f32_bf16 v246, v116, v116, 0
    v_lshlrev_b32 v112, 16, v116
    v_and_b32 v113, 0xffff0000, v116
    v_lshlrev_b32 v114, 16, v117
    v_and_b32 v115, 0xffff0000, v117
    v_dot2c_f32_bf16 v230, s38, v117
    s_add_u32 m0, s30, 12288
    s_xor_b32 s36, s21, 384
    buffer_load_dwordx4 v7, s[16:19], s36 offen offset:1024  lds
    v_dot2c_f32_bf16 v246, v117, v117
    v_dot2c_f32_bf16 v230, s38, v118
    v_dot2c_f32_bf16 v246, v118, v118
    v_dot2c_f32_bf16 v230, s38, v119
    v_dot2c_f32_bf16 v246, v119, v119
    v_lshlrev_b32 v116, 16, v118
    v_and_b32 v117, 0xffff0000, v118
    s_add_u32 m0, s30, 12288
    s_xor_b32 s36, s21, 384
    buffer_load_dwordx4 v8, s[16:19], s36 offen offset:2048  lds
    v_lshlrev_b32 v118, 16, v119
    v_and_b32 v119, 0xffff0000, v119
    s_waitcnt vmcnt(19)
    v_dot2_f32_bf16 v231, v124, s38, 0
    v_dot2_f32_bf16 v247, v124, v124, 0
    v_lshlrev_b32 v120, 16, v124
    v_and_b32 v121, 0xffff0000, v124
    s_add_u32 m0, s30, 12288
    s_xor_b32 s36, s21, 384
    buffer_load_dwordx4 v9, s[16:19], s36 offen offset:3072  lds
    v_lshlrev_b32 v122, 16, v125
    v_and_b32 v123, 0xffff0000, v125
    v_dot2c_f32_bf16 v231, s38, v125
    v_dot2c_f32_bf16 v247, v125, v125
    v_dot2c_f32_bf16 v231, s38, v126
    v_dot2c_f32_bf16 v247, v126, v126
    v_dot2c_f32_bf16 v231, s38, v127
    v_dot2c_f32_bf16 v247, v127, v127
    v_lshlrev_b32 v124, 16, v126
    v_and_b32 v125, 0xffff0000, v126
    v_lshlrev_b32 v126, 16, v127
    v_and_b32 v127, 0xffff0000, v127
    s_mov_b32 s38, 0x3f803f80
    s_waitcnt vmcnt(19)
    v_dot2_f32_bf16 v232, v132, s38, 0
    v_dot2_f32_bf16 v248, v132, v132, 0
    v_lshlrev_b32 v128, 16, v132
    v_and_b32 v129, 0xffff0000, v132
    v_lshlrev_b32 v130, 16, v133
    v_and_b32 v131, 0xffff0000, v133
    s_add_u32 m0, s30, 16384
    s_xor_b32 s36, s21, 512
    buffer_load_dwordx4 v6, s[16:19], s36 offen offset:0  lds
    v_dot2c_f32_bf16 v232, s38, v133
    v_dot2c_f32_bf16 v248, v133, v133
    v_dot2c_f32_bf16 v232, s38, v134
    v_dot2c_f32_bf16 v248, v134, v134
    v_dot2c_f32_bf16 v232, s38, v135
    v_dot2c_f32_bf16 v248, v135, v135
    v_lshlrev_b32 v132, 16, v134
    s_add_u32 m0, s30, 16384
    s_xor_b32 s36, s21, 512
    buffer_load_dwordx4 v7, s[16:19], s36 offen offset:1024  lds
    v_and_b32 v133, 0xffff0000, v134
    v_lshlrev_b32 v134, 16, v135
    v_and_b32 v135, 0xffff0000, v135
    s_waitcnt vmcnt(20)
    v_dot2_f32_bf16 v233, v140, s38, 0
    v_dot2_f32_bf16 v249, v140, v140, 0
    v_lshlrev_b32 v136, 16, v140
    s_add_u32 m0, s30, 16384
    s_xor_b32 s36, s21, 512
    buffer_load_dwordx4 v8, s[16:19], s36 offen offset:2048  lds
    v_and_b32 v137, 0xffff0000, v140
    v_lshlrev_b32 v138, 16, v141
    v_and_b32 v139, 0xffff0000, v141
    v_dot2c_f32_bf16 v233, s38, v141
    v_dot2c_f32_bf16 v249, v141, v141
    v_dot2c_f32_bf16 v233, s38, v142
    v_dot2c_f32_bf16 v249, v142, v142
    s_add_u32 m0, s30, 16384
    s_xor_b32 s36, s21, 512
    buffer_load_dwordx4 v9, s[16:19], s36 offen offset:3072  lds
    v_dot2c_f32_bf16 v233, s38, v143
    v_dot2c_f32_bf16 v249, v143, v143
    v_lshlrev_b32 v140, 16, v142
    v_and_b32 v141, 0xffff0000, v142
    v_lshlrev_b32 v142, 16, v143
    v_and_b32 v143, 0xffff0000, v143
    s_waitcnt vmcnt(21)
    ds_read_b128 a[192:195], v10 offset:0
    ds_read_b128 a[196:199], v11 offset:0
    ds_read_b128 a[200:203], v12 offset:0
    ds_read_b128 a[204:207], v13 offset:0
    s_waitcnt lgkmcnt(0)
    s_add_u32 m0, s30, 0
    s_xor_b32 s36, s21, 640
    buffer_load_dwordx4 v6, s[16:19], s36 offen offset:0  lds
    v_dot2_f32_bf16 v234, v148, s38, 0
    v_dot2_f32_bf16 v250, v148, v148, 0
    v_lshlrev_b32 v144, 16, v148
    v_and_b32 v145, 0xffff0000, v148
    v_lshlrev_b32 v146, 16, v149
    v_and_b32 v147, 0xffff0000, v149
    v_dot2c_f32_bf16 v234, s38, v149
    s_add_u32 m0, s30, 0
    s_xor_b32 s36, s21, 640
    buffer_load_dwordx4 v7, s[16:19], s36 offen offset:1024  lds
    v_dot2c_f32_bf16 v250, v149, v149
    v_dot2c_f32_bf16 v234, s38, v150
    v_dot2c_f32_bf16 v250, v150, v150
    v_dot2c_f32_bf16 v234, s38, v151
    v_dot2c_f32_bf16 v250, v151, v151
    v_lshlrev_b32 v148, 16, v150
    v_and_b32 v149, 0xffff0000, v150
    s_add_u32 m0, s30, 0
    s_xor_b32 s36, s21, 640
    buffer_load_dwordx4 v8, s[16:19], s36 offen offset:2048  lds
    v_lshlrev_b32 v150, 16, v151
    v_and_b32 v151, 0xffff0000, v151
    s_waitcnt vmcnt(23)
    v_dot2_f32_bf16 v235, v156, s38, 0
    v_dot2_f32_bf16 v251, v156, v156, 0
    v_lshlrev_b32 v152, 16, v156
    v_and_b32 v153, 0xffff0000, v156
    s_add_u32 m0, s30, 0
    s_xor_b32 s36, s21, 640
    buffer_load_dwordx4 v9, s[16:19], s36 offen offset:3072  lds
    v_lshlrev_b32 v154, 16, v157
    v_and_b32 v155, 0xffff0000, v157
    v_dot2c_f32_bf16 v235, s38, v157
    v_dot2c_f32_bf16 v251, v157, v157
    v_dot2c_f32_bf16 v235, s38, v158
    v_dot2c_f32_bf16 v251, v158, v158
    v_dot2c_f32_bf16 v235, s38, v159
    v_dot2c_f32_bf16 v251, v159, v159
    v_lshlrev_b32 v156, 16, v158
    v_and_b32 v157, 0xffff0000, v158
    v_lshlrev_b32 v158, 16, v159
    v_and_b32 v159, 0xffff0000, v159
    s_mov_b32 s38, 0x3f803f80
    s_waitcnt vmcnt(23)
    v_dot2_f32_bf16 v236, v164, s38, 0
    v_dot2_f32_bf16 v252, v164, v164, 0
    v_lshlrev_b32 v160, 16, v164
    v_and_b32 v161, 0xffff0000, v164
    v_lshlrev_b32 v162, 16, v165
    v_and_b32 v163, 0xffff0000, v165
    s_waitcnt vmcnt(16)
    ds_read_b128 a[208:211], v10 offset:4096
    ds_read_b128 a[212:215], v11 offset:4096
    ds_read_b128 a[216:219], v12 offset:4096
    ds_read_b128 a[220:223], v13 offset:4096
    s_waitcnt lgkmcnt(0)
    s_add_u32 m0, s30, 4096
    s_xor_b32 s36, s21, 768
    buffer_load_dwordx4 v6, s[16:19], s36 offen offset:0  lds
    v_dot2c_f32_bf16 v236, s38, v165
    v_dot2c_f32_bf16 v252, v165, v165
    v_dot2c_f32_bf16 v236, s38, v166
    v_dot2c_f32_bf16 v252, v166, v166
    v_dot2c_f32_bf16 v236, s38, v167
    v_dot2c_f32_bf16 v252, v167, v167
    v_lshlrev_b32 v164, 16, v166
    s_add_u32 m0, s30, 4096
    s_xor_b32 s36, s21, 768
    buffer_load_dwordx4 v7, s[16:19], s36 offen offset:1024  lds
    v_and_b32 v165, 0xffff0000, v166
    v_lshlrev_b32 v166, 16, v167
    v_and_b32 v167, 0xffff0000, v167
    v_dot2_f32_bf16 v237, v172, s38, 0
    v_dot2_f32_bf16 v253, v172, v172, 0
    v_lshlrev_b32 v168, 16, v172
    v_and_b32 v169, 0xffff0000, v172
    s_add_u32 m0, s30, 4096
    s_xor_b32 s36, s21, 768
    buffer_load_dwordx4 v8, s[16:19], s36 offen offset:2048  lds
    v_lshlrev_b32 v170, 16, v173
    v_and_b32 v171, 0xffff0000, v173
    v_dot2c_f32_bf16 v237, s38, v173
    v_dot2c_f32_bf16 v253, v173, v173
    v_dot2c_f32_bf16 v237, s38, v174
    v_dot2c_f32_bf16 v253, v174, v174
    v_dot2c_f32_bf16 v237, s38, v175
    s_add_u32 m0, s30, 4096
    s_xor_b32 s36, s21, 768
    buffer_load_dwordx4 v9, s[16:19], s36 offen offset:3072  lds
    v_dot2c_f32_bf16 v253, v175, v175
    v_lshlrev_b32 v172, 16, v174
    v_and_b32 v173, 0xffff0000, v174
    v_lshlrev_b32 v174, 16, v175
    v_and_b32 v175, 0xffff0000, v175
    v_dot2_f32_bf16 v238, v180, s38, 0
    v_dot2_f32_bf16 v254, v180, v180, 0
    s_waitcnt vmcnt(16)
    ds_read_b128 a[224:227], v10 offset:8192
    ds_read_b128 a[228:231], v11 offset:8192
    ds_read_b128 a[232:235], v12 offset:8192
    ds_read_b128 a[236:239], v13 offset:8192
    s_waitcnt lgkmcnt(0)
    s_add_u32 m0, s30, 8192
    s_xor_b32 s36, s21, 896
    buffer_load_dwordx4 v6, s[16:19], s36 offen offset:0  lds
    v_lshlrev_b32 v176, 16, v180
    v_and_b32 v177, 0xffff0000, v180
    v_lshlrev_b32 v178, 16, v181
    v_and_b32 v179, 0xffff0000, v181
    v_dot2c_f32_bf16 v238, s38, v181
    v_dot2c_f32_bf16 v254, v181, v181
    v_dot2c_f32_bf16 v238, s38, v182
    s_add_u32 m0, s30, 8192
    s_xor_b32 s36, s21, 896
    buffer_load_dwordx4 v7, s[16:19], s36 offen offset:1024  lds
    v_dot2c_f32_bf16 v254, v182, v182
    v_dot2c_f32_bf16 v238, s38, v183
    v_dot2c_f32_bf16 v254, v183, v183
    v_lshlrev_b32 v180, 16, v182
    v_and_b32 v181, 0xffff0000, v182
    v_lshlrev_b32 v182, 16, v183
    v_and_b32 v183, 0xffff0000, v183
    s_add_u32 m0, s30, 8192
    s_xor_b32 s36, s21, 896
    buffer_load_dwordx4 v8, s[16:19], s36 offen offset:2048  lds
    v_dot2_f32_bf16 v239, v188, s38, 0
    v_dot2_f32_bf16 v255, v188, v188, 0
    v_lshlrev_b32 v184, 16, v188
    v_and_b32 v185, 0xffff0000, v188
    v_lshlrev_b32 v186, 16, v189
    v_and_b32 v187, 0xffff0000, v189
    v_dot2c_f32_bf16 v239, s38, v189
    s_add_u32 m0, s30, 8192
    s_xor_b32 s36, s21, 896
    buffer_load_dwordx4 v9, s[16:19], s36 offen offset:3072  lds
    v_dot2c_f32_bf16 v255, v189, v189
    v_dot2c_f32_bf16 v239, s38, v190
    v_dot2c_f32_bf16 v255, v190, v190
    v_dot2c_f32_bf16 v239, s38, v191
    v_dot2c_f32_bf16 v255, v191, v191
    v_lshlrev_b32 v188, 16, v190
    v_and_b32 v189, 0xffff0000, v190
    v_lshlrev_b32 v190, 16, v191
    v_and_b32 v191, 0xffff0000, v191
    s_lshl_b32 s25, s3, 10
    s_add_u32 s25, s25, 25690112
    buffer_load_dword v30, v29, s[32:35], 0 offen sc1
    buffer_load_dwordx4 v[32:35], v28, s[32:35], 0 offen sc1
    buffer_load_dwordx4 v[36:39], v1, s[4:7], s25 offen sc1
    s_add_u32 s36, s25, 12288
    buffer_load_dwordx4 v[40:43], v1, s[4:7], s36 offen sc1
    s_add_u32 s36, s36, 12288
    buffer_load_dwordx4 v[44:47], v1, s[4:7], s36 offen sc1
    s_add_u32 s36, s36, 12288
    buffer_load_dwordx4 v[48:51], v1, s[4:7], s36 offen sc1
    v_permlane32_swap_b32 v224, v232
    v_permlane32_swap_b32 v225, v233
    v_permlane32_swap_b32 v226, v234
    v_permlane32_swap_b32 v227, v235
    v_permlane32_swap_b32 v228, v236
    v_permlane32_swap_b32 v229, v237
    v_permlane32_swap_b32 v230, v238
    v_permlane32_swap_b32 v231, v239
    v_add_f32 v224, v224, v232
    v_add_f32 v225, v225, v233
    v_add_f32 v226, v226, v234
    v_add_f32 v227, v227, v235
    v_add_f32 v228, v228, v236
    v_add_f32 v229, v229, v237
    v_add_f32 v230, v230, v238
    v_add_f32 v231, v231, v239
    v_permlane32_swap_b32 v240, v248
    v_permlane32_swap_b32 v241, v249
    v_permlane32_swap_b32 v242, v250
    v_permlane32_swap_b32 v243, v251
    v_permlane32_swap_b32 v244, v252
    v_permlane32_swap_b32 v245, v253
    v_permlane32_swap_b32 v246, v254
    v_permlane32_swap_b32 v247, v255
    v_add_f32 v240, v240, v248
    v_add_f32 v241, v241, v249
    v_add_f32 v242, v242, v250
    v_add_f32 v243, v243, v251
    v_add_f32 v244, v244, v252
    v_add_f32 v245, v245, v253
    v_add_f32 v246, v246, v254
    v_add_f32 v247, v247, v255
    v_permlane16_swap_b32 v224, v228
    v_permlane16_swap_b32 v225, v229
    v_permlane16_swap_b32 v226, v230
    v_permlane16_swap_b32 v227, v231
    v_permlane16_swap_b32 v240, v244
    v_permlane16_swap_b32 v241, v245
    v_permlane16_swap_b32 v242, v246
    v_permlane16_swap_b32 v243, v247
    v_add_f32 v224, v224, v228
    v_add_f32 v225, v225, v229
    v_add_f32 v226, v226, v230
    v_add_f32 v227, v227, v231
    v_add_f32 v240, v240, v244
    v_add_f32 v241, v241, v245
    v_add_f32 v242, v242, v246
    v_add_f32 v243, v243, v247
    s_waitcnt vmcnt(22)
    ds_read_b128 a[240:243], v10 offset:12288
    ds_read_b128 a[244:247], v11 offset:12288
    ds_read_b128 a[248:251], v12 offset:12288
    ds_read_b128 a[252:255], v13 offset:12288
    s_waitcnt vmcnt(18)
    ds_read_b128 v[192:195], v10 offset:16384
    ds_read_b128 v[196:199], v11 offset:16384
    ds_read_b128 v[200:203], v12 offset:16384
    ds_read_b128 v[204:207], v13 offset:16384
    s_waitcnt lgkmcnt(4)
    s_add_u32 m0, s30, 12288
    s_xor_b32 s36, s20, 512
    buffer_load_dwordx4 v2, s[12:15], s36 offen offset:0  lds
    buffer_load_dwordx4 v3, s[12:15], s36 offen offset:1024  lds
    buffer_load_dwordx4 v4, s[12:15], s36 offen offset:2048  lds
    buffer_load_dwordx4 v5, s[12:15], s36 offen offset:3072  lds
    s_waitcnt lgkmcnt(0)
    s_add_u32 m0, s30, 16384
    s_xor_b32 s36, s20, 640
    buffer_load_dwordx4 v2, s[12:15], s36 offen offset:0  lds
    buffer_load_dwordx4 v3, s[12:15], s36 offen offset:1024  lds
    buffer_load_dwordx4 v4, s[12:15], s36 offen offset:2048  lds
    buffer_load_dwordx4 v5, s[12:15], s36 offen offset:3072  lds
    v_add_f32_dpp v224, v224, v224 row_ror:8 row_mask:0xf bank_mask:0xf
    v_add_f32_dpp v225, v225, v225 row_ror:8 row_mask:0xf bank_mask:0xf
    v_add_f32_dpp v226, v226, v226 row_ror:8 row_mask:0xf bank_mask:0xf
    v_add_f32_dpp v227, v227, v227 row_ror:8 row_mask:0xf bank_mask:0xf
    v_add_f32_dpp v240, v240, v240 row_ror:8 row_mask:0xf bank_mask:0xf
    v_add_f32_dpp v241, v241, v241 row_ror:8 row_mask:0xf bank_mask:0xf
    v_add_f32_dpp v242, v242, v242 row_ror:8 row_mask:0xf bank_mask:0xf
    v_add_f32_dpp v243, v243, v243 row_ror:8 row_mask:0xf bank_mask:0xf
    v_add_f32_dpp v224, v224, v224 row_ror:4 row_mask:0xf bank_mask:0xf
    v_add_f32_dpp v225, v225, v225 row_ror:4 row_mask:0xf bank_mask:0xf
    v_add_f32_dpp v226, v226, v226 row_ror:4 row_mask:0xf bank_mask:0xf
    v_add_f32_dpp v227, v227, v227 row_ror:4 row_mask:0xf bank_mask:0xf
    v_add_f32_dpp v240, v240, v240 row_ror:4 row_mask:0xf bank_mask:0xf
    v_add_f32_dpp v241, v241, v241 row_ror:4 row_mask:0xf bank_mask:0xf
    v_add_f32_dpp v242, v242, v242 row_ror:4 row_mask:0xf bank_mask:0xf
    v_add_f32_dpp v243, v243, v243 row_ror:4 row_mask:0xf bank_mask:0xf
    v_add_f32_dpp v224, v224, v224 row_ror:2 row_mask:0xf bank_mask:0xf
    v_add_f32_dpp v225, v225, v225 row_ror:2 row_mask:0xf bank_mask:0xf
    v_add_f32_dpp v226, v226, v226 row_ror:2 row_mask:0xf bank_mask:0xf
    v_add_f32_dpp v227, v227, v227 row_ror:2 row_mask:0xf bank_mask:0xf
    v_add_f32_dpp v240, v240, v240 row_ror:2 row_mask:0xf bank_mask:0xf
    v_add_f32_dpp v241, v241, v241 row_ror:2 row_mask:0xf bank_mask:0xf
    v_add_f32_dpp v242, v242, v242 row_ror:2 row_mask:0xf bank_mask:0xf
    v_add_f32_dpp v243, v243, v243 row_ror:2 row_mask:0xf bank_mask:0xf
    v_add_f32_dpp v224, v224, v224 row_ror:1 row_mask:0xf bank_mask:0xf
    v_add_f32_dpp v225, v225, v225 row_ror:1 row_mask:0xf bank_mask:0xf
    v_add_f32_dpp v226, v226, v226 row_ror:1 row_mask:0xf bank_mask:0xf
    v_add_f32_dpp v227, v227, v227 row_ror:1 row_mask:0xf bank_mask:0xf
    v_add_f32_dpp v240, v240, v240 row_ror:1 row_mask:0xf bank_mask:0xf
    v_add_f32_dpp v241, v241, v241 row_ror:1 row_mask:0xf bank_mask:0xf
    v_add_f32_dpp v242, v242, v242 row_ror:1 row_mask:0xf bank_mask:0xf
    v_add_f32_dpp v243, v243, v243 row_ror:1 row_mask:0xf bank_mask:0xf
    v_mul_f32 v224, 0x3b000000, v224
    v_mul_f32 v225, 0x3b000000, v225
    v_mul_f32 v226, 0x3b000000, v226
    v_mul_f32 v227, 0x3b000000, v227
    v_mul_f32 v240, 0x3b000000, v240
    v_mul_f32 v241, 0x3b000000, v241
    v_mul_f32 v242, 0x3b000000, v242
    v_mul_f32 v243, 0x3b000000, v243
    v_fma_f32 v240, -v224, v224, v240
    v_fma_f32 v241, -v225, v225, v241
    v_fma_f32 v242, -v226, v226, v242
    v_fma_f32 v243, -v227, v227, v243
    v_max_f32 v240, 0, v240
    v_max_f32 v241, 0, v241
    v_max_f32 v242, 0, v242
    v_max_f32 v243, 0, v243
    v_add_f32 v240, 0x3727c5ac, v240
    v_add_f32 v241, 0x3727c5ac, v241
    v_add_f32 v242, 0x3727c5ac, v242
    v_add_f32 v243, 0x3727c5ac, v243
    v_rsq_f32 v240, v240
    v_rsq_f32 v241, v241
    v_rsq_f32 v242, v242
    v_rsq_f32 v243, v243
    v_mul_f32 v224, v224, -v240
    v_mul_f32 v225, v225, -v241
    v_mul_f32 v226, v226, -v242
    v_mul_f32 v227, v227, -v243
    s_waitcnt lgkmcnt(0)
    v_readlane_b32 s40, v240, 0
    v_readlane_b32 s41, v224, 0
    v_readlane_b32 s42, v241, 0
    v_readlane_b32 s43, v225, 0
    v_readlane_b32 s44, v242, 0
    v_readlane_b32 s45, v226, 0
    v_readlane_b32 s46, v243, 0
    v_readlane_b32 s47, v227, 0
    v_readlane_b32 s48, v240, 16
    v_readlane_b32 s49, v224, 16
    v_readlane_b32 s50, v241, 16
    v_readlane_b32 s51, v225, 16
    v_readlane_b32 s52, v242, 16
    v_readlane_b32 s53, v226, 16
    v_readlane_b32 s54, v243, 16
    v_readlane_b32 s55, v227, 16
    v_readlane_b32 s56, v240, 32
    v_readlane_b32 s57, v224, 32
    v_readlane_b32 s58, v241, 32
    v_readlane_b32 s59, v225, 32
    v_readlane_b32 s60, v242, 32
    v_readlane_b32 s61, v226, 32
    v_readlane_b32 s62, v243, 32
    v_readlane_b32 s63, v227, 32
    v_readlane_b32 s64, v240, 48
    v_readlane_b32 s65, v224, 48
    v_readlane_b32 s66, v241, 48
    v_readlane_b32 s67, v225, 48
    v_readlane_b32 s68, v242, 48
    v_readlane_b32 s69, v226, 48
    v_readlane_b32 s70, v243, 48
    v_readlane_b32 s71, v227, 48
    v_pk_fma_f32 v[64:65], v[64:65], s[40:41], s[40:41] op_sel:[0,0,1] op_sel_hi:[1,0,1]
    v_pk_fma_f32 v[66:67], v[66:67], s[40:41], s[40:41] op_sel:[0,0,1] op_sel_hi:[1,0,1]
    v_pk_fma_f32 v[68:69], v[68:69], s[40:41], s[40:41] op_sel:[0,0,1] op_sel_hi:[1,0,1]
    v_pk_fma_f32 v[70:71], v[70:71], s[40:41], s[40:41] op_sel:[0,0,1] op_sel_hi:[1,0,1]
    v_pk_fma_f32 v[72:73], v[72:73], s[42:43], s[42:43] op_sel:[0,0,1] op_sel_hi:[1,0,1]
    v_pk_fma_f32 v[74:75], v[74:75], s[42:43], s[42:43] op_sel:[0,0,1] op_sel_hi:[1,0,1]
    v_pk_fma_f32 v[76:77], v[76:77], s[42:43], s[42:43] op_sel:[0,0,1] op_sel_hi:[1,0,1]
    v_pk_fma_f32 v[78:79], v[78:79], s[42:43], s[42:43] op_sel:[0,0,1] op_sel_hi:[1,0,1]
    v_pk_fma_f32 v[80:81], v[80:81], s[44:45], s[44:45] op_sel:[0,0,1] op_sel_hi:[1,0,1]
    v_pk_fma_f32 v[82:83], v[82:83], s[44:45], s[44:45] op_sel:[0,0,1] op_sel_hi:[1,0,1]
    v_pk_fma_f32 v[84:85], v[84:85], s[44:45], s[44:45] op_sel:[0,0,1] op_sel_hi:[1,0,1]
    v_pk_fma_f32 v[86:87], v[86:87], s[44:45], s[44:45] op_sel:[0,0,1] op_sel_hi:[1,0,1]
    v_pk_fma_f32 v[88:89], v[88:89], s[46:47], s[46:47] op_sel:[0,0,1] op_sel_hi:[1,0,1]
    v_pk_fma_f32 v[90:91], v[90:91], s[46:47], s[46:47] op_sel:[0,0,1] op_sel_hi:[1,0,1]
    v_pk_fma_f32 v[92:93], v[92:93], s[46:47], s[46:47] op_sel:[0,0,1] op_sel_hi:[1,0,1]
    v_pk_fma_f32 v[94:95], v[94:95], s[46:47], s[46:47] op_sel:[0,0,1] op_sel_hi:[1,0,1]
    v_pk_fma_f32 v[96:97], v[96:97], s[48:49], s[48:49] op_sel:[0,0,1] op_sel_hi:[1,0,1]
    v_pk_fma_f32 v[98:99], v[98:99], s[48:49], s[48:49] op_sel:[0,0,1] op_sel_hi:[1,0,1]
    v_pk_fma_f32 v[100:101], v[100:101], s[48:49], s[48:49] op_sel:[0,0,1] op_sel_hi:[1,0,1]
    v_pk_fma_f32 v[102:103], v[102:103], s[48:49], s[48:49] op_sel:[0,0,1] op_sel_hi:[1,0,1]
    v_pk_fma_f32 v[104:105], v[104:105], s[50:51], s[50:51] op_sel:[0,0,1] op_sel_hi:[1,0,1]
    v_pk_fma_f32 v[106:107], v[106:107], s[50:51], s[50:51] op_sel:[0,0,1] op_sel_hi:[1,0,1]
    v_pk_fma_f32 v[108:109], v[108:109], s[50:51], s[50:51] op_sel:[0,0,1] op_sel_hi:[1,0,1]
    v_pk_fma_f32 v[110:111], v[110:111], s[50:51], s[50:51] op_sel:[0,0,1] op_sel_hi:[1,0,1]
    v_pk_fma_f32 v[112:113], v[112:113], s[52:53], s[52:53] op_sel:[0,0,1] op_sel_hi:[1,0,1]
    v_pk_fma_f32 v[114:115], v[114:115], s[52:53], s[52:53] op_sel:[0,0,1] op_sel_hi:[1,0,1]
    v_pk_fma_f32 v[116:117], v[116:117], s[52:53], s[52:53] op_sel:[0,0,1] op_sel_hi:[1,0,1]
    v_pk_fma_f32 v[118:119], v[118:119], s[52:53], s[52:53] op_sel:[0,0,1] op_sel_hi:[1,0,1]
    v_pk_fma_f32 v[120:121], v[120:121], s[54:55], s[54:55] op_sel:[0,0,1] op_sel_hi:[1,0,1]
    v_pk_fma_f32 v[122:123], v[122:123], s[54:55], s[54:55] op_sel:[0,0,1] op_sel_hi:[1,0,1]
    v_pk_fma_f32 v[124:125], v[124:125], s[54:55], s[54:55] op_sel:[0,0,1] op_sel_hi:[1,0,1]
    v_pk_fma_f32 v[126:127], v[126:127], s[54:55], s[54:55] op_sel:[0,0,1] op_sel_hi:[1,0,1]
    v_pk_fma_f32 v[128:129], v[128:129], s[56:57], s[56:57] op_sel:[0,0,1] op_sel_hi:[1,0,1]
    v_pk_fma_f32 v[130:131], v[130:131], s[56:57], s[56:57] op_sel:[0,0,1] op_sel_hi:[1,0,1]
    v_pk_fma_f32 v[132:133], v[132:133], s[56:57], s[56:57] op_sel:[0,0,1] op_sel_hi:[1,0,1]
    v_pk_fma_f32 v[134:135], v[134:135], s[56:57], s[56:57] op_sel:[0,0,1] op_sel_hi:[1,0,1]
    v_pk_fma_f32 v[136:137], v[136:137], s[58:59], s[58:59] op_sel:[0,0,1] op_sel_hi:[1,0,1]
    v_pk_fma_f32 v[138:139], v[138:139], s[58:59], s[58:59] op_sel:[0,0,1] op_sel_hi:[1,0,1]
    v_pk_fma_f32 v[140:141], v[140:141], s[58:59], s[58:59] op_sel:[0,0,1] op_sel_hi:[1,0,1]
    v_pk_fma_f32 v[142:143], v[142:143], s[58:59], s[58:59] op_sel:[0,0,1] op_sel_hi:[1,0,1]
    v_pk_fma_f32 v[144:145], v[144:145], s[60:61], s[60:61] op_sel:[0,0,1] op_sel_hi:[1,0,1]
    v_pk_fma_f32 v[146:147], v[146:147], s[60:61], s[60:61] op_sel:[0,0,1] op_sel_hi:[1,0,1]
    v_pk_fma_f32 v[148:149], v[148:149], s[60:61], s[60:61] op_sel:[0,0,1] op_sel_hi:[1,0,1]
    v_pk_fma_f32 v[150:151], v[150:151], s[60:61], s[60:61] op_sel:[0,0,1] op_sel_hi:[1,0,1]
    v_pk_fma_f32 v[152:153], v[152:153], s[62:63], s[62:63] op_sel:[0,0,1] op_sel_hi:[1,0,1]
    v_pk_fma_f32 v[154:155], v[154:155], s[62:63], s[62:63] op_sel:[0,0,1] op_sel_hi:[1,0,1]
    v_pk_fma_f32 v[156:157], v[156:157], s[62:63], s[62:63] op_sel:[0,0,1] op_sel_hi:[1,0,1]
    v_pk_fma_f32 v[158:159], v[158:159], s[62:63], s[62:63] op_sel:[0,0,1] op_sel_hi:[1,0,1]
    v_pk_fma_f32 v[160:161], v[160:161], s[64:65], s[64:65] op_sel:[0,0,1] op_sel_hi:[1,0,1]
    v_pk_fma_f32 v[162:163], v[162:163], s[64:65], s[64:65] op_sel:[0,0,1] op_sel_hi:[1,0,1]
    v_pk_fma_f32 v[164:165], v[164:165], s[64:65], s[64:65] op_sel:[0,0,1] op_sel_hi:[1,0,1]
    v_pk_fma_f32 v[166:167], v[166:167], s[64:65], s[64:65] op_sel:[0,0,1] op_sel_hi:[1,0,1]
    v_pk_fma_f32 v[168:169], v[168:169], s[66:67], s[66:67] op_sel:[0,0,1] op_sel_hi:[1,0,1]
    v_pk_fma_f32 v[170:171], v[170:171], s[66:67], s[66:67] op_sel:[0,0,1] op_sel_hi:[1,0,1]
    v_pk_fma_f32 v[172:173], v[172:173], s[66:67], s[66:67] op_sel:[0,0,1] op_sel_hi:[1,0,1]
    v_pk_fma_f32 v[174:175], v[174:175], s[66:67], s[66:67] op_sel:[0,0,1] op_sel_hi:[1,0,1]
    v_pk_fma_f32 v[176:177], v[176:177], s[68:69], s[68:69] op_sel:[0,0,1] op_sel_hi:[1,0,1]
    v_pk_fma_f32 v[178:179], v[178:179], s[68:69], s[68:69] op_sel:[0,0,1] op_sel_hi:[1,0,1]
    v_pk_fma_f32 v[180:181], v[180:181], s[68:69], s[68:69] op_sel:[0,0,1] op_sel_hi:[1,0,1]
    v_pk_fma_f32 v[182:183], v[182:183], s[68:69], s[68:69] op_sel:[0,0,1] op_sel_hi:[1,0,1]
    v_pk_fma_f32 v[184:185], v[184:185], s[70:71], s[70:71] op_sel:[0,0,1] op_sel_hi:[1,0,1]
    v_pk_fma_f32 v[186:187], v[186:187], s[70:71], s[70:71] op_sel:[0,0,1] op_sel_hi:[1,0,1]
    v_pk_fma_f32 v[188:189], v[188:189], s[70:71], s[70:71] op_sel:[0,0,1] op_sel_hi:[1,0,1]
    v_pk_fma_f32 v[190:191], v[190:191], s[70:71], s[70:71] op_sel:[0,0,1] op_sel_hi:[1,0,1]
    s_waitcnt vmcnt(22)
    ds_read_b128 v[208:211], v10 offset:0
    ds_read_b128 v[212:215], v11 offset:0
    ds_read_b128 v[216:219], v12 offset:0
    ds_read_b128 v[220:223], v13 offset:0
    s_waitcnt vmcnt(18)
    ds_read_b128 v[224:227], v10 offset:4096
    ds_read_b128 v[228:231], v11 offset:4096
    ds_read_b128 v[232:235], v12 offset:4096
    ds_read_b128 v[236:239], v13 offset:4096
    s_waitcnt vmcnt(14)
    ds_read_b128 v[240:243], v10 offset:8192
    ds_read_b128 v[244:247], v11 offset:8192
    ds_read_b128 v[248:251], v12 offset:8192
    ds_read_b128 v[252:255], v13 offset:8192
    s_mov_b32 s37, 0x04000c0c
    s_mov_b32 s38, 0x0706000c
    s_cmp_ge_u32 s3, 2
    s_cselect_b32 s40, 1.0, 0
    s_lshl_b32 s41, s3, 10
    s_add_u32 s41, s41, 149504
    v_add_u32 v22, s41, v1
    v_lshlrev_b32 v23, 5, v0
    v_add_u32 v23, 149504, v23
    s_waitcnt vmcnt(8)
    v_xor_b32 v52, v32, v39
    v_xor_b32 v53, v33, v43
    v_xor_b32 v54, v34, v47
    v_xor_b32 v55, v35, v51
    v_and_b32 v56, v32, v33
    v_and_b32 v57, v34, v35
    v_or3_b32 v52, v52, v53, v54
    v_and_b32 v56, v56, v57
    v_and_b32 v56, v56, v30
    v_not_b32 v56, v56
    v_and_b32 v56, 1, v56
    v_or3_b32 v52, v52, v55, v56
    v_cmp_ne_u32 vcc, 0, v52
    s_nop 3
    s_cbranch_vccnz MG_19
MGD_20:
    s_load_dwordx4 s[48:51], s[0:1], 64
    v_lshrrev_b32 v28, 1, v0
    v_and_b32 v27, 1, v0
    v_lshlrev_b32 v27, 7, v27
    v_lshl_add_u32 v28, v28, 12, v27
    v_readfirstlane_b32 s24, v30
    v_perm_b32 v32, v38, v37, s37
    v_perm_b32 v33, v42, v41, s37
    v_perm_b32 v34, v46, v45, s37
    v_perm_b32 v35, v50, v49, s37
    v_perm_b32 v39, v32, v36, s38
    v_perm_b32 v43, v33, v40, s38
    v_perm_b32 v47, v34, v44, s38
    v_perm_b32 v51, v35, v48, s38
    v_add_f32 v36, v36, v40
    v_add_f32 v37, v37, v41
    v_add_f32 v38, v38, v42
    v_add_f32 v39, v39, v43
    v_add_f32 v44, v44, v48
    v_add_f32 v45, v45, v49
    v_add_f32 v46, v46, v50
    v_add_f32 v47, v47, v51
    v_add_f32 v36, v36, v44
    v_add_f32 v37, v37, v45
    v_add_f32 v38, v38, v46
    v_add_f32 v39, v39, v47
    v_cvt_pk_bf16_f32 v40, v36, v37
    v_cvt_pk_bf16_f32 v41, v38, v39
    v_lshlrev_b32 v36, 16, v40
    v_and_b32 v37, 0xffff0000, v40
    v_lshlrev_b32 v38, 16, v41
    v_and_b32 v39, 0xffff0000, v41
    v_add_f32 v36, s40, v36
    v_add_f32 v37, s40, v37
    v_add_f32 v38, s40, v38
    v_add_f32 v39, s40, v39
    v_cvt_pk_bf16_f32 v40, v36, v37
    v_cvt_pk_bf16_f32 v41, v38, v39
    v_lshlrev_b32 v36, 16, v40
    v_and_b32 v37, 0xffff0000, v40
    v_lshlrev_b32 v38, 16, v41
    v_and_b32 v39, 0xffff0000, v41
    ds_write_b128 v22, v[36:39]
NOLATE_21:
    s_waitcnt lgkmcnt(9)
    s_add_u32 m0, s30, 0
    s_xor_b32 s36, s20, 1536
    buffer_load_dwordx4 v2, s[12:15], s36 offen offset:0  lds
    buffer_load_dwordx4 v3, s[12:15], s36 offen offset:1024  lds
    buffer_load_dwordx4 v4, s[12:15], s36 offen offset:2048  lds
    buffer_load_dwordx4 v5, s[12:15], s36 offen offset:3072  lds
    s_waitcnt lgkmcnt(5)
    s_add_u32 m0, s30, 4096
    s_xor_b32 s36, s20, 1664
    buffer_load_dwordx4 v2, s[12:15], s36 offen offset:0  lds
    buffer_load_dwordx4 v3, s[12:15], s36 offen offset:1024  lds
    buffer_load_dwordx4 v4, s[12:15], s36 offen offset:2048  lds
    buffer_load_dwordx4 v5, s[12:15], s36 offen offset:3072  lds
    s_waitcnt lgkmcnt(0)
    s_barrier
    ds_read_b128 v[56:59], v23 offset:0
    ds_read_b128 v[60:63], v23 offset:16
    ds_read_b128 v[48:51], v23 offset:2048
    ds_read_b128 v[52:55], v23 offset:2064
    s_lshl_b32 s36, s26, 2
    s_add_u32 s36, s36, s27
    s_lshl_b32 s44, s36, 2
    s_add_u32 s44, s44, s3
    s_lshl_b32 s44, s44, 4
    s_add_u32 s44, s44, s29
    s_lshl_b32 s44, s44, 1
    s_lshr_b32 s37, s27, 1
    s_mul_i32 s37, s37, 1
    s_add_u32 s44, s44, s37
    s_lshl_b32 s44, s44, 11
    s_xor_b32 s45, s44, 2048
    s_lshl_b32 s46, s36, 6
    s_add_u32 s46, s46, s29
    s_lshl_b32 s46, s46, 2
    s_add_u32 s46, s46, 25755648
    s_cmp_lt_u32 s26, 2
    s_cselect_b32 s47, 0, 0x80008000
    s_waitcnt lgkmcnt(0)
    v_pk_fma_f32 v[64:65], v[64:65], v[48:49], v[56:57]
    v_pk_fma_f32 v[66:67], v[66:67], v[50:51], v[58:59]
    v_pk_fma_f32 v[68:69], v[68:69], v[52:53], v[60:61]
    v_pk_fma_f32 v[70:71], v[70:71], v[54:55], v[62:63]
    v_cvt_pk_bf16_f32 v64, v64, v65
    v_cvt_pk_bf16_f32 v65, v66, v67
    v_cvt_pk_bf16_f32 v66, v68, v69
    v_cvt_pk_bf16_f32 v67, v70, v71
    v_xor_b32 v68, 0, v31
    ds_write_b128 v68, v[64:67] offset:0
    v_pk_fma_f32 v[72:73], v[72:73], v[48:49], v[56:57]
    v_pk_fma_f32 v[74:75], v[74:75], v[50:51], v[58:59]
    v_pk_fma_f32 v[76:77], v[76:77], v[52:53], v[60:61]
    v_pk_fma_f32 v[78:79], v[78:79], v[54:55], v[62:63]
    v_cvt_pk_bf16_f32 v72, v72, v73
    v_cvt_pk_bf16_f32 v73, v74, v75
    v_cvt_pk_bf16_f32 v74, v76, v77
    v_cvt_pk_bf16_f32 v75, v78, v79
    v_xor_b32 v76, 1040, v31
    ds_write_b128 v76, v[72:75] offset:0
    v_pk_fma_f32 v[80:81], v[80:81], v[48:49], v[56:57]
    v_pk_fma_f32 v[82:83], v[82:83], v[50:51], v[58:59]
    v_pk_fma_f32 v[84:85], v[84:85], v[52:53], v[60:61]
    v_pk_fma_f32 v[86:87], v[86:87], v[54:55], v[62:63]
    v_cvt_pk_bf16_f32 v80, v80, v81
    v_cvt_pk_bf16_f32 v81, v82, v83
    v_cvt_pk_bf16_f32 v82, v84, v85
    v_cvt_pk_bf16_f32 v83, v86, v87
    v_xor_b32 v84, 2080, v31
    ds_write_b128 v84, v[80:83] offset:0
    v_pk_fma_f32 v[88:89], v[88:89], v[48:49], v[56:57]
    v_pk_fma_f32 v[90:91], v[90:91], v[50:51], v[58:59]
    v_pk_fma_f32 v[92:93], v[92:93], v[52:53], v[60:61]
    v_pk_fma_f32 v[94:95], v[94:95], v[54:55], v[62:63]
    v_cvt_pk_bf16_f32 v88, v88, v89
    v_cvt_pk_bf16_f32 v89, v90, v91
    v_cvt_pk_bf16_f32 v90, v92, v93
    v_cvt_pk_bf16_f32 v91, v94, v95
    v_xor_b32 v92, 3120, v31
    ds_write_b128 v92, v[88:91] offset:0
    v_pk_fma_f32 v[96:97], v[96:97], v[48:49], v[56:57]
    v_pk_fma_f32 v[98:99], v[98:99], v[50:51], v[58:59]
    v_pk_fma_f32 v[100:101], v[100:101], v[52:53], v[60:61]
    v_pk_fma_f32 v[102:103], v[102:103], v[54:55], v[62:63]
    v_cvt_pk_bf16_f32 v96, v96, v97
    v_cvt_pk_bf16_f32 v97, v98, v99
    v_cvt_pk_bf16_f32 v98, v100, v101
    v_cvt_pk_bf16_f32 v99, v102, v103
    v_xor_b32 v100, 4160, v31
    ds_write_b128 v100, v[96:99] offset:0
    v_pk_fma_f32 v[104:105], v[104:105], v[48:49], v[56:57]
    v_pk_fma_f32 v[106:107], v[106:107], v[50:51], v[58:59]
    v_pk_fma_f32 v[108:109], v[108:109], v[52:53], v[60:61]
    v_pk_fma_f32 v[110:111], v[110:111], v[54:55], v[62:63]
    v_cvt_pk_bf16_f32 v104, v104, v105
    v_cvt_pk_bf16_f32 v105, v106, v107
    v_cvt_pk_bf16_f32 v106, v108, v109
    v_cvt_pk_bf16_f32 v107, v110, v111
    v_xor_b32 v108, 5200, v31
    ds_write_b128 v108, v[104:107] offset:0
    v_pk_fma_f32 v[112:113], v[112:113], v[48:49], v[56:57]
    v_pk_fma_f32 v[114:115], v[114:115], v[50:51], v[58:59]
    v_pk_fma_f32 v[116:117], v[116:117], v[52:53], v[60:61]
    v_pk_fma_f32 v[118:119], v[118:119], v[54:55], v[62:63]
    v_cvt_pk_bf16_f32 v112, v112, v113
    v_cvt_pk_bf16_f32 v113, v114, v115
    v_cvt_pk_bf16_f32 v114, v116, v117
    v_cvt_pk_bf16_f32 v115, v118, v119
    v_xor_b32 v116, 6240, v31
    ds_write_b128 v116, v[112:115] offset:0
    v_pk_fma_f32 v[120:121], v[120:121], v[48:49], v[56:57]
    v_pk_fma_f32 v[122:123], v[122:123], v[50:51], v[58:59]
    v_pk_fma_f32 v[124:125], v[124:125], v[52:53], v[60:61]
    v_pk_fma_f32 v[126:127], v[126:127], v[54:55], v[62:63]
    v_cvt_pk_bf16_f32 v120, v120, v121
    v_cvt_pk_bf16_f32 v121, v122, v123
    v_cvt_pk_bf16_f32 v122, v124, v125
    v_cvt_pk_bf16_f32 v123, v126, v127
    v_xor_b32 v124, 7280, v31
    ds_write_b128 v124, v[120:123] offset:0
    s_waitcnt lgkmcnt(0)
    s_barrier
    ds_read_b128 v[80:83], v14 offset:0
    ds_read_b128 v[84:87], v15 offset:256
    ds_read_b128 v[88:91], v16 offset:512
    ds_read_b128 v[92:95], v17 offset:768
    ds_read_b128 v[96:99], v15 offset:0
    ds_read_b128 v[100:103], v14 offset:256
    s_waitcnt lgkmcnt(5)
    v_mfma_f32_32x32x16_bf16 v[32:47], v[80:83], a[192:195], 0
    ds_read_b128 v[104:107], v17 offset:512
    v_fma_f32 v128, v128, v48, v56
    v_fma_f32 v129, v129, v49, v57
    v_fma_f32 v130, v130, v50, v58
    v_fma_f32 v131, v131, v51, v59
    v_fma_f32 v132, v132, v52, v60
    s_waitcnt lgkmcnt(5)
    v_mfma_f32_32x32x16_bf16 v[32:47], v[84:87], a[196:199], v[32:47]
    ds_read_b128 v[108:111], v16 offset:768
    v_fma_f32 v133, v133, v53, v61
    v_fma_f32 v134, v134, v54, v62
    v_fma_f32 v135, v135, v55, v63
    v_cvt_pk_bf16_f32 v128, v128, v129
    v_cvt_pk_bf16_f32 v129, v130, v131
    s_waitcnt lgkmcnt(5)
    v_mfma_f32_32x32x16_bf16 v[32:47], v[88:91], a[200:203], v[32:47]
    ds_read_b128 v[80:83], v16 offset:0
    v_cvt_pk_bf16_f32 v130, v132, v133
    v_cvt_pk_bf16_f32 v131, v134, v135
    v_xor_b32 v132, 0, v31
    ds_write_b128 v132, v[128:131] offset:32768
    v_fma_f32 v136, v136, v48, v56
    s_waitcnt lgkmcnt(6)
    v_mfma_f32_32x32x16_bf16 v[32:47], v[92:95], a[204:207], v[32:47]
    ds_read_b128 v[84:87], v17 offset:256
    v_fma_f32 v137, v137, v49, v57
    v_fma_f32 v138, v138, v50, v58
    v_fma_f32 v139, v139, v51, v59
    v_fma_f32 v140, v140, v52, v60
    v_fma_f32 v141, v141, v53, v61
    s_waitcnt lgkmcnt(6)
    v_mfma_f32_32x32x16_bf16 v[32:47], v[96:99], a[208:211], v[32:47]
    ds_read_b128 v[88:91], v14 offset:512
    v_fma_f32 v142, v142, v54, v62
    v_fma_f32 v143, v143, v55, v63
    v_cvt_pk_bf16_f32 v136, v136, v137
    v_cvt_pk_bf16_f32 v137, v138, v139
    v_cvt_pk_bf16_f32 v138, v140, v141
    s_waitcnt lgkmcnt(6)
    v_mfma_f32_32x32x16_bf16 v[32:47], v[100:103], a[212:215], v[32:47]
    ds_read_b128 v[92:95], v15 offset:768
    v_cvt_pk_bf16_f32 v139, v142, v143
    v_xor_b32 v140, 1040, v31
    ds_write_b128 v140, v[136:139] offset:32768
    v_fma_f32 v144, v144, v48, v56
    v_fma_f32 v145, v145, v49, v57
    s_waitcnt lgkmcnt(7)
    v_mfma_f32_32x32x16_bf16 v[32:47], v[104:107], a[216:219], v[32:47]
    ds_read_b128 v[96:99], v17 offset:0
    v_fma_f32 v146, v146, v50, v58
    v_fma_f32 v147, v147, v51, v59
    v_fma_f32 v148, v148, v52, v60
    v_fma_f32 v149, v149, v53, v61
    v_fma_f32 v150, v150, v54, v62
    s_waitcnt lgkmcnt(7)
    v_mfma_f32_32x32x16_bf16 v[32:47], v[108:111], a[220:223], v[32:47]
    ds_read_b128 v[100:103], v16 offset:256
    v_fma_f32 v151, v151, v55, v63
    v_cvt_pk_bf16_f32 v144, v144, v145
    v_cvt_pk_bf16_f32 v145, v146, v147
    v_cvt_pk_bf16_f32 v146, v148, v149
    v_cvt_pk_bf16_f32 v147, v150, v151
    s_waitcnt lgkmcnt(7)
    v_mfma_f32_32x32x16_bf16 v[32:47], v[80:83], a[224:227], v[32:47]
    ds_read_b128 v[104:107], v15 offset:512
    v_xor_b32 v148, 2080, v31
    ds_write_b128 v148, v[144:147] offset:32768
    v_fma_f32 v152, v152, v48, v56
    v_fma_f32 v153, v153, v49, v57
    v_fma_f32 v154, v154, v50, v58
    s_waitcnt lgkmcnt(7)
    v_mfma_f32_32x32x16_bf16 v[32:47], v[84:87], a[228:231], v[32:47]
    ds_read_b128 v[108:111], v14 offset:768
    v_fma_f32 v155, v155, v51, v59
    v_fma_f32 v156, v156, v52, v60
    v_fma_f32 v157, v157, v53, v61
    v_fma_f32 v158, v158, v54, v62
    v_fma_f32 v159, v159, v55, v63
    s_waitcnt lgkmcnt(7)
    v_mfma_f32_32x32x16_bf16 v[32:47], v[88:91], a[232:235], v[32:47]
    ds_read_b128 v[80:83], v18 offset:0
    v_cvt_pk_bf16_f32 v152, v152, v153
    v_cvt_pk_bf16_f32 v153, v154, v155
    v_cvt_pk_bf16_f32 v154, v156, v157
    v_cvt_pk_bf16_f32 v155, v158, v159
    v_xor_b32 v156, 3120, v31
    s_waitcnt lgkmcnt(7)
    v_mfma_f32_32x32x16_bf16 v[32:47], v[92:95], a[236:239], v[32:47]
    ds_read_b128 v[84:87], v19 offset:256
    ds_write_b128 v156, v[152:155] offset:32768
    v_fma_f32 v160, v160, v48, v56
    v_fma_f32 v161, v161, v49, v57
    v_fma_f32 v162, v162, v50, v58
    v_fma_f32 v163, v163, v51, v59
    s_waitcnt lgkmcnt(7)
    v_mfma_f32_32x32x16_bf16 v[32:47], v[96:99], a[240:243], v[32:47]
    ds_read_b128 v[88:91], v20 offset:512
    v_fma_f32 v164, v164, v52, v60
    v_fma_f32 v165, v165, v53, v61
    v_fma_f32 v166, v166, v54, v62
    v_fma_f32 v167, v167, v55, v63
    v_cvt_pk_bf16_f32 v160, v160, v161
    s_waitcnt lgkmcnt(7)
    v_mfma_f32_32x32x16_bf16 v[32:47], v[100:103], a[244:247], v[32:47]
    ds_read_b128 v[92:95], v21 offset:768
    v_cvt_pk_bf16_f32 v161, v162, v163
    v_cvt_pk_bf16_f32 v162, v164, v165
    v_cvt_pk_bf16_f32 v163, v166, v167
    v_xor_b32 v164, 4160, v31
    ds_write_b128 v164, v[160:163] offset:32768
    s_waitcnt lgkmcnt(8)
    v_mfma_f32_32x32x16_bf16 v[32:47], v[104:107], a[248:251], v[32:47]
    ds_read_b128 v[96:99], v19 offset:0
    v_fma_f32 v168, v168, v48, v56
    v_fma_f32 v169, v169, v49, v57
    v_fma_f32 v170, v170, v50, v58
    v_fma_f32 v171, v171, v51, v59
    v_fma_f32 v172, v172, v52, v60
    s_waitcnt lgkmcnt(7)
    v_mfma_f32_32x32x16_bf16 v[32:47], v[108:111], a[252:255], v[32:47]
    ds_read_b128 v[100:103], v18 offset:256
    v_fma_f32 v173, v173, v53, v61
    v_fma_f32 v174, v174, v54, v62
    v_fma_f32 v175, v175, v55, v63
    v_cvt_pk_bf16_f32 v168, v168, v169
    v_cvt_pk_bf16_f32 v169, v170, v171
    s_waitcnt lgkmcnt(7)
    v_mfma_f32_32x32x16_bf16 v[32:47], v[80:83], v[192:195], v[32:47]
    ds_read_b128 v[104:107], v21 offset:512
    s_waitcnt vmcnt(12)
    ds_read_b128 a[0:3], v10 offset:12288
    ds_read_b128 a[4:7], v11 offset:12288
    ds_read_b128 a[8:11], v12 offset:12288
    ds_read_b128 a[12:15], v13 offset:12288
    s_waitcnt vmcnt(8)
    ds_read_b128 a[16:19], v10 offset:16384
    s_waitcnt lgkmcnt(12)
    v_mfma_f32_32x32x16_bf16 v[32:47], v[84:87], v[196:199], v[32:47]
    ds_read_b128 v[108:111], v20 offset:768
    ds_read_b128 a[20:23], v11 offset:16384
    ds_read_b128 a[24:27], v12 offset:16384
    ds_read_b128 a[28:31], v13 offset:16384
    v_cvt_pk_bf16_f32 v170, v172, v173
    v_cvt_pk_bf16_f32 v171, v174, v175
    s_waitcnt lgkmcnt(14)
    v_mfma_f32_32x32x16_bf16 v[32:47], v[88:91], v[200:203], v[32:47]
    ds_read_b128 v[80:83], v20 offset:0
    v_xor_b32 v172, 5200, v31
    ds_write_b128 v172, v[168:171] offset:32768
    v_fma_f32 v176, v176, v48, v56
    v_fma_f32 v177, v177, v49, v57
    v_fma_f32 v178, v178, v50, v58
    s_waitcnt lgkmcnt(15)
    v_mfma_f32_32x32x16_bf16 v[32:47], v[92:95], v[204:207], v[32:47]
    ds_read_b128 v[84:87], v21 offset:256
    v_fma_f32 v179, v179, v51, v59
    v_fma_f32 v180, v180, v52, v60
    v_fma_f32 v181, v181, v53, v61
    v_fma_f32 v182, v182, v54, v62
    v_fma_f32 v183, v183, v55, v63
    s_waitcnt lgkmcnt(14)
    v_mfma_f32_32x32x16_bf16 v[32:47], v[96:99], v[208:211], v[32:47]
    ds_read_b128 v[88:91], v18 offset:512
    s_add_u32 m0, s30, 8192
    s_xor_b32 s36, s20, 768
    buffer_load_dwordx4 v2, s[12:15], s36 offen offset:0  lds
    v_cvt_pk_bf16_f32 v176, v176, v177
    v_cvt_pk_bf16_f32 v177, v178, v179
    s_waitcnt lgkmcnt(14)
    v_mfma_f32_32x32x16_bf16 v[32:47], v[100:103], v[212:215], v[32:47]
    ds_read_b128 v[92:95], v19 offset:768
    v_cvt_pk_bf16_f32 v178, v180, v181
    v_cvt_pk_bf16_f32 v179, v182, v183
    v_xor_b32 v180, 6240, v31
    ds_write_b128 v180, v[176:179] offset:32768
    v_fma_f32 v184, v184, v48, v56
    s_waitcnt lgkmcnt(15)
    v_mfma_f32_32x32x16_bf16 v[32:47], v[104:107], v[216:219], v[32:47]
    ds_read_b128 v[96:99], v21 offset:0
    s_add_u32 m0, s30, 8192
    s_xor_b32 s36, s20, 768
    buffer_load_dwordx4 v3, s[12:15], s36 offen offset:1024  lds
    v_fma_f32 v185, v185, v49, v57
    v_fma_f32 v186, v186, v50, v58
    s_waitcnt lgkmcnt(10)
    v_mfma_f32_32x32x16_bf16 v[32:47], v[108:111], v[220:223], v[32:47]
    ds_read_b128 v[100:103], v20 offset:256
    v_fma_f32 v187, v187, v51, v59
    v_fma_f32 v188, v188, v52, v60
    v_fma_f32 v189, v189, v53, v61
    v_fma_f32 v190, v190, v54, v62
    v_fma_f32 v191, v191, v55, v63
    s_waitcnt lgkmcnt(7)
    v_mfma_f32_32x32x16_bf16 v[32:47], v[80:83], v[224:227], v[32:47]
    ds_read_b128 v[104:107], v19 offset:512
    s_add_u32 m0, s30, 8192
    s_xor_b32 s36, s20, 768
    buffer_load_dwordx4 v4, s[12:15], s36 offen offset:2048  lds
    v_cvt_pk_bf16_f32 v184, v184, v185
    v_cvt_pk_bf16_f32 v185, v186, v187
    s_waitcnt lgkmcnt(6)
    v_mfma_f32_32x32x16_bf16 v[32:47], v[84:87], v[228:231], v[32:47]
    ds_read_b128 v[108:111], v18 offset:768
    v_cvt_pk_bf16_f32 v186, v188, v189
    v_cvt_pk_bf16_f32 v187, v190, v191
    v_xor_b32 v188, 7280, v31
    ds_write_b128 v188, v[184:187] offset:32768
    s_waitcnt lgkmcnt(7)
    v_mfma_f32_32x32x16_bf16 v[32:47], v[88:91], v[232:235], v[32:47]
    s_waitcnt lgkmcnt(0)
    s_barrier
    ds_read_b128 v[80:83], v14 offset:32768
    s_add_u32 m0, s30, 8192
    s_xor_b32 s36, s20, 768
    buffer_load_dwordx4 v5, s[12:15], s36 offen offset:3072  lds
    v_mfma_f32_32x32x16_bf16 v[32:47], v[92:95], v[236:239], v[32:47]
    ds_read_b128 v[84:87], v15 offset:33024
    v_mfma_f32_32x32x16_bf16 v[32:47], v[96:99], v[240:243], v[32:47]
    ds_read_b128 v[88:91], v16 offset:33280
    s_add_u32 m0, s30, 12288
    s_xor_b32 s36, s20, 896
    buffer_load_dwordx4 v2, s[12:15], s36 offen offset:0  lds
    v_mfma_f32_32x32x16_bf16 v[32:47], v[100:103], v[244:247], v[32:47]
    ds_read_b128 v[92:95], v17 offset:33536
    v_mfma_f32_32x32x16_bf16 v[32:47], v[104:107], v[248:251], v[32:47]
    ds_read_b128 v[96:99], v15 offset:32768
    s_add_u32 m0, s30, 12288
    s_xor_b32 s36, s20, 896
    buffer_load_dwordx4 v3, s[12:15], s36 offen offset:1024  lds
    v_mfma_f32_32x32x16_bf16 v[32:47], v[108:111], v[252:255], v[32:47]
    ds_read_b128 v[100:103], v14 offset:33024
    s_waitcnt lgkmcnt(5)
    v_mfma_f32_32x32x16_bf16 v[64:79], v[80:83], a[192:195], 0
    ds_read_b128 v[104:107], v17 offset:33280
    s_add_u32 m0, s30, 12288
    s_xor_b32 s36, s20, 896
    buffer_load_dwordx4 v4, s[12:15], s36 offen offset:2048  lds
    s_waitcnt lgkmcnt(5)
    v_mfma_f32_32x32x16_bf16 v[64:79], v[84:87], a[196:199], v[64:79]
    ds_read_b128 v[108:111], v16 offset:33536
    s_nop 1
    v_cvt_pk_bf16_f32 v32, v32, v33
    v_cvt_pk_bf16_f32 v33, v34, v35
    v_cvt_pk_bf16_f32 v34, v36, v37
    v_cvt_pk_bf16_f32 v35, v38, v39
    v_cvt_pk_bf16_f32 v36, v40, v41
    s_waitcnt lgkmcnt(5)
    v_mfma_f32_32x32x16_bf16 v[64:79], v[88:91], a[200:203], v[64:79]
    ds_read_b128 v[80:83], v16 offset:32768
    s_add_u32 m0, s30, 12288
    s_xor_b32 s36, s20, 896
    buffer_load_dwordx4 v5, s[12:15], s36 offen offset:3072  lds
    v_cvt_pk_bf16_f32 v37, v42, v43
    v_cvt_pk_bf16_f32 v38, v44, v45
    s_waitcnt lgkmcnt(5)
    v_mfma_f32_32x32x16_bf16 v[64:79], v[92:95], a[204:207], v[64:79]
    ds_read_b128 v[84:87], v17 offset:33024
    v_cvt_pk_bf16_f32 v39, v46, v47
    v_xor_b32 v32, s47, v32
    v_xor_b32 v33, s47, v33
    v_xor_b32 v34, s47, v34
    v_xor_b32 v35, s47, v35
    s_waitcnt lgkmcnt(5)
    v_mfma_f32_32x32x16_bf16 v[64:79], v[96:99], a[208:211], v[64:79]
    ds_read_b128 v[88:91], v14 offset:33280
    s_add_u32 m0, s30, 16384
    s_xor_b32 s36, s20, 0
    buffer_load_dwordx4 v2, s[12:15], s36 offen offset:0  lds
    v_xor_b32 v36, s47, v36
    v_xor_b32 v37, s47, v37
    s_waitcnt lgkmcnt(5)
    v_mfma_f32_32x32x16_bf16 v[64:79], v[100:103], a[212:215], v[64:79]
    ds_read_b128 v[92:95], v15 offset:33536
    v_xor_b32 v38, s47, v38
    v_xor_b32 v39, s47, v39
    s_waitcnt lgkmcnt(5)
    v_mfma_f32_32x32x16_bf16 v[64:79], v[104:107], a[216:219], v[64:79]
    ds_read_b128 v[96:99], v17 offset:32768
    s_add_u32 m0, s30, 16384
    s_xor_b32 s36, s20, 0
    buffer_load_dwordx4 v3, s[12:15], s36 offen offset:1024  lds
    s_waitcnt lgkmcnt(5)
    v_mfma_f32_32x32x16_bf16 v[64:79], v[108:111], a[220:223], v[64:79]
    ds_read_b128 v[100:103], v16 offset:33024
    s_waitcnt lgkmcnt(5)
    v_mfma_f32_32x32x16_bf16 v[64:79], v[80:83], a[224:227], v[64:79]
    ds_read_b128 v[104:107], v15 offset:33280
    s_add_u32 m0, s30, 16384
    s_xor_b32 s36, s20, 0
    buffer_load_dwordx4 v4, s[12:15], s36 offen offset:2048  lds
    s_waitcnt lgkmcnt(5)
    v_mfma_f32_32x32x16_bf16 v[64:79], v[84:87], a[228:231], v[64:79]
    ds_read_b128 v[108:111], v14 offset:33536
    s_waitcnt lgkmcnt(5)
    v_mfma_f32_32x32x16_bf16 v[64:79], v[88:91], a[232:235], v[64:79]
    ds_read_b128 v[80:83], v18 offset:32768
    s_add_u32 m0, s30, 16384
    s_xor_b32 s36, s20, 0
    buffer_load_dwordx4 v5, s[12:15], s36 offen offset:3072  lds
    s_waitcnt lgkmcnt(5)
    v_mfma_f32_32x32x16_bf16 v[64:79], v[92:95], a[236:239], v[64:79]
    ds_read_b128 v[84:87], v19 offset:33024
    s_waitcnt lgkmcnt(5)
    v_mfma_f32_32x32x16_bf16 v[64:79], v[96:99], a[240:243], v[64:79]
    ds_read_b128 v[88:91], v20 offset:33280
    buffer_store_dwordx4 v[32:35], v1, s[4:7], s44 offen offset:0 sc1
    s_waitcnt vmcnt(17)
    ds_read_b128 a[128:131], v10 offset:0
    ds_read_b128 a[132:135], v11 offset:0
    s_waitcnt lgkmcnt(7)
    v_mfma_f32_32x32x16_bf16 v[64:79], v[100:103], a[244:247], v[64:79]
    ds_read_b128 v[92:95], v21 offset:33536
    ds_read_b128 a[136:139], v12 offset:0
    ds_read_b128 a[140:143], v13 offset:0
    s_waitcnt vmcnt(13)
    ds_read_b128 a[144:147], v10 offset:4096
    ds_read_b128 a[148:151], v11 offset:4096
    ds_read_b128 a[152:155], v12 offset:4096
    s_waitcnt lgkmcnt(12)
    v_mfma_f32_32x32x16_bf16 v[64:79], v[104:107], a[248:251], v[64:79]
    ds_read_b128 v[96:99], v19 offset:32768
    buffer_store_dwordx4 v[36:39], v1, s[4:7], s44 offen offset:1024 sc1
    ds_read_b128 a[156:159], v13 offset:4096
    s_waitcnt lgkmcnt(13)
    v_mfma_f32_32x32x16_bf16 v[64:79], v[108:111], a[252:255], v[64:79]
    ds_read_b128 v[100:103], v18 offset:33024
    s_waitcnt lgkmcnt(13)
    v_mfma_f32_32x32x16_bf16 v[64:79], v[80:83], v[192:195], v[64:79]
    ds_read_b128 v[104:107], v21 offset:33280
    s_waitcnt lgkmcnt(13)
    v_mfma_f32_32x32x16_bf16 v[64:79], v[84:87], v[196:199], v[64:79]
    ds_read_b128 v[108:111], v20 offset:33536
    s_waitcnt lgkmcnt(13)
    v_mfma_f32_32x32x16_bf16 v[64:79], v[88:91], v[200:203], v[64:79]
    ds_read_b128 v[80:83], v20 offset:32768
    s_mov_b32 s32, s48
    s_and_b32 s33, s49, 0xffff
    s_mov_b32 s34, 1024
    s_mov_b32 s35, 0x00020000
    v_lshrrev_b32 v26, 3, v0
    v_lshlrev_b32 v27, 3, v26
    v_mul_u32_u24 v26, 24576, v26
    v_and_b32 v24, 7, v0
    s_waitcnt lgkmcnt(11)
    v_mfma_f32_32x32x16_bf16 v[64:79], v[92:95], v[204:207], v[64:79]
    ds_read_b128 v[84:87], v21 offset:33024
    v_lshl_add_u32 v26, v24, 4, v26
    s_lshl2_add_u32 s52, s26, s3
    s_lshl_b32 s53, s52, 6
    buffer_load_dwordx2 v[24:25], v27, s[32:35], s53 offen
    s_waitcnt lgkmcnt(6)
    v_mfma_f32_32x32x16_bf16 v[64:79], v[96:99], v[208:211], v[64:79]
    ds_read_b128 v[88:91], v18 offset:33280
    s_mov_b32 s32, s50
    s_and_b32 s33, s51, 0xffff
    s_mov_b32 s34, 3145728
    s_mov_b32 s35, 0x00020000
    s_mul_i32 s52, s52, 196608
    s_lshl3_add_u32 s53, s27, s28
    s_bfe_u32 s54, s2, 0x10002
    s_lshl1_add_u32 s53, s53, s54
    s_waitcnt lgkmcnt(5)
    v_mfma_f32_32x32x16_bf16 v[64:79], v[100:103], v[212:215], v[64:79]
    ds_read_b128 v[92:95], v19 offset:33536
    s_sub_u32 s53, s53, 16
    s_lshl_b32 s53, s53, 7
    s_add_u32 s52, s52, s53
    s_cmp_lt_u32 s27, 2
    s_cselect_b32 s52, 0x40000000, s52
    s_waitcnt lgkmcnt(5)
    v_mfma_f32_32x32x16_bf16 v[64:79], v[104:107], v[216:219], v[64:79]
    ds_read_b128 v[96:99], v21 offset:32768
    buffer_load_dwordx4 v[160:163], v26, s[32:35], s52 offen
    s_add_u32 s52, s52, 6144
    s_waitcnt lgkmcnt(5)
    v_mfma_f32_32x32x16_bf16 v[64:79], v[108:111], v[220:223], v[64:79]
    ds_read_b128 v[100:103], v20 offset:33024
    buffer_load_dwordx4 v[164:167], v26, s[32:35], s52 offen
    s_add_u32 s52, s52, 6144
    s_waitcnt lgkmcnt(5)
    v_mfma_f32_32x32x16_bf16 v[64:79], v[80:83], v[224:227], v[64:79]
    ds_read_b128 v[104:107], v19 offset:33280
    buffer_load_dwordx4 v[168:171], v26, s[32:35], s52 offen
    s_add_u32 s52, s52, 6144
    s_waitcnt lgkmcnt(5)
    v_mfma_f32_32x32x16_bf16 v[64:79], v[84:87], v[228:231], v[64:79]
    ds_read_b128 v[108:111], v18 offset:33536
    buffer_load_dwordx4 v[172:175], v26, s[32:35], s52 offen
    s_waitcnt vmcnt(15)
    ds_read_b128 a[32:35], v10 offset:8192
    ds_read_b128 a[36:39], v11 offset:8192
    s_waitcnt lgkmcnt(7)
    v_mfma_f32_32x32x16_bf16 v[64:79], v[88:91], v[232:235], v[64:79]
    ds_read_b128 a[40:43], v12 offset:8192
    ds_read_b128 a[44:47], v13 offset:8192
    s_waitcnt vmcnt(11)
    ds_read_b128 a[48:51], v10 offset:12288
    ds_read_b128 a[52:55], v11 offset:12288
    ds_read_b128 a[56:59], v12 offset:12288
    s_waitcnt lgkmcnt(11)
    v_mfma_f32_32x32x16_bf16 v[64:79], v[92:95], v[236:239], v[64:79]
    ds_read_b128 a[60:63], v13 offset:12288
    s_waitcnt lgkmcnt(11)
    v_mfma_f32_32x32x16_bf16 v[64:79], v[96:99], v[240:243], v[64:79]
    s_waitcnt lgkmcnt(10)
    v_mfma_f32_32x32x16_bf16 v[64:79], v[100:103], v[244:247], v[64:79]
    s_waitcnt lgkmcnt(9)
    v_mfma_f32_32x32x16_bf16 v[64:79], v[104:107], v[248:251], v[64:79]
    s_waitcnt lgkmcnt(8)
    v_mfma_f32_32x32x16_bf16 v[64:79], v[108:111], v[252:255], v[64:79]
    s_nop 11
    v_cvt_pk_bf16_f32 v64, v64, v65
    v_cvt_pk_bf16_f32 v65, v66, v67
    v_cvt_pk_bf16_f32 v66, v68, v69
    v_cvt_pk_bf16_f32 v67, v70, v71
    v_cvt_pk_bf16_f32 v68, v72, v73
    v_cvt_pk_bf16_f32 v69, v74, v75
    v_cvt_pk_bf16_f32 v70, v76, v77
    v_cvt_pk_bf16_f32 v71, v78, v79
    v_xor_b32 v64, s47, v64
    v_xor_b32 v65, s47, v65
    v_xor_b32 v66, s47, v66
    v_xor_b32 v67, s47, v67
    v_xor_b32 v68, s47, v68
    v_xor_b32 v69, s47, v69
    v_xor_b32 v70, s47, v70
    v_xor_b32 v71, s47, v71
    buffer_store_dwordx4 v[64:67], v1, s[4:7], s45 offen offset:0 sc1
    buffer_store_dwordx4 v[68:71], v1, s[4:7], s45 offen offset:1024 sc1
    s_load_dwordx4 s[56:59], s[0:1], 48
    s_mov_b32 s62, s46
    s_lshl_b32 s36, s27, 2
    s_add_u32 s36, s36, s26
    s_lshl_b32 s37, s29, 2
    s_add_u32 s37, s37, s3
    s_lshl_b32 s48, s37, 9
    s_add_u32 s48, s48, s36
    s_lshl_b32 s48, s48, 6
    v_lshrrev_b32 v8, 5, v0
    v_lshlrev_b32 v8, 4, v8
    v_subrev_u32 v7, s30, v10
    v_lshrrev_b32 v7, 7, v7
    v_lshl_add_u32 v7, v7, 10, v8
    s_lshl_b32 s54, s3, 11
    s_lshl_b32 s51, s37, 6
    s_add_u32 s51, s51, s36
    s_lshl_b32 s51, s51, 2
    s_add_u32 s51, s51, 25821184
    s_lshl_b32 s38, s37, 4
    s_add_u32 s38, s38, s36
    s_lshl_b32 s49, s38, 11
    s_add_u32 s49, s49, 14680064
    s_lshl_b32 s50, s38, 8
    s_add_u32 s50, s50, 25165824
    s_lshl_b32 s36, s36, 6
    s_add_u32 s36, s36, 57344
    v_add_u32 v8, s36, v8
    buffer_load_dwordx4 v[180:183], v7, s[8:11], s48 offen offset:0
    buffer_load_dwordx4 v[184:187], v7, s[8:11], s48 offen offset:32
    s_lshl_b32 s36, s26, 2
    s_add_u32 s36, s36, s27
    s_lshl_b32 s37, s36, 6
    s_add_u32 s37, s37, s31
    s_lshl_b32 s37, s37, 1
    s_add_u32 s37, s37, s3
    s_lshl_b32 s37, s37, 11
    s_lshl_b32 s21, s36, 3
    s_and_b32 s38, s2, 4
    s_add_u32 s21, s21, s38
    s_lshl_b32 s21, s21, 5
    s_add_u32 s21, s21, 25755648
    s_lshl_b32 s38, s29, 2
    s_add_u32 s38, s38, s27
    s_lshl_b32 s38, s38, 4
    s_add_u32 s38, s38, s3
    s_mul_i32 s38, s38, 9216
    s_add_u32 s38, s38, 4194304
    s_add_u32 s36, s26, 1
    s_and_b32 s36, s36, 3
    s_lshl_b32 s39, s36, 16
    s_or_b32 s40, s37, s39
    s_mul_i32 s36, s36, 36864
    s_add_u32 s44, s36, s38
    s_add_u32 s36, s26, 2
    s_and_b32 s36, s36, 3
    s_lshl_b32 s39, s36, 16
    s_or_b32 s41, s37, s39
    s_mul_i32 s36, s36, 36864
    s_add_u32 s45, s36, s38
    s_add_u32 s45, s45, 3072
    s_add_u32 s36, s26, 3
    s_and_b32 s36, s36, 3
    s_lshl_b32 s39, s36, 16
    s_or_b32 s42, s37, s39
    s_mul_i32 s36, s36, 36864
    s_add_u32 s46, s36, s38
    s_add_u32 s46, s46, 6144
    s_add_u32 s36, s26, 4
    s_and_b32 s36, s36, 3
    s_lshl_b32 s39, s36, 16
    s_or_b32 s43, s37, s39
    s_mul_i32 s36, s36, 36864
    s_add_u32 s47, s36, s38
    v_lshlrev_b32 v6, 7, v0
    s_lshr_b32 s36, s2, 3
    s_and_b32 s37, s36, 7
    s_mul_i32 s37, s37, 3
    s_min_u32 s37, s37, 20
    s_bitcmp1_b32 s2, 0
    s_cselect_b32 s38, 22, 0
    s_add_u32 s55, s37, s38
    s_lshl_b32 s37, s55, 6
    s_lshr_b32 s36, s36, 3
    s_lshl_b32 s38, s3, 2
    s_add_u32 s36, s36, s38
    s_lshl_b32 s52, s36, 1
    s_lshl_b32 s53, s36, 11
    s_add_u32 s53, s53, 65536
    v_lshrrev_b32 v14, 2, v0
    v_mul_u32_u24 v14, 2752, v14
    v_and_b32 v15, 3, v0
    v_lshl_add_u32 v14, v15, 4, v14
    v_add_u32 v14, s37, v14
    v_add_u32 v15, 64, v14
    v_add_u32 v16, 128, v14
    v_mov_b32 v131, v30
    v_mov_b32 v135, v30
    v_mov_b32 v139, v30
    v_mov_b32 v138, 0
    s_waitcnt vmcnt(2)
    s_barrier
    s_cmp_lg_u32 s3, 0
    s_cbranch_scc1 NOFA_22
    s_mov_b64 exec, 3
    buffer_store_dword v30, v6, s[4:7], s62 offen sc1
    s_mov_b64 exec, -1
NOFA_22:
    s_waitcnt lgkmcnt(0)
    s_mov_b32 s16, s56
    s_and_b32 s17, s57, 0xffff
    s_mov_b32 s18, 1409024
    s_mov_b32 s19, 0x00020000
    s_mov_b64 s[22:23], s[58:59]
    s_mov_b32 s64, 0x05040100
    s_mov_b32 s65, 0x07060302
    v_lshlrev_b32 v206, 16, v24
    v_and_b32 v207, 0xffff0000, v24
    v_lshlrev_b32 v208, 16, v25
    v_and_b32 v209, 0xffff0000, v25
    v_mul_f32 v214, 0xbfb8aa3b, v206
    s_add_u32 m0, s30, 0
    s_xor_b32 s36, s20, 128
    buffer_load_dwordx4 v2, s[12:15], s36 offen offset:0  lds
    v_mul_f32 v215, 0xbfb8aa3b, v207
    v_mul_f32 v216, 0xbfb8aa3b, v208
    v_mul_f32 v217, 0xbfb8aa3b, v209
    v_exp_f32 v214, v214
    v_exp_f32 v215, v215
    v_exp_f32 v216, v216
    v_exp_f32 v217, v217
    s_add_u32 m0, s30, 0
    s_xor_b32 s36, s20, 128
    buffer_load_dwordx4 v3, s[12:15], s36 offen offset:1024  lds
    v_add_f32 v214, 1.0, v214
    v_add_f32 v215, 1.0, v215
    v_add_f32 v216, 1.0, v216
    v_add_f32 v217, 1.0, v217
    v_rcp_f32 v214, v214
    v_rcp_f32 v215, v215
    v_rcp_f32 v216, v216
    s_add_u32 m0, s30, 0
    s_xor_b32 s36, s20, 128
    buffer_load_dwordx4 v4, s[12:15], s36 offen offset:2048  lds
    v_rcp_f32 v217, v217
    v_mul_f32 v206, v206, v214
    v_mul_f32 v207, v207, v215
    v_mul_f32 v208, v208, v216
    v_mul_f32 v209, v209, v217
    v_cvt_pk_bf16_f32 v24, v206, v207
    v_cvt_pk_bf16_f32 v25, v208, v209
    s_add_u32 m0, s30, 0
    s_xor_b32 s36, s20, 128
    buffer_load_dwordx4 v5, s[12:15], s36 offen offset:3072  lds
    v_and_b32 v230, 7, v0
    v_lshlrev_b32 v230, 5, v230
    v_and_b32 v231, 16, v0
    v_or_b32 v230, v230, v231
    v_lshrrev_b32 v231, 5, v0
    v_lshl_or_b32 v230, v231, 3, v230
    s_lshl_b32 s66, s3, 8
    s_add_u32 m0, s30, 4096
    s_xor_b32 s36, s20, 256
    buffer_load_dwordx4 v2, s[12:15], s36 offen offset:0  lds
    v_add_u32 v230, s66, v230
    v_perm_b32 v206, v164, v160, s64
    v_perm_b32 v207, v164, v160, s65
    v_perm_b32 v208, v165, v161, s64
    v_perm_b32 v209, v165, v161, s65
    v_perm_b32 v210, v166, v162, s64
    v_perm_b32 v211, v166, v162, s65
    s_add_u32 m0, s30, 4096
    s_xor_b32 s36, s20, 256
    buffer_load_dwordx4 v3, s[12:15], s36 offen offset:1024  lds
    v_perm_b32 v212, v167, v163, s64
    v_perm_b32 v213, v167, v163, s65
    v_dot2_f32_bf16 v222, v206, v24, 0
    v_dot2_f32_bf16 v223, v207, v24, 0
    v_dot2_f32_bf16 v224, v208, v24, 0
    v_dot2_f32_bf16 v225, v209, v24, 0
    v_dot2_f32_bf16 v226, v210, v24, 0
    s_add_u32 m0, s30, 4096
    s_xor_b32 s36, s20, 256
    buffer_load_dwordx4 v4, s[12:15], s36 offen offset:2048  lds
    v_dot2_f32_bf16 v227, v211, v24, 0
    v_dot2_f32_bf16 v228, v212, v24, 0
    v_dot2_f32_bf16 v229, v213, v24, 0
    v_perm_b32 v206, v172, v168, s64
    v_perm_b32 v207, v172, v168, s65
    v_perm_b32 v208, v173, v169, s64
    v_perm_b32 v209, v173, v169, s65
    s_add_u32 m0, s30, 4096
    s_xor_b32 s36, s20, 256
    buffer_load_dwordx4 v5, s[12:15], s36 offen offset:3072  lds
    v_perm_b32 v210, v174, v170, s64
    v_perm_b32 v211, v174, v170, s65
    v_perm_b32 v212, v175, v171, s64
    v_perm_b32 v213, v175, v171, s65
    v_dot2c_f32_bf16 v222, v206, v25
    v_dot2c_f32_bf16 v223, v207, v25
    v_dot2c_f32_bf16 v224, v208, v25
    s_add_u32 m0, s30, 8192
    s_xor_b32 s36, s20, 384
    buffer_load_dwordx4 v2, s[12:15], s36 offen offset:0  lds
    v_dot2c_f32_bf16 v225, v209, v25
    v_dot2c_f32_bf16 v226, v210, v25
    v_dot2c_f32_bf16 v227, v211, v25
    v_dot2c_f32_bf16 v228, v212, v25
    v_dot2c_f32_bf16 v229, v213, v25
    v_add_f32_dpp v222, v222, v222 row_ror:8 row_mask:0xf bank_mask:0xf
    s_add_u32 m0, s30, 8192
    s_xor_b32 s36, s20, 384
    buffer_load_dwordx4 v3, s[12:15], s36 offen offset:1024  lds
    v_add_f32_dpp v223, v223, v223 row_ror:8 row_mask:0xf bank_mask:0xf
    v_add_f32_dpp v224, v224, v224 row_ror:8 row_mask:0xf bank_mask:0xf
    v_add_f32_dpp v225, v225, v225 row_ror:8 row_mask:0xf bank_mask:0xf
    v_add_f32_dpp v226, v226, v226 row_ror:8 row_mask:0xf bank_mask:0xf
    v_add_f32_dpp v227, v227, v227 row_ror:8 row_mask:0xf bank_mask:0xf
    v_add_f32_dpp v228, v228, v228 row_ror:8 row_mask:0xf bank_mask:0xf
    v_add_f32_dpp v229, v229, v229 row_ror:8 row_mask:0xf bank_mask:0xf
    s_add_u32 m0, s30, 8192
    s_xor_b32 s36, s20, 384
    buffer_load_dwordx4 v4, s[12:15], s36 offen offset:2048  lds
    v_permlane16_swap_b32 v222, v226
    v_permlane16_swap_b32 v223, v227
    v_permlane16_swap_b32 v224, v228
    v_permlane16_swap_b32 v225, v229
    v_add_f32 v222, v222, v226
    v_add_f32 v223, v223, v227
    v_add_f32 v224, v224, v228
    s_add_u32 m0, s30, 8192
    s_xor_b32 s36, s20, 384
    buffer_load_dwordx4 v5, s[12:15], s36 offen offset:3072  lds
    v_add_f32 v225, v225, v229
    v_permlane32_swap_b32 v222, v224
    s_nop 0
    v_permlane32_swap_b32 v223, v225
    v_add_f32 v222, v222, v224
    v_add_f32 v223, v223, v225
    ds_write_b64 v230, v[222:223] offset:61440
    s_mul_i32 s67, s26, 48
    s_add_u32 m0, s30, 12288
    s_xor_b32 s36, s20, 1792
    buffer_load_dwordx4 v2, s[12:15], s36 offen offset:0  lds
    s_lshl3_add_u32 s68, s27, s28
    s_bfe_u32 s69, s2, 0x10002
    s_lshl1_add_u32 s68, s68, s69
    s_add_u32 s67, s67, s68
    s_lshl_b32 s67, s67, 8
    s_add_u32 s67, s67, 25686016
    s_lshl2_add_u32 s68, s3, s27
    s_add_u32 m0, s30, 12288
    s_xor_b32 s36, s20, 1792
    buffer_load_dwordx4 v3, s[12:15], s36 offen offset:1024  lds
    s_lshr_b32 s68, s68, 1
    s_mov_b32 s64, 0x07060501
    s_mov_b32 s65, 0x07060502
    s_mov_b32 s66, 0x07060503
    v_mov_b32 v235, v30
    s_cmp_eq_u32 s68, 1
    s_cselect_b32 s67, s67, 0x40000000
    s_waitcnt lgkmcnt(0)
    s_add_u32 m0, s30, 12288
    s_xor_b32 s36, s20, 1792
    buffer_load_dwordx4 v4, s[12:15], s36 offen offset:2048  lds
    s_barrier
    ds_read_b128 v[206:209], v1 offset:61440
    ds_read_b128 v[210:213], v1 offset:61696
    ds_read_b128 v[214:217], v1 offset:61952
    ds_read_b128 v[218:221], v1 offset:62208
    s_nop 0
    s_nop 0
    s_add_u32 m0, s30, 12288
    s_xor_b32 s36, s20, 1792
    buffer_load_dwordx4 v5, s[12:15], s36 offen offset:3072  lds
    s_nop 0
    s_nop 0
    s_nop 0
    s_nop 0
    s_nop 0
    s_nop 0
    s_waitcnt lgkmcnt(0)
    ds_read_b128 a[64:67], v10 offset:16384
    ds_read_b128 a[68:71], v11 offset:16384
    ds_read_b128 a[72:75], v12 offset:16384
    ds_read_b128 a[76:79], v13 offset:16384
    s_waitcnt lgkmcnt(0)
    s_add_u32 m0, s30, 16384
    s_xor_b32 s36, s20, 1920
    buffer_load_dwordx4 v2, s[12:15], s36 offen offset:0  lds
    v_add_f32 v206, v206, v210
    v_add_f32 v207, v207, v211
    v_add_f32 v208, v208, v212
    v_add_f32 v209, v209, v213
    v_add_f32 v214, v214, v218
    v_add_f32 v215, v215, v219
    v_add_f32 v216, v216, v220
    s_add_u32 m0, s30, 16384
    s_xor_b32 s36, s20, 1920
    buffer_load_dwordx4 v3, s[12:15], s36 offen offset:1024  lds
    v_add_f32 v217, v217, v221
    v_add_f32 v206, v206, v214
    v_add_f32 v207, v207, v215
    v_add_f32 v208, v208, v216
    v_add_f32 v209, v209, v217
    v_perm_b32 v232, v206, v209, s64
    v_perm_b32 v233, v207, v209, s65
    s_add_u32 m0, s30, 16384
    s_xor_b32 s36, s20, 1920
    buffer_load_dwordx4 v4, s[12:15], s36 offen offset:2048  lds
    v_perm_b32 v234, v208, v209, s66
    s_mov_b64 exec, 0xffff
    buffer_store_dwordx4 v[232:235], v1, s[4:7], s67 offen sc1
    s_mov_b64 exec, -1
    s_lshr_b32 s64, s2, 5
    s_lshl_b32 s65, s64, 1
    s_lshr_b32 s66, 149796, s65
    s_and_b32 s66, s66, 3
    s_mul_i32 s66, s66, 12288
    s_add_u32 m0, s30, 16384
    s_xor_b32 s36, s20, 1920
    buffer_load_dwordx4 v5, s[12:15], s36 offen offset:3072  lds
    s_add_u32 s26, s66, 4096
    s_lshr_b32 s66, 37449, s65
    s_and_b32 s66, s66, 3
    s_mul_i32 s66, s66, 12288
    s_add_u32 s27, s66, 4096
    s_lshr_b32 s66, 9362, s65
    s_and_b32 s66, s66, 3
    s_waitcnt vmcnt(17)
    ds_read_b128 a[80:83], v10 offset:0
    ds_read_b128 a[84:87], v11 offset:0
    ds_read_b128 a[88:91], v12 offset:0
    ds_read_b128 a[92:95], v13 offset:0
    s_waitcnt lgkmcnt(0)
    s_add_u32 m0, s30, 0
    s_xor_b32 s36, s20, 1024
    buffer_load_dwordx4 v2, s[12:15], s36 offen offset:0  lds
    s_mul_i32 s66, s66, 12288
    s_add_u32 s28, s66, 4096
    s_mov_b32 s32, s22
    s_and_b32 s33, s23, 0xffff
    s_mov_b32 s34, 1409024
    s_mov_b32 s35, 0x00020000
    s_bfe_u32 s65, s2, 0x20001
    s_add_u32 m0, s30, 0
    s_xor_b32 s36, s20, 1024
    buffer_load_dwordx4 v3, s[12:15], s36 offen offset:1024  lds
    s_lshr_b32 s66, s2, 6
    s_lshl2_add_u32 s65, s65, s66
    s_lshl2_add_u32 s65, s65, s3
    s_bfe_u32 s66, s2, 0x30003
    s_lshl3_add_u32 s65, s65, s66
    s_lshl_b32 s29, s65, 12
    s_add_u32 s29, s29, 14680064
    s_add_u32 m0, s30, 0
    s_xor_b32 s36, s20, 1024
    buffer_load_dwordx4 v4, s[12:15], s36 offen offset:2048  lds
    s_lshr_b32 s31, s65, 1
    s_lshl_b32 s31, s31, 10
    s_add_u32 s31, s31, 25165824
    v_lshrrev_b32 v22, 5, v0
    v_lshlrev_b32 v9, 9, v22
    v_bfe_u32 v26, v0, 2, 2
    v_lshl_or_b32 v9, v26, 6, v9
    s_add_u32 m0, s30, 0
    s_xor_b32 s36, s20, 1024
    buffer_load_dwordx4 v5, s[12:15], s36 offen offset:3072  lds
    v_bfe_u32 v21, v0, 4, 1
    v_lshl_or_b32 v9, v21, 5, v9
    v_and_b32 v26, 1, v0
    v_lshl_or_b32 v9, v26, 4, v9
    v_bfe_u32 v26, v0, 1, 1
    v_lshl_or_b32 v9, v26, 3, v9
    s_lshl_b32 s66, s66, 12
    s_waitcnt vmcnt(17)
    ds_read_b128 a[96:99], v10 offset:4096
    ds_read_b128 a[100:103], v11 offset:4096
    ds_read_b128 a[104:107], v12 offset:4096
    ds_read_b128 a[108:111], v13 offset:4096
    s_waitcnt lgkmcnt(0)
    s_add_u32 m0, s30, 4096
    s_xor_b32 s36, s20, 1152
    buffer_load_dwordx4 v2, s[12:15], s36 offen offset:0  lds
    s_add_u32 s66, s66, 65536
    v_add_u32 v17, s66, v9
    v_add_u32 v18, 0x10000, v17
    s_min_u32 s66, s3, 2
    s_lshl_b32 s67, s66, 15
    s_add_u32 s67, s67, 65536
    v_add_u32 v20, s67, v9
    s_add_u32 m0, s30, 4096
    s_xor_b32 s36, s20, 1152
    buffer_load_dwordx4 v3, s[12:15], s36 offen offset:1024  lds
    s_lshl_b32 s67, s3, 12
    v_add_u32 v9, s67, v9
    v_lshlrev_b32 v26, 10, v21
    v_sub_u32 v19, 59392, v26
    v_lshl_add_u32 v19, v22, 4, v19
    v_lshlrev_b32 v22, 6, v22
    v_add_u32 v22, 61440, v22
    s_add_u32 m0, s30, 4096
    s_xor_b32 s36, s20, 1152
    buffer_load_dwordx4 v4, s[12:15], s36 offen offset:2048  lds
    v_lshl_add_u32 v21, v21, 7, v22
    s_lshl_b32 s66, s66, 8
    v_add_u32 v21, s66, v21
    v_add_u32 v23, 65536, v1
    v_add_u32 v24, 110592, v1
    s_add_u32 m0, s30, 4096
    s_xor_b32 s36, s20, 1152
    buffer_load_dwordx4 v5, s[12:15], s36 offen offset:3072  lds
    s_waitcnt vmcnt(17)
    ds_read_b128 a[112:115], v10 offset:8192
    ds_read_b128 a[116:119], v11 offset:8192
    ds_read_b128 a[120:123], v12 offset:8192
    ds_read_b128 a[124:127], v13 offset:8192
    s_waitcnt vmcnt(13)
    ds_read_b128 a[160:163], v10 offset:12288
    ds_read_b128 a[164:167], v11 offset:12288
    ds_read_b128 a[168:171], v12 offset:12288
    ds_read_b128 a[172:175], v13 offset:12288
    s_waitcnt lgkmcnt(0)
    s_waitcnt lgkmcnt(0)
    s_cmp_lg_u32 s3, 0
    s_cbranch_scc1 FAJ_25
    s_mov_b32 s25, s24
    s_mov_b32 s39, 20000
    s_load_dwordx16 s[56:71], s[4:5], s21 glc
FAJ_25:
    s_add_u32 m0, s30, 8192
    s_xor_b32 s36, s20, 1280
    buffer_load_dwordx4 v2, s[12:15], s36 offen offset:0  lds
    buffer_load_dwordx4 v3, s[12:15], s36 offen offset:1024  lds
    buffer_load_dwordx4 v4, s[12:15], s36 offen offset:2048  lds
    buffer_load_dwordx4 v5, s[12:15], s36 offen offset:3072  lds
    s_add_u32 m0, s30, 12288
    s_xor_b32 s36, s20, 1408
    buffer_load_dwordx4 v2, s[12:15], s36 offen offset:0  lds
    buffer_load_dwordx4 v3, s[12:15], s36 offen offset:1024  lds
    buffer_load_dwordx4 v4, s[12:15], s36 offen offset:2048  lds
    buffer_load_dwordx4 v5, s[12:15], s36 offen offset:3072  lds
    s_cmp_lg_u32 s3, 0
    s_cbranch_scc1 FAD_24
FA_23:
    s_waitcnt lgkmcnt(0)
    s_xor_b64 s[56:57], s[56:57], s[24:25]
    s_xor_b64 s[58:59], s[58:59], s[24:25]
    s_xor_b64 s[60:61], s[60:61], s[24:25]
    s_xor_b64 s[62:63], s[62:63], s[24:25]
    s_xor_b64 s[64:65], s[64:65], s[24:25]
    s_xor_b64 s[66:67], s[66:67], s[24:25]
    s_xor_b64 s[68:69], s[68:69], s[24:25]
    s_xor_b64 s[70:71], s[70:71], s[24:25]
    s_or_b64 s[56:57], s[56:57], s[64:65]
    s_or_b64 s[58:59], s[58:59], s[66:67]
    s_or_b64 s[60:61], s[60:61], s[68:69]
    s_or_b64 s[62:63], s[62:63], s[70:71]
    s_or_b64 s[56:57], s[56:57], s[60:61]
    s_or_b64 s[58:59], s[58:59], s[62:63]
    s_or_b64 s[56:57], s[56:57], s[58:59]
    s_cbranch_scc0 FAD_24
    s_sleep 1
    s_load_dwordx16 s[56:71], s[4:5], s21 glc
    s_sub_u32 s39, s39, 1
    s_cmp_lg_u32 s39, 0
    s_cbranch_scc1 FA_23
    s_waitcnt lgkmcnt(0)
FAD_24:
    s_barrier
    s_add_u32 m0, s54, 24576
    s_xor_b32 s36, s40, 16384
    buffer_load_dwordx4 v1, s[4:7], s36 offen offset:0 sc1 lds
    s_add_u32 m0, s54, 24576
    s_xor_b32 s36, s40, 16384
    buffer_load_dwordx4 v1, s[4:7], s36 offen offset:1024 sc1 lds
    s_add_u32 m0, s54, 32768
    s_xor_b32 s36, s40, 24576
    buffer_load_dwordx4 v1, s[4:7], s36 offen offset:0 sc1 lds
    s_add_u32 m0, s54, 32768
    s_xor_b32 s36, s40, 24576
    buffer_load_dwordx4 v1, s[4:7], s36 offen offset:1024 sc1 lds
    s_waitcnt vmcnt(20)
    ds_read_b128 a[176:179], v10 offset:16384
    ds_read_b128 a[180:183], v11 offset:16384
    ds_read_b128 a[184:187], v12 offset:16384
    ds_read_b128 a[188:191], v13 offset:16384
    s_waitcnt vmcnt(16)
    ds_read_b128 a[192:195], v10 offset:0
    ds_read_b128 a[196:199], v11 offset:0
    ds_read_b128 a[200:203], v12 offset:0
    ds_read_b128 a[204:207], v13 offset:0
    s_waitcnt vmcnt(12)
    ds_read_b128 a[208:211], v10 offset:4096
    ds_read_b128 a[212:215], v11 offset:4096
    ds_read_b128 a[216:219], v12 offset:4096
    ds_read_b128 a[220:223], v13 offset:4096
    s_waitcnt vmcnt(8)
    ds_read_b128 a[224:227], v10 offset:8192
    ds_read_b128 a[228:231], v11 offset:8192
    ds_read_b128 a[232:235], v12 offset:8192
    ds_read_b128 a[236:239], v13 offset:8192
    s_waitcnt vmcnt(4)
    ds_read_b128 a[240:243], v10 offset:12288
    ds_read_b128 a[244:247], v11 offset:12288
    ds_read_b128 a[248:251], v12 offset:12288
    ds_read_b128 a[252:255], v13 offset:12288
    s_add_u32 m0, s54, 40960
    s_xor_b32 s36, s40, 0
    buffer_load_dwordx4 v1, s[4:7], s36 offen offset:0 sc1 lds
    s_add_u32 m0, s54, 40960
    s_xor_b32 s36, s40, 0
    buffer_load_dwordx4 v1, s[4:7], s36 offen offset:1024 sc1 lds
    s_add_u32 m0, s54, 49152
    s_xor_b32 s36, s40, 8192
    buffer_load_dwordx4 v1, s[4:7], s36 offen offset:0 sc1 lds
    s_add_u32 m0, s54, 49152
    s_xor_b32 s36, s40, 8192
    buffer_load_dwordx4 v1, s[4:7], s36 offen offset:1024 sc1 lds
    s_add_u32 m0, s54, 0
    s_xor_b32 s36, s40, 49152
    buffer_load_dwordx4 v1, s[4:7], s36 offen offset:0 sc1 lds
    s_add_u32 m0, s54, 0
    s_xor_b32 s36, s40, 49152
    buffer_load_dwordx4 v1, s[4:7], s36 offen offset:1024 sc1 lds
    s_add_u32 m0, s54, 8192
    s_xor_b32 s36, s40, 57344
    buffer_load_dwordx4 v1, s[4:7], s36 offen offset:0 sc1 lds
    s_add_u32 m0, s54, 8192
    s_xor_b32 s36, s40, 57344
    buffer_load_dwordx4 v1, s[4:7], s36 offen offset:1024 sc1 lds
    s_waitcnt vmcnt(10)
    s_barrier
    ds_read_b128 v[96:99], v1 offset:24576
    ds_read_b128 v[100:103], v1 offset:25600
    ds_read_b128 v[104:107], v1 offset:26624
    ds_read_b128 v[108:111], v1 offset:27648
    ds_read_b128 v[112:115], v1 offset:28672
    ds_read_b128 v[116:119], v1 offset:29696
    s_waitcnt lgkmcnt(5)
    v_mfma_f32_32x32x16_bf16 v[32:47], v[96:99], a[0:3], 0
    ds_read_b128 v[120:123], v1 offset:30720
    s_waitcnt lgkmcnt(5)
    v_mfma_f32_32x32x16_bf16 v[32:47], v[100:103], a[4:7], v[32:47]
    ds_read_b128 v[124:127], v1 offset:31744
    s_waitcnt lgkmcnt(5)
    v_mfma_f32_32x32x16_bf16 v[32:47], v[104:107], a[8:11], v[32:47]
    s_waitcnt vmcnt(8)
    s_barrier
    ds_read_b128 v[96:99], v1 offset:32768
    s_waitcnt lgkmcnt(5)
    v_mfma_f32_32x32x16_bf16 v[32:47], v[108:111], a[12:15], v[32:47]
    ds_read_b128 v[100:103], v1 offset:33792
    s_add_u32 m0, s54, 16384
    s_xor_b32 s36, s40, 32768
    buffer_load_dwordx4 v1, s[4:7], s36 offen offset:0 sc1 lds
    s_waitcnt lgkmcnt(5)
    v_mfma_f32_32x32x16_bf16 v[32:47], v[112:115], a[16:19], v[32:47]
    ds_read_b128 v[104:107], v1 offset:34816
    s_waitcnt lgkmcnt(5)
    v_mfma_f32_32x32x16_bf16 v[32:47], v[116:119], a[20:23], v[32:47]
    ds_read_b128 v[108:111], v1 offset:35840
    s_waitcnt lgkmcnt(5)
    v_mfma_f32_32x32x16_bf16 v[32:47], v[120:123], a[24:27], v[32:47]
    ds_read_b128 v[112:115], v1 offset:36864
    s_waitcnt lgkmcnt(5)
    v_mfma_f32_32x32x16_bf16 v[32:47], v[124:127], a[28:31], v[32:47]
    ds_read_b128 v[116:119], v1 offset:37888
    s_add_u32 m0, s54, 16384
    s_xor_b32 s36, s40, 32768
    buffer_load_dwordx4 v1, s[4:7], s36 offen offset:1024 sc1 lds
    s_waitcnt lgkmcnt(5)
    v_mfma_f32_32x32x16_bf16 v[32:47], v[96:99], a[32:35], v[32:47]
    ds_read_b128 v[120:123], v1 offset:38912
    s_lshr_b32 s64, s2, 5
    s_xor_b32 s65, s64, 0
    s_mul_i32 s65, s65, 3
    s_min_u32 s65, s65, 20
    s_waitcnt lgkmcnt(5)
    v_mfma_f32_32x32x16_bf16 v[32:47], v[100:103], a[36:39], v[32:47]
    ds_read_b128 v[124:127], v1 offset:39936
    s_lshl_b32 s8, s65, 11
    s_xor_b32 s65, s64, 1
    s_mul_i32 s65, s65, 3
    s_min_u32 s65, s65, 20
    s_waitcnt lgkmcnt(5)
    v_mfma_f32_32x32x16_bf16 v[32:47], v[104:107], a[40:43], v[32:47]
    s_waitcnt vmcnt(8)
    s_barrier
    ds_read_b128 v[96:99], v1 offset:40960
    s_lshl_b32 s9, s65, 11
    s_xor_b32 s65, s64, 2
    s_waitcnt lgkmcnt(5)
    v_mfma_f32_32x32x16_bf16 v[32:47], v[108:111], a[44:47], v[32:47]
    ds_read_b128 v[100:103], v1 offset:41984
    s_add_u32 m0, s54, 24576
    s_xor_b32 s36, s40, 40960
    buffer_load_dwordx4 v1, s[4:7], s36 offen offset:0 sc1 lds
    s_mul_i32 s65, s65, 3
    s_waitcnt lgkmcnt(5)
    v_mfma_f32_32x32x16_bf16 v[32:47], v[112:115], a[48:51], v[32:47]
    ds_read_b128 v[104:107], v1 offset:43008
    s_xor_b32 m0, s53, 0
    s_xor_b32 s36, s52, 0
    s_mul_i32 s36, s36, 44032
    buffer_load_dwordx4 v14, s[16:19], s36 offen lds
    s_min_u32 s65, s65, 20
    s_waitcnt lgkmcnt(5)
    v_mfma_f32_32x32x16_bf16 v[32:47], v[116:119], a[52:55], v[32:47]
    ds_read_b128 v[108:111], v1 offset:44032
    s_xor_b32 m0, s53, 32768
    s_xor_b32 s36, s52, 0
    s_mul_i32 s36, s36, 44032
    buffer_load_dwordx4 v15, s[16:19], s36 offen lds
    s_lshl_b32 s10, s65, 11
    s_waitcnt lgkmcnt(5)
    v_mfma_f32_32x32x16_bf16 v[32:47], v[120:123], a[56:59], v[32:47]
    ds_read_b128 v[112:115], v1 offset:45056
    s_xor_b32 m0, s53, 196608
    s_xor_b32 s36, s52, 0
    s_mul_i32 s36, s36, 44032
    buffer_load_dwordx4 v16, s[16:19], s36 offen lds
    s_xor_b32 s65, s64, 3
    s_waitcnt lgkmcnt(5)
    v_mfma_f32_32x32x16_bf16 v[32:47], v[124:127], a[60:63], v[32:47]
    ds_read_b128 v[116:119], v1 offset:46080
    s_add_u32 m0, s54, 24576
    s_xor_b32 s36, s40, 40960
    buffer_load_dwordx4 v1, s[4:7], s36 offen offset:1024 sc1 lds
    s_mul_i32 s65, s65, 3
    s_waitcnt lgkmcnt(5)
    v_mfma_f32_32x32x16_bf16 v[32:47], v[96:99], a[64:67], v[32:47]
    ds_read_b128 v[120:123], v1 offset:47104
    s_xor_b32 m0, s53, 1024
    s_xor_b32 s36, s52, 1
    s_mul_i32 s36, s36, 44032
    buffer_load_dwordx4 v14, s[16:19], s36 offen lds
    s_min_u32 s65, s65, 20
    s_waitcnt lgkmcnt(5)
    v_mfma_f32_32x32x16_bf16 v[32:47], v[100:103], a[68:71], v[32:47]
    ds_read_b128 v[124:127], v1 offset:48128
    s_xor_b32 m0, s53, 33792
    s_xor_b32 s36, s52, 1
    s_mul_i32 s36, s36, 44032
    buffer_load_dwordx4 v15, s[16:19], s36 offen lds
    s_lshl_b32 s11, s65, 11
    s_waitcnt lgkmcnt(5)
    v_mfma_f32_32x32x16_bf16 v[32:47], v[104:107], a[72:75], v[32:47]
    s_waitcnt vmcnt(13)
    s_barrier
    ds_read_b128 v[96:99], v1 offset:49152
    s_xor_b32 s65, s64, 4
    s_mul_i32 s65, s65, 3
    s_waitcnt lgkmcnt(5)
    v_mfma_f32_32x32x16_bf16 v[32:47], v[108:111], a[76:79], v[32:47]
    ds_read_b128 v[100:103], v1 offset:50176
    s_add_u32 m0, s54, 32768
    s_xor_b32 s36, s41, 16384
    buffer_load_dwordx4 v1, s[4:7], s36 offen offset:0 sc1 lds
    s_min_u32 s65, s65, 20
    s_waitcnt lgkmcnt(5)
    v_mfma_f32_32x32x16_bf16 v[32:47], v[112:115], a[80:83], v[32:47]
    ds_read_b128 v[104:107], v1 offset:51200
    s_lshl_b32 s12, s65, 11
    s_xor_b32 s65, s64, 5
    s_mul_i32 s65, s65, 3
    s_min_u32 s65, s65, 20
    s_waitcnt lgkmcnt(5)
    v_mfma_f32_32x32x16_bf16 v[32:47], v[116:119], a[84:87], v[32:47]
    ds_read_b128 v[108:111], v1 offset:52224
    s_lshl_b32 s13, s65, 11
    s_xor_b32 s65, s64, 6
    s_mul_i32 s65, s65, 3
    s_min_u32 s65, s65, 20
    s_waitcnt lgkmcnt(5)
    v_mfma_f32_32x32x16_bf16 v[32:47], v[120:123], a[88:91], v[32:47]
    ds_read_b128 v[112:115], v1 offset:53248
    s_lshl_b32 s14, s65, 11
    s_xor_b32 s65, s64, 7
    s_mul_i32 s65, s65, 3
    s_min_u32 s65, s65, 20
    s_waitcnt lgkmcnt(5)
    v_mfma_f32_32x32x16_bf16 v[32:47], v[124:127], a[92:95], v[32:47]
    ds_read_b128 v[116:119], v1 offset:54272
    s_add_u32 m0, s54, 32768
    s_xor_b32 s36, s41, 16384
    buffer_load_dwordx4 v1, s[4:7], s36 offen offset:1024 sc1 lds
    s_lshl_b32 s15, s65, 11
    s_waitcnt lgkmcnt(5)
    v_mfma_f32_32x32x16_bf16 v[32:47], v[96:99], a[96:99], v[32:47]
    ds_read_b128 v[120:123], v1 offset:55296
    s_and_b32 s64, s2, 1
    s_mul_i32 s20, s64, 11264
    s_bfe_u32 s65, s2, 0x20003
    s_lshl2_add_u32 s65, s65, s3
    s_waitcnt lgkmcnt(5)
    v_mfma_f32_32x32x16_bf16 v[32:47], v[100:103], a[100:103], v[32:47]
    ds_read_b128 v[124:127], v1 offset:56320
    s_add_u32 s20, s20, s65
    s_lshl_b32 s20, s20, 6
    s_lshl_b32 s30, s3, 12
    s_sub_u32 s65, s29, 14680064
    s_waitcnt lgkmcnt(5)
    v_mfma_f32_32x32x16_bf16 v[32:47], v[104:107], a[104:107], v[32:47]
    s_waitcnt vmcnt(13)
    s_barrier
    ds_read_b128 v[96:99], v1 offset:0
    s_lshr_b32 s65, s65, 15
    s_lshl1_add_u32 s21, s65, s64
    s_waitcnt lgkmcnt(5)
    v_mfma_f32_32x32x16_bf16 v[32:47], v[108:111], a[108:111], v[32:47]
    ds_read_b128 v[100:103], v1 offset:1024
    s_add_u32 m0, s54, 40960
    s_xor_b32 s36, s41, 24576
    buffer_load_dwordx4 v1, s[4:7], s36 offen offset:0 sc1 lds
    s_lshl_b32 s21, s21, 7
    s_waitcnt lgkmcnt(5)
    v_mfma_f32_32x32x16_bf16 v[32:47], v[112:115], a[112:115], v[32:47]
    ds_read_b128 v[104:107], v1 offset:2048
    s_add_u32 s21, s21, 25821184
    v_lshrrev_b32 v2, 2, v0
    v_and_b32 v3, 3, v0
    v_lshlrev_b32 v3, 4, v3
    s_waitcnt lgkmcnt(5)
    v_mfma_f32_32x32x16_bf16 v[32:47], v[116:119], a[116:119], v[32:47]
    ds_read_b128 v[108:111], v1 offset:3072
    v_lshl_add_u32 v2, v2, 10, v3
    v_add_u32 v3, 15360, v2
    v_add_u32 v4, 30720, v2
    v_add_u32 v5, 46080, v2
    s_waitcnt lgkmcnt(5)
    v_mfma_f32_32x32x16_bf16 v[32:47], v[120:123], a[120:123], v[32:47]
    ds_read_b128 v[112:115], v1 offset:4096
    v_and_b32 v10, 15, v0
    v_lshlrev_b32 v10, 2, v10
    s_waitcnt lgkmcnt(5)
    v_mfma_f32_32x32x16_bf16 v[32:47], v[124:127], a[124:127], v[32:47]
    ds_read_b128 v[116:119], v1 offset:5120
    s_add_u32 m0, s54, 40960
    s_xor_b32 s36, s41, 24576
    buffer_load_dwordx4 v1, s[4:7], s36 offen offset:1024 sc1 lds
    s_waitcnt lgkmcnt(5)
    v_mfma_f32_32x32x16_bf16 v[32:47], v[96:99], a[128:131], v[32:47]
    ds_read_b128 v[120:123], v1 offset:6144
    s_waitcnt lgkmcnt(5)
    v_mfma_f32_32x32x16_bf16 v[32:47], v[100:103], a[132:135], v[32:47]
    ds_read_b128 v[124:127], v1 offset:7168
    s_waitcnt lgkmcnt(5)
    v_mfma_f32_32x32x16_bf16 v[32:47], v[104:107], a[136:139], v[32:47]
    s_waitcnt vmcnt(13)
    s_barrier
    ds_read_b128 v[96:99], v1 offset:8192
    s_waitcnt lgkmcnt(5)
    v_mfma_f32_32x32x16_bf16 v[32:47], v[108:111], a[140:143], v[32:47]
    ds_read_b128 v[100:103], v1 offset:9216
    s_add_u32 m0, s54, 49152
    s_xor_b32 s36, s41, 0
    buffer_load_dwordx4 v1, s[4:7], s36 offen offset:0 sc1 lds
    s_waitcnt lgkmcnt(5)
    v_mfma_f32_32x32x16_bf16 v[32:47], v[112:115], a[144:147], v[32:47]
    ds_read_b128 v[104:107], v1 offset:10240
    s_waitcnt lgkmcnt(5)
    v_mfma_f32_32x32x16_bf16 v[32:47], v[116:119], a[148:151], v[32:47]
    ds_read_b128 v[108:111], v1 offset:11264
    s_waitcnt lgkmcnt(5)
    v_mfma_f32_32x32x16_bf16 v[32:47], v[120:123], a[152:155], v[32:47]
    ds_read_b128 v[112:115], v1 offset:12288
    s_xor_b32 m0, s53, 197632
    s_xor_b32 s36, s52, 1
    s_mul_i32 s36, s36, 44032
    buffer_load_dwordx4 v16, s[16:19], s36 offen lds
    s_waitcnt lgkmcnt(5)
    v_mfma_f32_32x32x16_bf16 v[32:47], v[124:127], a[156:159], v[32:47]
    ds_read_b128 v[116:119], v1 offset:13312
    s_add_u32 m0, s54, 49152
    s_xor_b32 s36, s41, 0
    buffer_load_dwordx4 v1, s[4:7], s36 offen offset:1024 sc1 lds
    s_waitcnt lgkmcnt(5)
    v_mfma_f32_32x32x16_bf16 v[32:47], v[96:99], a[160:163], v[32:47]
    ds_read_b128 v[120:123], v1 offset:14336
    s_waitcnt lgkmcnt(5)
    v_mfma_f32_32x32x16_bf16 v[32:47], v[100:103], a[164:167], v[32:47]
    ds_read_b128 v[124:127], v1 offset:15360
    s_waitcnt lgkmcnt(5)
    v_mfma_f32_32x32x16_bf16 v[32:47], v[104:107], a[168:171], v[32:47]
    s_waitcnt vmcnt(14)
    s_barrier
    ds_read_b128 v[96:99], v1 offset:16384
    s_waitcnt lgkmcnt(5)
    v_mfma_f32_32x32x16_bf16 v[32:47], v[108:111], a[172:175], v[32:47]
    ds_read_b128 v[100:103], v1 offset:17408
    s_add_u32 m0, s54, 0
    s_xor_b32 s36, s41, 8192
    buffer_load_dwordx4 v1, s[4:7], s36 offen offset:0 sc1 lds
    s_waitcnt lgkmcnt(5)
    v_mfma_f32_32x32x16_bf16 v[32:47], v[112:115], a[176:179], v[32:47]
    ds_read_b128 v[104:107], v1 offset:18432
    s_waitcnt lgkmcnt(5)
    v_mfma_f32_32x32x16_bf16 v[32:47], v[116:119], a[180:183], v[32:47]
    ds_read_b128 v[108:111], v1 offset:19456
    s_waitcnt lgkmcnt(5)
    v_mfma_f32_32x32x16_bf16 v[32:47], v[120:123], a[184:187], v[32:47]
    ds_read_b128 v[112:115], v1 offset:20480
    s_waitcnt lgkmcnt(5)
    v_mfma_f32_32x32x16_bf16 v[32:47], v[124:127], a[188:191], v[32:47]
    ds_read_b128 v[116:119], v1 offset:21504
    s_add_u32 m0, s54, 0
    s_xor_b32 s36, s41, 8192
    buffer_load_dwordx4 v1, s[4:7], s36 offen offset:1024 sc1 lds
    s_waitcnt lgkmcnt(5)
    v_mfma_f32_32x32x16_bf16 v[32:47], v[96:99], a[192:195], v[32:47]
    ds_read_b128 v[120:123], v1 offset:22528
    s_waitcnt lgkmcnt(5)
    v_mfma_f32_32x32x16_bf16 v[32:47], v[100:103], a[196:199], v[32:47]
    ds_read_b128 v[124:127], v1 offset:23552
    s_waitcnt lgkmcnt(5)
    v_mfma_f32_32x32x16_bf16 v[32:47], v[104:107], a[200:203], v[32:47]
    s_waitcnt vmcnt(11)
    s_barrier
    ds_read_b128 v[96:99], v1 offset:24576
    s_waitcnt lgkmcnt(5)
    v_mfma_f32_32x32x16_bf16 v[32:47], v[108:111], a[204:207], v[32:47]
    ds_read_b128 v[100:103], v1 offset:25600
    s_add_u32 m0, s54, 8192
    s_xor_b32 s36, s41, 49152
    buffer_load_dwordx4 v1, s[4:7], s36 offen offset:0 sc1 lds
    s_waitcnt lgkmcnt(5)
    v_mfma_f32_32x32x16_bf16 v[32:47], v[112:115], a[208:211], v[32:47]
    ds_read_b128 v[104:107], v1 offset:26624
    s_waitcnt lgkmcnt(5)
    v_mfma_f32_32x32x16_bf16 v[32:47], v[116:119], a[212:215], v[32:47]
    ds_read_b128 v[108:111], v1 offset:27648
    s_waitcnt lgkmcnt(5)
    v_mfma_f32_32x32x16_bf16 v[32:47], v[120:123], a[216:219], v[32:47]
    ds_read_b128 v[112:115], v1 offset:28672
    s_waitcnt lgkmcnt(5)
    v_mfma_f32_32x32x16_bf16 v[32:47], v[124:127], a[220:223], v[32:47]
    ds_read_b128 v[116:119], v1 offset:29696
    s_add_u32 m0, s54, 8192
    s_xor_b32 s36, s41, 49152
    buffer_load_dwordx4 v1, s[4:7], s36 offen offset:1024 sc1 lds
    s_waitcnt lgkmcnt(5)
    v_mfma_f32_32x32x16_bf16 v[32:47], v[96:99], a[224:227], v[32:47]
    ds_read_b128 v[120:123], v1 offset:30720
    s_waitcnt lgkmcnt(5)
    v_mfma_f32_32x32x16_bf16 v[32:47], v[100:103], a[228:231], v[32:47]
    ds_read_b128 v[124:127], v1 offset:31744
    s_waitcnt lgkmcnt(5)
    v_mfma_f32_32x32x16_bf16 v[32:47], v[104:107], a[232:235], v[32:47]
    s_waitcnt vmcnt(9)
    s_barrier
    ds_read_b128 v[96:99], v1 offset:32768
    s_waitcnt lgkmcnt(5)
    v_mfma_f32_32x32x16_bf16 v[32:47], v[108:111], a[236:239], v[32:47]
    ds_read_b128 v[100:103], v1 offset:33792
    s_add_u32 m0, s54, 16384
    s_xor_b32 s36, s41, 57344
    buffer_load_dwordx4 v1, s[4:7], s36 offen offset:0 sc1 lds
    s_waitcnt lgkmcnt(5)
    v_mfma_f32_32x32x16_bf16 v[32:47], v[112:115], a[240:243], v[32:47]
    ds_read_b128 v[104:107], v1 offset:34816
    s_waitcnt lgkmcnt(5)
    v_mfma_f32_32x32x16_bf16 v[32:47], v[116:119], a[244:247], v[32:47]
    ds_read_b128 v[108:111], v1 offset:35840
    s_waitcnt lgkmcnt(5)
    v_mfma_f32_32x32x16_bf16 v[32:47], v[120:123], a[248:251], v[32:47]
    ds_read_b128 v[112:115], v1 offset:36864
    s_waitcnt lgkmcnt(5)
    v_mfma_f32_32x32x16_bf16 v[32:47], v[124:127], a[252:255], v[32:47]
    ds_read_b128 v[116:119], v1 offset:37888
    s_add_u32 m0, s54, 16384
    s_xor_b32 s36, s41, 57344
    buffer_load_dwordx4 v1, s[4:7], s36 offen offset:1024 sc1 lds
    s_waitcnt lgkmcnt(5)
    v_mfma_f32_32x32x16_bf16 v[48:63], v[96:99], a[0:3], 0
    ds_read_b128 v[120:123], v1 offset:38912
    s_waitcnt lgkmcnt(5)
    v_mfma_f32_32x32x16_bf16 v[48:63], v[100:103], a[4:7], v[48:63]
    ds_read_b128 v[124:127], v1 offset:39936
    s_nop 1
    v_cvt_pk_bf16_f32 v128, v32, v33
    v_cvt_pk_bf16_f32 v129, v34, v35
    v_cvt_pk_bf16_f32 v130, v36, v37
    v_cvt_pk_bf16_f32 v132, v38, v39
    s_waitcnt lgkmcnt(5)
    v_mfma_f32_32x32x16_bf16 v[48:63], v[104:107], a[8:11], v[48:63]
    s_waitcnt vmcnt(9)
    s_barrier
    ds_read_b128 v[96:99], v1 offset:40960
    v_cvt_pk_bf16_f32 v133, v40, v41
    v_cvt_pk_bf16_f32 v134, v42, v43
    s_waitcnt lgkmcnt(5)
    v_mfma_f32_32x32x16_bf16 v[48:63], v[108:111], a[12:15], v[48:63]
    ds_read_b128 v[100:103], v1 offset:41984
    s_add_u32 m0, s54, 24576
    s_xor_b32 s36, s41, 32768
    buffer_load_dwordx4 v1, s[4:7], s36 offen offset:0 sc1 lds
    v_cvt_pk_bf16_f32 v136, v44, v45
    s_waitcnt lgkmcnt(5)
    v_mfma_f32_32x32x16_bf16 v[48:63], v[112:115], a[16:19], v[48:63]
    ds_read_b128 v[104:107], v1 offset:43008
    v_cvt_pk_bf16_f32 v137, v46, v47
    s_waitcnt lgkmcnt(5)
    v_mfma_f32_32x32x16_bf16 v[48:63], v[116:119], a[20:23], v[48:63]
    ds_read_b128 v[108:111], v1 offset:44032
    buffer_store_dwordx4 v[128:131], v1, s[4:7], s44 offen offset:0 sc1
    s_waitcnt lgkmcnt(5)
    v_mfma_f32_32x32x16_bf16 v[48:63], v[120:123], a[24:27], v[48:63]
    ds_read_b128 v[112:115], v1 offset:45056
    s_waitcnt lgkmcnt(5)
    v_mfma_f32_32x32x16_bf16 v[48:63], v[124:127], a[28:31], v[48:63]
    ds_read_b128 v[116:119], v1 offset:46080
    s_add_u32 m0, s54, 24576
    s_xor_b32 s36, s41, 32768
    buffer_load_dwordx4 v1, s[4:7], s36 offen offset:1024 sc1 lds
    s_waitcnt lgkmcnt(5)
    v_mfma_f32_32x32x16_bf16 v[48:63], v[96:99], a[32:35], v[48:63]
    ds_read_b128 v[120:123], v1 offset:47104
    s_waitcnt lgkmcnt(5)
    v_mfma_f32_32x32x16_bf16 v[48:63], v[100:103], a[36:39], v[48:63]
    ds_read_b128 v[124:127], v1 offset:48128
    buffer_store_dwordx4 v[132:135], v1, s[4:7], s44 offen offset:1024 sc1
    s_waitcnt lgkmcnt(5)
    v_mfma_f32_32x32x16_bf16 v[48:63], v[104:107], a[40:43], v[48:63]
    s_waitcnt vmcnt(10)
    s_barrier
    ds_read_b128 v[96:99], v1 offset:49152
    s_waitcnt lgkmcnt(5)
    v_mfma_f32_32x32x16_bf16 v[48:63], v[108:111], a[44:47], v[48:63]
    ds_read_b128 v[100:103], v1 offset:50176
    s_add_u32 m0, s54, 32768
    s_xor_b32 s36, s41, 40960
    buffer_load_dwordx4 v1, s[4:7], s36 offen offset:0 sc1 lds
    s_waitcnt lgkmcnt(5)
    v_mfma_f32_32x32x16_bf16 v[48:63], v[112:115], a[48:51], v[48:63]
    ds_read_b128 v[104:107], v1 offset:51200
    s_waitcnt lgkmcnt(5)
    v_mfma_f32_32x32x16_bf16 v[48:63], v[116:119], a[52:55], v[48:63]
    ds_read_b128 v[108:111], v1 offset:52224
    s_waitcnt lgkmcnt(5)
    v_mfma_f32_32x32x16_bf16 v[48:63], v[120:123], a[56:59], v[48:63]
    ds_read_b128 v[112:115], v1 offset:53248
    buffer_store_dwordx4 v[136:139], v1, s[4:7], s44 offen offset:2048 sc1
    s_waitcnt lgkmcnt(5)
    v_mfma_f32_32x32x16_bf16 v[48:63], v[124:127], a[60:63], v[48:63]
    ds_read_b128 v[116:119], v1 offset:54272
    s_add_u32 m0, s54, 32768
    s_xor_b32 s36, s41, 40960
    buffer_load_dwordx4 v1, s[4:7], s36 offen offset:1024 sc1 lds
    s_waitcnt lgkmcnt(5)
    v_mfma_f32_32x32x16_bf16 v[48:63], v[96:99], a[64:67], v[48:63]
    ds_read_b128 v[120:123], v1 offset:55296
    s_waitcnt lgkmcnt(5)
    v_mfma_f32_32x32x16_bf16 v[48:63], v[100:103], a[68:71], v[48:63]
    ds_read_b128 v[124:127], v1 offset:56320
    s_waitcnt lgkmcnt(5)
    v_mfma_f32_32x32x16_bf16 v[48:63], v[104:107], a[72:75], v[48:63]
    s_waitcnt vmcnt(11)
    s_barrier
    ds_read_b128 v[96:99], v1 offset:0
    s_waitcnt lgkmcnt(5)
    v_mfma_f32_32x32x16_bf16 v[48:63], v[108:111], a[76:79], v[48:63]
    ds_read_b128 v[100:103], v1 offset:1024
    s_add_u32 m0, s54, 40960
    s_xor_b32 s36, s42, 16384
    buffer_load_dwordx4 v1, s[4:7], s36 offen offset:0 sc1 lds
    s_waitcnt lgkmcnt(5)
    v_mfma_f32_32x32x16_bf16 v[48:63], v[112:115], a[80:83], v[48:63]
    ds_read_b128 v[104:107], v1 offset:2048
    s_waitcnt lgkmcnt(5)
    v_mfma_f32_32x32x16_bf16 v[48:63], v[116:119], a[84:87], v[48:63]
    ds_read_b128 v[108:111], v1 offset:3072
    s_add_u32 s36, s54, 25694208
    buffer_load_dwordx4 v[140:143], v1, s[4:7], s36 offen offset:0 sc1
    s_waitcnt lgkmcnt(5)
    v_mfma_f32_32x32x16_bf16 v[48:63], v[120:123], a[88:91], v[48:63]
    ds_read_b128 v[112:115], v1 offset:4096
    s_waitcnt lgkmcnt(5)
    v_mfma_f32_32x32x16_bf16 v[48:63], v[124:127], a[92:95], v[48:63]
    ds_read_b128 v[116:119], v1 offset:5120
    s_add_u32 m0, s54, 40960
    s_xor_b32 s36, s42, 16384
    buffer_load_dwordx4 v1, s[4:7], s36 offen offset:1024 sc1 lds
    s_waitcnt lgkmcnt(5)
    v_mfma_f32_32x32x16_bf16 v[48:63], v[96:99], a[96:99], v[48:63]
    ds_read_b128 v[120:123], v1 offset:6144
    s_waitcnt lgkmcnt(5)
    v_mfma_f32_32x32x16_bf16 v[48:63], v[100:103], a[100:103], v[48:63]
    ds_read_b128 v[124:127], v1 offset:7168
    s_add_u32 s36, s54, 25694208
    buffer_load_dwordx4 v[156:159], v1, s[4:7], s36 offen offset:1024 sc1
    s_waitcnt lgkmcnt(5)
    v_mfma_f32_32x32x16_bf16 v[48:63], v[104:107], a[104:107], v[48:63]
    s_waitcnt vmcnt(13)
    s_barrier
    ds_read_b128 v[96:99], v1 offset:8192
    s_waitcnt lgkmcnt(5)
    v_mfma_f32_32x32x16_bf16 v[48:63], v[108:111], a[108:111], v[48:63]
    ds_read_b128 v[100:103], v1 offset:9216
    s_add_u32 m0, s54, 49152
    s_xor_b32 s36, s42, 24576
    buffer_load_dwordx4 v1, s[4:7], s36 offen offset:0 sc1 lds
    s_waitcnt lgkmcnt(5)
    v_mfma_f32_32x32x16_bf16 v[48:63], v[112:115], a[112:115], v[48:63]
    ds_read_b128 v[104:107], v1 offset:10240
    s_waitcnt lgkmcnt(5)
    v_mfma_f32_32x32x16_bf16 v[48:63], v[116:119], a[116:119], v[48:63]
    ds_read_b128 v[108:111], v1 offset:11264
    s_waitcnt lgkmcnt(5)
    v_mfma_f32_32x32x16_bf16 v[48:63], v[120:123], a[120:123], v[48:63]
    ds_read_b128 v[112:115], v1 offset:12288
    s_add_u32 s36, s54, 25706496
    buffer_load_dwordx4 v[144:147], v1, s[4:7], s36 offen offset:0 sc1
    s_waitcnt lgkmcnt(5)
    v_mfma_f32_32x32x16_bf16 v[48:63], v[124:127], a[124:127], v[48:63]
    ds_read_b128 v[116:119], v1 offset:13312
    s_add_u32 m0, s54, 49152
    s_xor_b32 s36, s42, 24576
    buffer_load_dwordx4 v1, s[4:7], s36 offen offset:1024 sc1 lds
    s_waitcnt lgkmcnt(5)
    v_mfma_f32_32x32x16_bf16 v[48:63], v[96:99], a[128:131], v[48:63]
    ds_read_b128 v[120:123], v1 offset:14336
    s_waitcnt lgkmcnt(5)
    v_mfma_f32_32x32x16_bf16 v[48:63], v[100:103], a[132:135], v[48:63]
    ds_read_b128 v[124:127], v1 offset:15360
    s_waitcnt lgkmcnt(5)
    v_mfma_f32_32x32x16_bf16 v[48:63], v[104:107], a[136:139], v[48:63]
    s_waitcnt vmcnt(14)
    s_barrier
    ds_read_b128 v[96:99], v1 offset:16384
    s_waitcnt lgkmcnt(5)
    v_mfma_f32_32x32x16_bf16 v[48:63], v[108:111], a[140:143], v[48:63]
    ds_read_b128 v[100:103], v1 offset:17408
    s_add_u32 m0, s54, 0
    s_xor_b32 s36, s42, 0
    buffer_load_dwordx4 v1, s[4:7], s36 offen offset:0 sc1 lds
    s_waitcnt lgkmcnt(5)
    v_mfma_f32_32x32x16_bf16 v[48:63], v[112:115], a[144:147], v[48:63]
    ds_read_b128 v[104:107], v1 offset:18432
    s_waitcnt lgkmcnt(5)
    v_mfma_f32_32x32x16_bf16 v[48:63], v[116:119], a[148:151], v[48:63]
    ds_read_b128 v[108:111], v1 offset:19456
    s_add_u32 s36, s54, 25706496
    buffer_load_dwordx4 v[160:163], v1, s[4:7], s36 offen offset:1024 sc1
    s_waitcnt lgkmcnt(5)
    v_mfma_f32_32x32x16_bf16 v[48:63], v[120:123], a[152:155], v[48:63]
    ds_read_b128 v[112:115], v1 offset:20480
    s_waitcnt lgkmcnt(5)
    v_mfma_f32_32x32x16_bf16 v[48:63], v[124:127], a[156:159], v[48:63]
    ds_read_b128 v[116:119], v1 offset:21504
    s_add_u32 m0, s54, 0
    s_xor_b32 s36, s42, 0
    buffer_load_dwordx4 v1, s[4:7], s36 offen offset:1024 sc1 lds
    s_waitcnt lgkmcnt(5)
    v_mfma_f32_32x32x16_bf16 v[48:63], v[96:99], a[160:163], v[48:63]
    ds_read_b128 v[120:123], v1 offset:22528
    s_waitcnt lgkmcnt(5)
    v_mfma_f32_32x32x16_bf16 v[48:63], v[100:103], a[164:167], v[48:63]
    ds_read_b128 v[124:127], v1 offset:23552
    s_add_u32 s36, s54, 25718784
    buffer_load_dwordx4 v[148:151], v1, s[4:7], s36 offen offset:0 sc1
    s_waitcnt lgkmcnt(5)
    v_mfma_f32_32x32x16_bf16 v[48:63], v[104:107], a[168:171], v[48:63]
    s_waitcnt vmcnt(15)
    s_barrier
    ds_read_b128 v[96:99], v1 offset:24576
    s_waitcnt lgkmcnt(5)
    v_mfma_f32_32x32x16_bf16 v[48:63], v[108:111], a[172:175], v[48:63]
    ds_read_b128 v[100:103], v1 offset:25600
    s_add_u32 m0, s54, 8192
    s_xor_b32 s36, s42, 8192
    buffer_load_dwordx4 v1, s[4:7], s36 offen offset:0 sc1 lds
    s_waitcnt lgkmcnt(5)
    v_mfma_f32_32x32x16_bf16 v[48:63], v[112:115], a[176:179], v[48:63]
    ds_read_b128 v[104:107], v1 offset:26624
    s_waitcnt lgkmcnt(5)
    v_mfma_f32_32x32x16_bf16 v[48:63], v[116:119], a[180:183], v[48:63]
    ds_read_b128 v[108:111], v1 offset:27648
    s_waitcnt lgkmcnt(5)
    v_mfma_f32_32x32x16_bf16 v[48:63], v[120:123], a[184:187], v[48:63]
    ds_read_b128 v[112:115], v1 offset:28672
    s_add_u32 s36, s54, 25718784
    buffer_load_dwordx4 v[164:167], v1, s[4:7], s36 offen offset:1024 sc1
    s_waitcnt lgkmcnt(5)
    v_mfma_f32_32x32x16_bf16 v[48:63], v[124:127], a[188:191], v[48:63]
    ds_read_b128 v[116:119], v1 offset:29696
    s_add_u32 m0, s54, 8192
    s_xor_b32 s36, s42, 8192
    buffer_load_dwordx4 v1, s[4:7], s36 offen offset:1024 sc1 lds
    s_waitcnt lgkmcnt(5)
    v_mfma_f32_32x32x16_bf16 v[48:63], v[96:99], a[192:195], v[48:63]
    ds_read_b128 v[120:123], v1 offset:30720
    s_waitcnt lgkmcnt(5)
    v_mfma_f32_32x32x16_bf16 v[48:63], v[100:103], a[196:199], v[48:63]
    ds_read_b128 v[124:127], v1 offset:31744
    s_waitcnt lgkmcnt(5)
    v_mfma_f32_32x32x16_bf16 v[48:63], v[104:107], a[200:203], v[48:63]
    s_waitcnt vmcnt(14)
    s_barrier
    ds_read_b128 v[96:99], v1 offset:32768
    s_waitcnt lgkmcnt(5)
    v_mfma_f32_32x32x16_bf16 v[48:63], v[108:111], a[204:207], v[48:63]
    ds_read_b128 v[100:103], v1 offset:33792
    s_add_u32 m0, s54, 16384
    s_xor_b32 s36, s42, 49152
    buffer_load_dwordx4 v1, s[4:7], s36 offen offset:0 sc1 lds
    s_waitcnt lgkmcnt(5)
    v_mfma_f32_32x32x16_bf16 v[48:63], v[112:115], a[208:211], v[48:63]
    ds_read_b128 v[104:107], v1 offset:34816
    s_waitcnt lgkmcnt(5)
    v_mfma_f32_32x32x16_bf16 v[48:63], v[116:119], a[212:215], v[48:63]
    ds_read_b128 v[108:111], v1 offset:35840
    s_add_u32 s36, s54, 25731072
    buffer_load_dwordx4 v[152:155], v1, s[4:7], s36 offen offset:0 sc1
    s_waitcnt lgkmcnt(5)
    v_mfma_f32_32x32x16_bf16 v[48:63], v[120:123], a[216:219], v[48:63]
    ds_read_b128 v[112:115], v1 offset:36864
    s_waitcnt lgkmcnt(5)
    v_mfma_f32_32x32x16_bf16 v[48:63], v[124:127], a[220:223], v[48:63]
    ds_read_b128 v[116:119], v1 offset:37888
    s_add_u32 m0, s54, 16384
    s_xor_b32 s36, s42, 49152
    buffer_load_dwordx4 v1, s[4:7], s36 offen offset:1024 sc1 lds
    s_waitcnt lgkmcnt(5)
    v_mfma_f32_32x32x16_bf16 v[48:63], v[96:99], a[224:227], v[48:63]
    ds_read_b128 v[120:123], v1 offset:38912
    s_waitcnt lgkmcnt(5)
    v_mfma_f32_32x32x16_bf16 v[48:63], v[100:103], a[228:231], v[48:63]
    ds_read_b128 v[124:127], v1 offset:39936
    s_waitcnt lgkmcnt(5)
    v_mfma_f32_32x32x16_bf16 v[48:63], v[104:107], a[232:235], v[48:63]
    s_waitcnt vmcnt(14)
    s_barrier
    ds_read_b128 v[96:99], v1 offset:40960
    s_waitcnt lgkmcnt(5)
    v_mfma_f32_32x32x16_bf16 v[48:63], v[108:111], a[236:239], v[48:63]
    ds_read_b128 v[100:103], v1 offset:41984
    s_add_u32 m0, s54, 24576
    s_xor_b32 s36, s42, 57344
    buffer_load_dwordx4 v1, s[4:7], s36 offen offset:0 sc1 lds
    s_waitcnt lgkmcnt(5)
    v_mfma_f32_32x32x16_bf16 v[48:63], v[112:115], a[240:243], v[48:63]
    ds_read_b128 v[104:107], v1 offset:43008
    s_waitcnt lgkmcnt(5)
    v_mfma_f32_32x32x16_bf16 v[48:63], v[116:119], a[244:247], v[48:63]
    ds_read_b128 v[108:111], v1 offset:44032
    s_add_u32 s36, s54, 25731072
    buffer_load_dwordx4 v[168:171], v1, s[4:7], s36 offen offset:1024 sc1
    s_waitcnt vmcnt(0)
    v_xor_b32 v172, v30, v143
    v_xor_b32 v173, v30, v147
    v_xor_b32 v174, v30, v151
    v_xor_b32 v175, v30, v155
    v_xor_b32 v176, v30, v159
    v_xor_b32 v177, v30, v163
    v_xor_b32 v178, v30, v167
    v_xor_b32 v179, v30, v171
    v_or3_b32 v172, v172, v173, v174
    v_or3_b32 v175, v175, v176, v177
    v_or3_b32 v172, v172, v178, v179
    v_or_b32 v172, v172, v175
    v_cmp_ne_u32 vcc, 0, v172
    s_nop 3
    s_cbranch_vccnz LM_26
LMD_27:
    s_mov_b32 s60, 0x04000c0c
    s_mov_b32 s61, 0x0706000c
    s_cmp_eq_u32 s3, 2
    s_cselect_b32 s62, 1.0, 0
    s_lshl_b32 s63, s3, 10
    s_add_u32 s63, s63, 57344
    s_waitcnt lgkmcnt(5)
    v_mfma_f32_32x32x16_bf16 v[48:63], v[120:123], a[248:251], v[48:63]
    ds_read_b128 v[112:115], v1 offset:45056
    v_perm_b32 v172, v142, v141, s60
    v_perm_b32 v173, v146, v145, s60
    v_perm_b32 v174, v150, v149, s60
    v_perm_b32 v175, v154, v153, s60
    s_waitcnt lgkmcnt(5)
    v_mfma_f32_32x32x16_bf16 v[48:63], v[124:127], a[252:255], v[48:63]
    ds_read_b128 v[116:119], v1 offset:46080
    s_add_u32 m0, s54, 24576
    s_xor_b32 s36, s42, 57344
    buffer_load_dwordx4 v1, s[4:7], s36 offen offset:1024 sc1 lds
    v_perm_b32 v143, v172, v140, s61
    s_waitcnt lgkmcnt(5)
    v_mfma_f32_32x32x16_bf16 v[64:79], v[96:99], a[0:3], 0
    ds_read_b128 v[120:123], v1 offset:47104
    v_perm_b32 v147, v173, v144, s61
    v_perm_b32 v151, v174, v148, s61
    v_perm_b32 v155, v175, v152, s61
    v_add_f32 v140, v140, v144
    s_waitcnt lgkmcnt(5)
    v_mfma_f32_32x32x16_bf16 v[64:79], v[100:103], a[4:7], v[64:79]
    ds_read_b128 v[124:127], v1 offset:48128
    s_xor_b32 m0, s53, 2048
    s_xor_b32 s36, s52, 2
    s_mul_i32 s36, s36, 44032
    buffer_load_dwordx4 v14, s[16:19], s36 offen lds
    v_cvt_pk_bf16_f32 v128, v48, v49
    s_waitcnt lgkmcnt(5)
    v_mfma_f32_32x32x16_bf16 v[64:79], v[104:107], a[8:11], v[64:79]
    s_barrier
    ds_read_b128 v[96:99], v1 offset:49152
    v_cvt_pk_bf16_f32 v129, v50, v51
    v_cvt_pk_bf16_f32 v130, v52, v53
    s_waitcnt lgkmcnt(5)
    v_mfma_f32_32x32x16_bf16 v[64:79], v[108:111], a[12:15], v[64:79]
    ds_read_b128 v[100:103], v1 offset:50176
    s_add_u32 m0, s54, 32768
    s_xor_b32 s36, s42, 32768
    buffer_load_dwordx4 v1, s[4:7], s36 offen offset:0 sc1 lds
    v_cvt_pk_bf16_f32 v132, v54, v55
    s_waitcnt lgkmcnt(5)
    v_mfma_f32_32x32x16_bf16 v[64:79], v[112:115], a[16:19], v[64:79]
    ds_read_b128 v[104:107], v1 offset:51200
    v_cvt_pk_bf16_f32 v133, v56, v57
    v_cvt_pk_bf16_f32 v134, v58, v59
    v_cvt_pk_bf16_f32 v136, v60, v61
    v_cvt_pk_bf16_f32 v137, v62, v63
    s_waitcnt lgkmcnt(5)
    v_mfma_f32_32x32x16_bf16 v[64:79], v[116:119], a[20:23], v[64:79]
    ds_read_b128 v[108:111], v1 offset:52224
    v_add_f32 v141, v141, v145
    v_add_f32 v142, v142, v146
    v_add_f32 v143, v143, v147
    v_add_f32 v148, v148, v152
    s_waitcnt lgkmcnt(5)
    v_mfma_f32_32x32x16_bf16 v[64:79], v[120:123], a[24:27], v[64:79]
    ds_read_b128 v[112:115], v1 offset:53248
    buffer_store_dwordx4 v[128:131], v1, s[4:7], s45 offen offset:0 sc1
    v_add_f32 v149, v149, v153
    s_waitcnt lgkmcnt(5)
    v_mfma_f32_32x32x16_bf16 v[64:79], v[124:127], a[28:31], v[64:79]
    ds_read_b128 v[116:119], v1 offset:54272
    s_add_u32 m0, s54, 32768
    s_xor_b32 s36, s42, 32768
    buffer_load_dwordx4 v1, s[4:7], s36 offen offset:1024 sc1 lds
    v_add_f32 v150, v150, v154
    s_waitcnt lgkmcnt(5)
    v_mfma_f32_32x32x16_bf16 v[64:79], v[96:99], a[32:35], v[64:79]
    ds_read_b128 v[120:123], v1 offset:55296
    v_add_f32 v151, v151, v155
    v_add_f32 v140, v140, v148
    v_add_f32 v141, v141, v149
    v_add_f32 v142, v142, v150
    s_waitcnt lgkmcnt(5)
    v_mfma_f32_32x32x16_bf16 v[64:79], v[100:103], a[36:39], v[64:79]
    ds_read_b128 v[124:127], v1 offset:56320
    v_add_f32 v143, v143, v151
    v_cvt_pk_bf16_f32 v144, v140, v141
    v_cvt_pk_bf16_f32 v145, v142, v143
    v_lshlrev_b32 v140, 16, v144
    s_waitcnt lgkmcnt(5)
    v_mfma_f32_32x32x16_bf16 v[64:79], v[104:107], a[40:43], v[64:79]
    s_barrier
    ds_read_b128 v[96:99], v1 offset:0
    v_and_b32 v141, 0xffff0000, v144
    v_lshlrev_b32 v142, 16, v145
    s_waitcnt lgkmcnt(5)
    v_mfma_f32_32x32x16_bf16 v[64:79], v[108:111], a[44:47], v[64:79]
    ds_read_b128 v[100:103], v1 offset:1024
    s_add_u32 m0, s54, 40960
    s_xor_b32 s36, s42, 40960
    buffer_load_dwordx4 v1, s[4:7], s36 offen offset:0 sc1 lds
    v_and_b32 v143, 0xffff0000, v145
    s_waitcnt lgkmcnt(5)
    v_mfma_f32_32x32x16_bf16 v[64:79], v[112:115], a[48:51], v[64:79]
    ds_read_b128 v[104:107], v1 offset:2048
    v_add_f32 v140, s62, v140
    v_add_f32 v141, s62, v141
    v_add_f32 v142, s62, v142
    v_add_f32 v143, s62, v143
    s_waitcnt lgkmcnt(5)
    v_mfma_f32_32x32x16_bf16 v[64:79], v[116:119], a[52:55], v[64:79]
    ds_read_b128 v[108:111], v1 offset:3072
    buffer_store_dwordx4 v[132:135], v1, s[4:7], s45 offen offset:1024 sc1
    v_cvt_pk_bf16_f32 v144, v140, v141
    s_waitcnt lgkmcnt(5)
    v_mfma_f32_32x32x16_bf16 v[64:79], v[120:123], a[56:59], v[64:79]
    ds_read_b128 v[112:115], v1 offset:4096
    v_cvt_pk_bf16_f32 v145, v142, v143
    v_lshl_add_u32 v176, v0, 3, s63
    ds_write_b64 v176, v[144:145] offset:0
    v_perm_b32 v172, v158, v157, s60
    s_waitcnt lgkmcnt(6)
    v_mfma_f32_32x32x16_bf16 v[64:79], v[124:127], a[60:63], v[64:79]
    ds_read_b128 v[116:119], v1 offset:5120
    s_add_u32 m0, s54, 40960
    s_xor_b32 s36, s42, 40960
    buffer_load_dwordx4 v1, s[4:7], s36 offen offset:1024 sc1 lds
    v_perm_b32 v173, v162, v161, s60
    s_waitcnt lgkmcnt(6)
    v_mfma_f32_32x32x16_bf16 v[64:79], v[96:99], a[64:67], v[64:79]
    ds_read_b128 v[120:123], v1 offset:6144
    v_perm_b32 v174, v166, v165, s60
    v_perm_b32 v175, v170, v169, s60
    v_perm_b32 v159, v172, v156, s61
    v_perm_b32 v163, v173, v160, s61
    s_waitcnt lgkmcnt(6)
    v_mfma_f32_32x32x16_bf16 v[64:79], v[100:103], a[68:71], v[64:79]
    ds_read_b128 v[124:127], v1 offset:7168
    buffer_store_dwordx4 v[136:139], v1, s[4:7], s45 offen offset:2048 sc1
    v_perm_b32 v167, v174, v164, s61
    s_waitcnt lgkmcnt(6)
    v_mfma_f32_32x32x16_bf16 v[64:79], v[104:107], a[72:75], v[64:79]
    s_waitcnt lgkmcnt(3)
    s_barrier
    ds_read_b128 v[96:99], v1 offset:8192
    v_perm_b32 v171, v175, v168, s61
    v_add_f32 v156, v156, v160
    v_mfma_f32_32x32x16_bf16 v[64:79], v[108:111], a[76:79], v[64:79]
    ds_read_b128 v[100:103], v1 offset:9216
    s_add_u32 m0, s54, 49152
    s_xor_b32 s36, s43, 16384
    buffer_load_dwordx4 v1, s[4:7], s36 offen offset:0 sc1 lds
    v_add_f32 v157, v157, v161
    v_mfma_f32_32x32x16_bf16 v[64:79], v[112:115], a[80:83], v[64:79]
    ds_read_b128 v[104:107], v1 offset:10240
    v_add_f32 v158, v158, v162
    v_add_f32 v159, v159, v163
    v_add_f32 v164, v164, v168
    v_add_f32 v165, v165, v169
    s_waitcnt lgkmcnt(5)
    v_mfma_f32_32x32x16_bf16 v[64:79], v[116:119], a[84:87], v[64:79]
    ds_read_b128 v[108:111], v1 offset:11264
    v_add_f32 v166, v166, v170
    v_add_f32 v167, v167, v171
    v_add_f32 v156, v156, v164
    v_add_f32 v157, v157, v165
    s_waitcnt lgkmcnt(5)
    v_mfma_f32_32x32x16_bf16 v[64:79], v[120:123], a[88:91], v[64:79]
    ds_read_b128 v[112:115], v1 offset:12288
    s_xor_b32 m0, s53, 34816
    s_xor_b32 s36, s52, 2
    s_mul_i32 s36, s36, 44032
    buffer_load_dwordx4 v15, s[16:19], s36 offen lds
    v_add_f32 v158, v158, v166
    s_waitcnt lgkmcnt(5)
    v_mfma_f32_32x32x16_bf16 v[64:79], v[124:127], a[92:95], v[64:79]
    ds_read_b128 v[116:119], v1 offset:13312
    s_add_u32 m0, s54, 49152
    s_xor_b32 s36, s43, 16384
    buffer_load_dwordx4 v1, s[4:7], s36 offen offset:1024 sc1 lds
    v_add_f32 v159, v159, v167
    s_waitcnt lgkmcnt(5)
    v_mfma_f32_32x32x16_bf16 v[64:79], v[96:99], a[96:99], v[64:79]
    ds_read_b128 v[120:123], v1 offset:14336
    v_cvt_pk_bf16_f32 v160, v156, v157
    v_cvt_pk_bf16_f32 v161, v158, v159
    v_lshlrev_b32 v156, 16, v160
    v_and_b32 v157, 0xffff0000, v160
    s_waitcnt lgkmcnt(5)
    v_mfma_f32_32x32x16_bf16 v[64:79], v[100:103], a[100:103], v[64:79]
    ds_read_b128 v[124:127], v1 offset:15360
    v_lshlrev_b32 v158, 16, v161
    v_and_b32 v159, 0xffff0000, v161
    v_add_f32 v156, s62, v156
    v_add_f32 v157, s62, v157
    s_waitcnt lgkmcnt(5)
    v_mfma_f32_32x32x16_bf16 v[64:79], v[104:107], a[104:107], v[64:79]
    s_barrier
    ds_read_b128 v[96:99], v1 offset:16384
    v_add_f32 v158, s62, v158
    v_add_f32 v159, s62, v159
    s_waitcnt lgkmcnt(5)
    v_mfma_f32_32x32x16_bf16 v[64:79], v[108:111], a[108:111], v[64:79]
    ds_read_b128 v[100:103], v1 offset:17408
    s_add_u32 m0, s54, 0
    s_xor_b32 s36, s43, 24576
    buffer_load_dwordx4 v1, s[4:7], s36 offen offset:0 sc1 lds
    v_cvt_pk_bf16_f32 v160, v156, v157
    s_waitcnt lgkmcnt(5)
    v_mfma_f32_32x32x16_bf16 v[64:79], v[112:115], a[112:115], v[64:79]
    ds_read_b128 v[104:107], v1 offset:18432
    v_cvt_pk_bf16_f32 v161, v158, v159
    ds_write_b64 v176, v[160:161] offset:512
    s_waitcnt lgkmcnt(6)
    v_mfma_f32_32x32x16_bf16 v[64:79], v[116:119], a[116:119], v[64:79]
    ds_read_b128 v[108:111], v1 offset:19456
    s_xor_b32 m0, s53, 198656
    s_xor_b32 s36, s52, 2
    s_mul_i32 s36, s36, 44032
    buffer_load_dwordx4 v16, s[16:19], s36 offen lds
    s_waitcnt lgkmcnt(6)
    v_mfma_f32_32x32x16_bf16 v[64:79], v[120:123], a[120:123], v[64:79]
    ds_read_b128 v[112:115], v1 offset:20480
    s_waitcnt lgkmcnt(6)
    v_mfma_f32_32x32x16_bf16 v[64:79], v[124:127], a[124:127], v[64:79]
    ds_read_b128 v[116:119], v1 offset:21504
    s_add_u32 m0, s54, 0
    s_xor_b32 s36, s43, 24576
    buffer_load_dwordx4 v1, s[4:7], s36 offen offset:1024 sc1 lds
    s_waitcnt lgkmcnt(6)
    v_mfma_f32_32x32x16_bf16 v[64:79], v[96:99], a[128:131], v[64:79]
    ds_read_b128 v[120:123], v1 offset:22528
    s_waitcnt lgkmcnt(6)
    v_mfma_f32_32x32x16_bf16 v[64:79], v[100:103], a[132:135], v[64:79]
    ds_read_b128 v[124:127], v1 offset:23552
    s_add_u32 s36, s47, 0
    buffer_load_dwordx4 v[140:143], v1, s[4:7], s36 offen offset:0 sc1
    s_waitcnt lgkmcnt(6)
    v_mfma_f32_32x32x16_bf16 v[64:79], v[104:107], a[136:139], v[64:79]
    s_waitcnt vmcnt(15) lgkmcnt(5)
    s_barrier
    ds_read_b128 v[96:99], v1 offset:24576
    ds_read_b128 v[236:239], v8 offset:0
    ds_read_b128 v[240:243], v8 offset:32
    s_waitcnt lgkmcnt(7)
    v_mfma_f32_32x32x16_bf16 v[64:79], v[108:111], a[140:143], v[64:79]
    ds_read_b128 v[100:103], v1 offset:25600
    s_add_u32 m0, s54, 8192
    s_xor_b32 s36, s43, 0
    buffer_load_dwordx4 v1, s[4:7], s36 offen offset:0 sc1 lds
    ds_read_b128 v[244:247], v8 offset:2048
    s_waitcnt lgkmcnt(8)
    v_mfma_f32_32x32x16_bf16 v[64:79], v[112:115], a[144:147], v[64:79]
    ds_read_b128 v[104:107], v1 offset:26624
    ds_read_b128 v[248:251], v8 offset:2080
    s_nop 0
    s_nop 0
    s_nop 0
    s_waitcnt lgkmcnt(9)
    v_mfma_f32_32x32x16_bf16 v[64:79], v[116:119], a[148:151], v[64:79]
    ds_read_b128 v[108:111], v1 offset:27648
    s_nop 0
    s_nop 0
    s_nop 0
    s_waitcnt lgkmcnt(1)
    v_mfma_f32_32x32x16_bf16 v[64:79], v[120:123], a[152:155], v[64:79]
    ds_read_b128 v[112:115], v1 offset:28672
    s_add_u32 s36, s47, 0
    buffer_load_dwordx4 v[144:147], v1, s[4:7], s36 offen offset:1024 sc1
    v_lshlrev_b32 v188, 16, v236
    v_mfma_f32_32x32x16_bf16 v[64:79], v[124:127], a[156:159], v[64:79]
    ds_read_b128 v[116:119], v1 offset:29696
    s_add_u32 m0, s54, 8192
    s_xor_b32 s36, s43, 0
    buffer_load_dwordx4 v1, s[4:7], s36 offen offset:1024 sc1 lds
    v_and_b32 v189, 0xffff0000, v236
    v_mfma_f32_32x32x16_bf16 v[64:79], v[96:99], a[160:163], v[64:79]
    ds_read_b128 v[120:123], v1 offset:30720
    v_lshlrev_b32 v190, 16, v237
    v_and_b32 v191, 0xffff0000, v237
    v_lshlrev_b32 v192, 16, v238
    v_and_b32 v193, 0xffff0000, v238
    v_mfma_f32_32x32x16_bf16 v[64:79], v[100:103], a[164:167], v[64:79]
    ds_read_b128 v[124:127], v1 offset:31744
    v_lshlrev_b32 v194, 16, v239
    v_and_b32 v195, 0xffff0000, v239
    v_lshlrev_b32 v196, 16, v240
    v_and_b32 v197, 0xffff0000, v240
    v_mfma_f32_32x32x16_bf16 v[64:79], v[104:107], a[168:171], v[64:79]
    s_waitcnt vmcnt(14)
    s_barrier
    ds_read_b128 v[96:99], v1 offset:32768
    v_lshlrev_b32 v198, 16, v241
    v_and_b32 v199, 0xffff0000, v241
    s_waitcnt lgkmcnt(5)
    v_mfma_f32_32x32x16_bf16 v[64:79], v[108:111], a[172:175], v[64:79]
    ds_read_b128 v[100:103], v1 offset:33792
    s_add_u32 m0, s54, 16384
    s_xor_b32 s36, s43, 8192
    buffer_load_dwordx4 v1, s[4:7], s36 offen offset:0 sc1 lds
    v_lshlrev_b32 v200, 16, v242
    s_waitcnt lgkmcnt(5)
    v_mfma_f32_32x32x16_bf16 v[64:79], v[112:115], a[176:179], v[64:79]
    ds_read_b128 v[104:107], v1 offset:34816
    v_and_b32 v201, 0xffff0000, v242
    v_lshlrev_b32 v202, 16, v243
    v_and_b32 v203, 0xffff0000, v243
    v_lshlrev_b32 v204, 16, v244
    s_waitcnt lgkmcnt(5)
    v_mfma_f32_32x32x16_bf16 v[64:79], v[116:119], a[180:183], v[64:79]
    ds_read_b128 v[108:111], v1 offset:35840
    s_add_u32 s36, s47, 0
    buffer_load_dwordx4 v[148:151], v1, s[4:7], s36 offen offset:2048 sc1
    v_and_b32 v205, 0xffff0000, v244
    s_waitcnt lgkmcnt(5)
    v_mfma_f32_32x32x16_bf16 v[64:79], v[120:123], a[184:187], v[64:79]
    ds_read_b128 v[112:115], v1 offset:36864
    v_lshlrev_b32 v206, 16, v245
    v_and_b32 v207, 0xffff0000, v245
    v_lshlrev_b32 v208, 16, v246
    v_and_b32 v209, 0xffff0000, v246
    s_waitcnt lgkmcnt(5)
    v_mfma_f32_32x32x16_bf16 v[64:79], v[124:127], a[188:191], v[64:79]
    ds_read_b128 v[116:119], v1 offset:37888
    s_add_u32 m0, s54, 16384
    s_xor_b32 s36, s43, 8192
    buffer_load_dwordx4 v1, s[4:7], s36 offen offset:1024 sc1 lds
    v_lshlrev_b32 v210, 16, v247
    s_waitcnt lgkmcnt(5)
    v_mfma_f32_32x32x16_bf16 v[64:79], v[96:99], a[192:195], v[64:79]
    ds_read_b128 v[120:123], v1 offset:38912
    v_and_b32 v211, 0xffff0000, v247
    v_lshlrev_b32 v212, 16, v248
    v_and_b32 v213, 0xffff0000, v248
    v_lshlrev_b32 v214, 16, v249
    s_waitcnt lgkmcnt(5)
    v_mfma_f32_32x32x16_bf16 v[64:79], v[100:103], a[196:199], v[64:79]
    ds_read_b128 v[124:127], v1 offset:39936
    v_and_b32 v215, 0xffff0000, v249
    v_lshlrev_b32 v216, 16, v250
    v_and_b32 v217, 0xffff0000, v250
    v_lshlrev_b32 v218, 16, v251
    s_waitcnt lgkmcnt(5)
    v_mfma_f32_32x32x16_bf16 v[64:79], v[104:107], a[200:203], v[64:79]
    s_waitcnt vmcnt(14)
    s_barrier
    ds_read_b128 v[96:99], v1 offset:40960
    v_and_b32 v219, 0xffff0000, v251
    s_waitcnt lgkmcnt(5)
    v_mfma_f32_32x32x16_bf16 v[64:79], v[108:111], a[204:207], v[64:79]
    ds_read_b128 v[100:103], v1 offset:41984
    s_add_u32 m0, s54, 24576
    s_xor_b32 s36, s43, 49152
    buffer_load_dwordx4 v1, s[4:7], s36 offen offset:0 sc1 lds
    v_lshlrev_b32 v220, 16, v180
    s_waitcnt lgkmcnt(5)
    v_mfma_f32_32x32x16_bf16 v[64:79], v[112:115], a[208:211], v[64:79]
    ds_read_b128 v[104:107], v1 offset:43008
    v_and_b32 v221, 0xffff0000, v180
    v_lshlrev_b32 v222, 16, v181
    v_and_b32 v223, 0xffff0000, v181
    v_lshlrev_b32 v224, 16, v182
    s_waitcnt lgkmcnt(5)
    v_mfma_f32_32x32x16_bf16 v[64:79], v[116:119], a[212:215], v[64:79]
    ds_read_b128 v[108:111], v1 offset:44032
    s_add_u32 s36, s47, 3072
    buffer_load_dwordx4 v[152:155], v1, s[4:7], s36 offen offset:0 sc1
    v_and_b32 v225, 0xffff0000, v182
    s_waitcnt lgkmcnt(5)
    v_mfma_f32_32x32x16_bf16 v[64:79], v[120:123], a[216:219], v[64:79]
    ds_read_b128 v[112:115], v1 offset:45056
    v_lshlrev_b32 v226, 16, v183
    v_and_b32 v227, 0xffff0000, v183
    v_lshlrev_b32 v228, 16, v184
    v_and_b32 v229, 0xffff0000, v184
    s_waitcnt lgkmcnt(5)
    v_mfma_f32_32x32x16_bf16 v[64:79], v[124:127], a[220:223], v[64:79]
    ds_read_b128 v[116:119], v1 offset:46080
    s_add_u32 m0, s54, 24576
    s_xor_b32 s36, s43, 49152
    buffer_load_dwordx4 v1, s[4:7], s36 offen offset:1024 sc1 lds
    v_lshlrev_b32 v230, 16, v185
    s_waitcnt lgkmcnt(5)
    v_mfma_f32_32x32x16_bf16 v[64:79], v[96:99], a[224:227], v[64:79]
    ds_read_b128 v[120:123], v1 offset:47104
    v_and_b32 v231, 0xffff0000, v185
    v_lshlrev_b32 v232, 16, v186
    v_and_b32 v233, 0xffff0000, v186
    v_lshlrev_b32 v234, 16, v187
    s_waitcnt lgkmcnt(5)
    v_mfma_f32_32x32x16_bf16 v[64:79], v[100:103], a[228:231], v[64:79]
    ds_read_b128 v[124:127], v1 offset:48128
    s_add_u32 s36, s47, 3072
    buffer_load_dwordx4 v[156:159], v1, s[4:7], s36 offen offset:1024 sc1
    v_and_b32 v235, 0xffff0000, v187
    s_waitcnt lgkmcnt(5)
    v_mfma_f32_32x32x16_bf16 v[64:79], v[104:107], a[232:235], v[64:79]
    s_waitcnt vmcnt(14)
    s_barrier
    ds_read_b128 v[96:99], v1 offset:49152
    s_waitcnt lgkmcnt(5)
    v_mfma_f32_32x32x16_bf16 v[64:79], v[108:111], a[236:239], v[64:79]
    ds_read_b128 v[100:103], v1 offset:50176
    s_add_u32 m0, s54, 32768
    s_xor_b32 s36, s43, 57344
    buffer_load_dwordx4 v1, s[4:7], s36 offen offset:0 sc1 lds
    s_waitcnt lgkmcnt(5)
    v_mfma_f32_32x32x16_bf16 v[64:79], v[112:115], a[240:243], v[64:79]
    ds_read_b128 v[104:107], v1 offset:51200
    s_waitcnt lgkmcnt(5)
    v_mfma_f32_32x32x16_bf16 v[64:79], v[116:119], a[244:247], v[64:79]
    ds_read_b128 v[108:111], v1 offset:52224
    s_waitcnt lgkmcnt(5)
    v_mfma_f32_32x32x16_bf16 v[64:79], v[120:123], a[248:251], v[64:79]
    ds_read_b128 v[112:115], v1 offset:53248
    s_add_u32 s36, s47, 3072
    buffer_load_dwordx4 v[160:163], v1, s[4:7], s36 offen offset:2048 sc1
    s_waitcnt lgkmcnt(5)
    v_mfma_f32_32x32x16_bf16 v[64:79], v[124:127], a[252:255], v[64:79]
    ds_read_b128 v[116:119], v1 offset:54272
    s_add_u32 m0, s54, 32768
    s_xor_b32 s36, s43, 57344
    buffer_load_dwordx4 v1, s[4:7], s36 offen offset:1024 sc1 lds
    s_waitcnt lgkmcnt(5)
    v_mfma_f32_32x32x16_bf16 v[80:95], v[96:99], a[0:3], 0
    ds_read_b128 v[120:123], v1 offset:55296
    s_waitcnt lgkmcnt(5)
    v_mfma_f32_32x32x16_bf16 v[80:95], v[100:103], a[4:7], v[80:95]
    ds_read_b128 v[124:127], v1 offset:56320
    s_nop 1
    v_cvt_pk_bf16_f32 v128, v64, v65
    v_cvt_pk_bf16_f32 v129, v66, v67
    v_cvt_pk_bf16_f32 v130, v68, v69
    v_cvt_pk_bf16_f32 v132, v70, v71
    s_waitcnt lgkmcnt(5)
    v_mfma_f32_32x32x16_bf16 v[80:95], v[104:107], a[8:11], v[80:95]
    s_waitcnt vmcnt(14)
    s_barrier
    ds_read_b128 v[96:99], v1 offset:0
    v_cvt_pk_bf16_f32 v133, v72, v73
    v_cvt_pk_bf16_f32 v134, v74, v75
    s_waitcnt lgkmcnt(5)
    v_mfma_f32_32x32x16_bf16 v[80:95], v[108:111], a[12:15], v[80:95]
    ds_read_b128 v[100:103], v1 offset:1024
    s_add_u32 m0, s54, 40960
    s_xor_b32 s36, s43, 32768
    buffer_load_dwordx4 v1, s[4:7], s36 offen offset:0 sc1 lds
    v_cvt_pk_bf16_f32 v136, v76, v77
    s_waitcnt lgkmcnt(5)
    v_mfma_f32_32x32x16_bf16 v[80:95], v[112:115], a[16:19], v[80:95]
    ds_read_b128 v[104:107], v1 offset:2048
    v_cvt_pk_bf16_f32 v137, v78, v79
    s_waitcnt lgkmcnt(5)
    v_mfma_f32_32x32x16_bf16 v[80:95], v[116:119], a[20:23], v[80:95]
    ds_read_b128 v[108:111], v1 offset:3072
    buffer_store_dwordx4 v[128:131], v1, s[4:7], s46 offen offset:0 sc1
    s_waitcnt lgkmcnt(5)
    v_mfma_f32_32x32x16_bf16 v[80:95], v[120:123], a[24:27], v[80:95]
    ds_read_b128 v[112:115], v1 offset:4096
    s_waitcnt lgkmcnt(5)
    v_mfma_f32_32x32x16_bf16 v[80:95], v[124:127], a[28:31], v[80:95]
    ds_read_b128 v[116:119], v1 offset:5120
    s_add_u32 m0, s54, 40960
    s_xor_b32 s36, s43, 32768
    buffer_load_dwordx4 v1, s[4:7], s36 offen offset:1024 sc1 lds
    s_waitcnt lgkmcnt(5)
    v_mfma_f32_32x32x16_bf16 v[80:95], v[96:99], a[32:35], v[80:95]
    ds_read_b128 v[120:123], v1 offset:6144
    s_waitcnt vmcnt(11)
    v_xor_b32 v236, v30, v143
    v_xor_b32 v237, v30, v147
    v_xor_b32 v238, v30, v151
    v_or3_b32 v236, v236, v237, v238
    v_cmp_ne_u32 vcc, 0, v236
    s_nop 3
    s_cbranch_vccnz PI_28
PID_29:
    v_lshlrev_b32 v240, 16, v140
    v_and_b32 v241, 0xffff0000, v140
    v_fma_f32 v220, v240, v188, v220
    s_waitcnt lgkmcnt(5)
    v_mfma_f32_32x32x16_bf16 v[80:95], v[100:103], a[36:39], v[80:95]
    ds_read_b128 v[124:127], v1 offset:7168
    buffer_store_dwordx4 v[132:135], v1, s[4:7], s46 offen offset:1024 sc1
    v_fma_f32 v221, v241, v189, v221
    s_waitcnt lgkmcnt(5)
    v_mfma_f32_32x32x16_bf16 v[80:95], v[104:107], a[40:43], v[80:95]
    s_barrier
    ds_read_b128 v[96:99], v1 offset:8192
    v_lshlrev_b32 v242, 16, v141
    v_and_b32 v243, 0xffff0000, v141
    s_waitcnt lgkmcnt(5)
    v_mfma_f32_32x32x16_bf16 v[80:95], v[108:111], a[44:47], v[80:95]
    ds_read_b128 v[100:103], v1 offset:9216
    s_add_u32 m0, s54, 49152
    s_xor_b32 s36, s43, 40960
    buffer_load_dwordx4 v1, s[4:7], s36 offen offset:0 sc1 lds
    v_fma_f32 v222, v242, v190, v222
    s_waitcnt lgkmcnt(5)
    v_mfma_f32_32x32x16_bf16 v[80:95], v[112:115], a[48:51], v[80:95]
    ds_read_b128 v[104:107], v1 offset:10240
    v_fma_f32 v223, v243, v191, v223
    v_lshlrev_b32 v244, 16, v142
    v_and_b32 v245, 0xffff0000, v142
    v_fma_f32 v224, v244, v192, v224
    s_waitcnt lgkmcnt(5)
    v_mfma_f32_32x32x16_bf16 v[80:95], v[116:119], a[52:55], v[80:95]
    ds_read_b128 v[108:111], v1 offset:11264
    v_fma_f32 v225, v245, v193, v225
    v_lshlrev_b32 v246, 16, v144
    v_and_b32 v247, 0xffff0000, v144
    v_fma_f32 v226, v246, v194, v226
    s_waitcnt lgkmcnt(5)
    v_mfma_f32_32x32x16_bf16 v[80:95], v[120:123], a[56:59], v[80:95]
    ds_read_b128 v[112:115], v1 offset:12288
    buffer_store_dwordx4 v[136:139], v1, s[4:7], s46 offen offset:2048 sc1
    v_fma_f32 v227, v247, v195, v227
    s_waitcnt lgkmcnt(5)
    v_mfma_f32_32x32x16_bf16 v[80:95], v[124:127], a[60:63], v[80:95]
    ds_read_b128 v[116:119], v1 offset:13312
    s_add_u32 m0, s54, 49152
    s_xor_b32 s36, s43, 40960
    buffer_load_dwordx4 v1, s[4:7], s36 offen offset:1024 sc1 lds
    v_lshlrev_b32 v240, 16, v145
    s_waitcnt lgkmcnt(5)
    v_mfma_f32_32x32x16_bf16 v[80:95], v[96:99], a[64:67], v[80:95]
    ds_read_b128 v[120:123], v1 offset:14336
    v_and_b32 v241, 0xffff0000, v145
    v_fma_f32 v228, v240, v196, v228
    v_fma_f32 v229, v241, v197, v229
    v_lshlrev_b32 v242, 16, v146
    s_waitcnt lgkmcnt(5)
    v_mfma_f32_32x32x16_bf16 v[80:95], v[100:103], a[68:71], v[80:95]
    ds_read_b128 v[124:127], v1 offset:15360
    v_and_b32 v243, 0xffff0000, v146
    v_fma_f32 v230, v242, v198, v230
    v_fma_f32 v231, v243, v199, v231
    v_lshlrev_b32 v244, 16, v148
    s_waitcnt lgkmcnt(5)
    v_mfma_f32_32x32x16_bf16 v[80:95], v[104:107], a[72:75], v[80:95]
    s_waitcnt vmcnt(14)
    s_barrier
    ds_read_b128 v[96:99], v1 offset:16384
    v_and_b32 v245, 0xffff0000, v148
    v_fma_f32 v232, v244, v200, v232
    s_waitcnt lgkmcnt(5)
    v_mfma_f32_32x32x16_bf16 v[80:95], v[108:111], a[76:79], v[80:95]
    ds_read_b128 v[100:103], v1 offset:17408
    s_xor_b32 m0, s53, 3072
    s_xor_b32 s36, s52, 3
    s_mul_i32 s36, s36, 44032
    buffer_load_dwordx4 v14, s[16:19], s36 offen lds
    v_fma_f32 v233, v245, v201, v233
    s_waitcnt lgkmcnt(5)
    v_mfma_f32_32x32x16_bf16 v[80:95], v[112:115], a[80:83], v[80:95]
    ds_read_b128 v[104:107], v1 offset:18432
    v_lshlrev_b32 v246, 16, v149
    v_and_b32 v247, 0xffff0000, v149
    v_fma_f32 v234, v246, v202, v234
    v_fma_f32 v235, v247, v203, v235
    s_waitcnt lgkmcnt(5)
    v_mfma_f32_32x32x16_bf16 v[80:95], v[116:119], a[84:87], v[80:95]
    ds_read_b128 v[108:111], v1 offset:19456
    s_xor_b32 m0, s53, 35840
    s_xor_b32 s36, s52, 3
    s_mul_i32 s36, s36, 44032
    buffer_load_dwordx4 v15, s[16:19], s36 offen lds
    s_waitcnt vmcnt(10)
    v_xor_b32 v236, v30, v155
    v_xor_b32 v237, v30, v159
    v_xor_b32 v238, v30, v163
    v_or3_b32 v236, v236, v237, v238
    v_cmp_ne_u32 vcc, 0, v236
    s_nop 3
    s_cbranch_vccnz PI_30
PID_31:
    s_waitcnt lgkmcnt(5)
    v_mfma_f32_32x32x16_bf16 v[80:95], v[120:123], a[88:91], v[80:95]
    ds_read_b128 v[112:115], v1 offset:20480
    v_lshlrev_b32 v240, 16, v152
    v_and_b32 v241, 0xffff0000, v152
    v_fma_f32 v220, v240, v188, v220
    v_fma_f32 v221, v241, v189, v221
    s_waitcnt lgkmcnt(5)
    v_mfma_f32_32x32x16_bf16 v[80:95], v[124:127], a[92:95], v[80:95]
    ds_read_b128 v[116:119], v1 offset:21504
    s_xor_b32 m0, s53, 199680
    s_xor_b32 s36, s52, 3
    s_mul_i32 s36, s36, 44032
    buffer_load_dwordx4 v16, s[16:19], s36 offen lds
    v_lshlrev_b32 v242, 16, v153
    s_waitcnt lgkmcnt(5)
    v_mfma_f32_32x32x16_bf16 v[80:95], v[96:99], a[96:99], v[80:95]
    ds_read_b128 v[120:123], v1 offset:22528
    v_and_b32 v243, 0xffff0000, v153
    v_fma_f32 v222, v242, v190, v222
    v_fma_f32 v223, v243, v191, v223
    v_lshlrev_b32 v244, 16, v154
    s_waitcnt lgkmcnt(5)
    v_mfma_f32_32x32x16_bf16 v[80:95], v[100:103], a[100:103], v[80:95]
    ds_read_b128 v[124:127], v1 offset:23552
    s_xor_b32 m0, s53, 4096
    s_xor_b32 s36, s52, 4
    s_mul_i32 s36, s36, 44032
    buffer_load_dwordx4 v14, s[16:19], s36 offen lds
    v_and_b32 v245, 0xffff0000, v154
    s_waitcnt lgkmcnt(5)
    v_mfma_f32_32x32x16_bf16 v[80:95], v[104:107], a[104:107], v[80:95]
    s_barrier
    ds_read_b128 v[96:99], v1 offset:24576
    v_fma_f32 v224, v244, v192, v224
    v_fma_f32 v225, v245, v193, v225
    s_waitcnt lgkmcnt(5)
    v_mfma_f32_32x32x16_bf16 v[80:95], v[108:111], a[108:111], v[80:95]
    ds_read_b128 v[100:103], v1 offset:25600
    v_lshlrev_b32 v246, 16, v156
    v_and_b32 v247, 0xffff0000, v156
    v_fma_f32 v226, v246, v194, v226
    v_fma_f32 v227, v247, v195, v227
    s_waitcnt lgkmcnt(5)
    v_mfma_f32_32x32x16_bf16 v[80:95], v[112:115], a[112:115], v[80:95]
    ds_read_b128 v[104:107], v1 offset:26624
    s_xor_b32 m0, s53, 36864
    s_xor_b32 s36, s52, 4
    s_mul_i32 s36, s36, 44032
    buffer_load_dwordx4 v15, s[16:19], s36 offen lds
    v_lshlrev_b32 v240, 16, v157
    s_waitcnt lgkmcnt(5)
    v_mfma_f32_32x32x16_bf16 v[80:95], v[116:119], a[116:119], v[80:95]
    ds_read_b128 v[108:111], v1 offset:27648
    v_and_b32 v241, 0xffff0000, v157
    v_fma_f32 v228, v240, v196, v228
    v_fma_f32 v229, v241, v197, v229
    v_lshlrev_b32 v242, 16, v158
    s_waitcnt lgkmcnt(5)
    v_mfma_f32_32x32x16_bf16 v[80:95], v[120:123], a[120:123], v[80:95]
    ds_read_b128 v[112:115], v1 offset:28672
    s_xor_b32 m0, s53, 200704
    s_xor_b32 s36, s52, 4
    s_mul_i32 s36, s36, 44032
    buffer_load_dwordx4 v16, s[16:19], s36 offen lds
    v_and_b32 v243, 0xffff0000, v158
    s_waitcnt lgkmcnt(5)
    v_mfma_f32_32x32x16_bf16 v[80:95], v[124:127], a[124:127], v[80:95]
    ds_read_b128 v[116:119], v1 offset:29696
    v_fma_f32 v230, v242, v198, v230
    v_fma_f32 v231, v243, v199, v231
    v_lshlrev_b32 v244, 16, v160
    v_and_b32 v245, 0xffff0000, v160
    s_waitcnt lgkmcnt(5)
    v_mfma_f32_32x32x16_bf16 v[80:95], v[96:99], a[128:131], v[80:95]
    ds_read_b128 v[120:123], v1 offset:30720
    s_xor_b32 m0, s53, 5120
    s_xor_b32 s36, s52, 5
    s_mul_i32 s36, s36, 44032
    buffer_load_dwordx4 v14, s[16:19], s36 offen lds
    v_fma_f32 v232, v244, v200, v232
    s_waitcnt lgkmcnt(5)
    v_mfma_f32_32x32x16_bf16 v[80:95], v[100:103], a[132:135], v[80:95]
    ds_read_b128 v[124:127], v1 offset:31744
    v_fma_f32 v233, v245, v201, v233
    v_lshlrev_b32 v246, 16, v161
    v_and_b32 v247, 0xffff0000, v161
    v_fma_f32 v234, v246, v202, v234
    s_waitcnt lgkmcnt(5)
    v_mfma_f32_32x32x16_bf16 v[80:95], v[104:107], a[136:139], v[80:95]
    s_waitcnt vmcnt(14)
    s_barrier
    ds_read_b128 v[96:99], v1 offset:32768
    v_fma_f32 v235, v247, v203, v235
    s_waitcnt lgkmcnt(5)
    v_mfma_f32_32x32x16_bf16 v[80:95], v[108:111], a[140:143], v[80:95]
    ds_read_b128 v[100:103], v1 offset:33792
    s_add_u32 s36, s47, 6144
    buffer_load_dwordx4 v[164:167], v1, s[4:7], s36 offen offset:0 sc1
    s_waitcnt lgkmcnt(5)
    v_mfma_f32_32x32x16_bf16 v[80:95], v[112:115], a[144:147], v[80:95]
    ds_read_b128 v[104:107], v1 offset:34816
    s_waitcnt lgkmcnt(5)
    v_mfma_f32_32x32x16_bf16 v[80:95], v[116:119], a[148:151], v[80:95]
    ds_read_b128 v[108:111], v1 offset:35840
    s_add_u32 s36, s47, 6144
    buffer_load_dwordx4 v[168:171], v1, s[4:7], s36 offen offset:1024 sc1
    s_waitcnt lgkmcnt(5)
    v_mfma_f32_32x32x16_bf16 v[80:95], v[120:123], a[152:155], v[80:95]
    ds_read_b128 v[112:115], v1 offset:36864
    s_waitcnt lgkmcnt(5)
    v_mfma_f32_32x32x16_bf16 v[80:95], v[124:127], a[156:159], v[80:95]
    ds_read_b128 v[116:119], v1 offset:37888
    s_add_u32 s36, s47, 6144
    buffer_load_dwordx4 v[172:175], v1, s[4:7], s36 offen offset:2048 sc1
    s_waitcnt lgkmcnt(5)
    v_mfma_f32_32x32x16_bf16 v[80:95], v[96:99], a[160:163], v[80:95]
    ds_read_b128 v[120:123], v1 offset:38912
    s_waitcnt lgkmcnt(5)
    v_mfma_f32_32x32x16_bf16 v[80:95], v[100:103], a[164:167], v[80:95]
    ds_read_b128 v[124:127], v1 offset:39936
    s_waitcnt lgkmcnt(5)
    v_mfma_f32_32x32x16_bf16 v[80:95], v[104:107], a[168:171], v[80:95]
    s_waitcnt vmcnt(14)
    s_barrier
    ds_read_b128 v[96:99], v1 offset:40960
    s_waitcnt lgkmcnt(5)
    v_mfma_f32_32x32x16_bf16 v[80:95], v[108:111], a[172:175], v[80:95]
    ds_read_b128 v[100:103], v1 offset:41984
    s_xor_b32 m0, s53, 37888
    s_xor_b32 s36, s52, 5
    s_mul_i32 s36, s36, 44032
    buffer_load_dwordx4 v15, s[16:19], s36 offen lds
    s_waitcnt lgkmcnt(5)
    v_mfma_f32_32x32x16_bf16 v[80:95], v[112:115], a[176:179], v[80:95]
    ds_read_b128 v[104:107], v1 offset:43008
    s_waitcnt lgkmcnt(5)
    v_mfma_f32_32x32x16_bf16 v[80:95], v[116:119], a[180:183], v[80:95]
    ds_read_b128 v[108:111], v1 offset:44032
    s_xor_b32 m0, s53, 201728
    s_xor_b32 s36, s52, 5
    s_mul_i32 s36, s36, 44032
    buffer_load_dwordx4 v16, s[16:19], s36 offen lds
    s_waitcnt lgkmcnt(5)
    v_mfma_f32_32x32x16_bf16 v[80:95], v[120:123], a[184:187], v[80:95]
    ds_read_b128 v[112:115], v1 offset:45056
    s_waitcnt lgkmcnt(5)
    v_mfma_f32_32x32x16_bf16 v[80:95], v[124:127], a[188:191], v[80:95]
    ds_read_b128 v[116:119], v1 offset:46080
    s_xor_b32 m0, s53, 6144
    s_xor_b32 s36, s52, 6
    s_mul_i32 s36, s36, 44032
    buffer_load_dwordx4 v14, s[16:19], s36 offen lds
    s_waitcnt lgkmcnt(5)
    v_mfma_f32_32x32x16_bf16 v[80:95], v[96:99], a[192:195], v[80:95]
    ds_read_b128 v[120:123], v1 offset:47104
    s_waitcnt lgkmcnt(5)
    v_mfma_f32_32x32x16_bf16 v[80:95], v[100:103], a[196:199], v[80:95]
    ds_read_b128 v[124:127], v1 offset:48128
    s_xor_b32 m0, s53, 38912
    s_xor_b32 s36, s52, 6
    s_mul_i32 s36, s36, 44032
    buffer_load_dwordx4 v15, s[16:19], s36 offen lds
    s_waitcnt lgkmcnt(5)
    v_mfma_f32_32x32x16_bf16 v[80:95], v[104:107], a[200:203], v[80:95]
    s_waitcnt vmcnt(14)
    s_barrier
    ds_read_b128 v[96:99], v1 offset:49152
    s_waitcnt lgkmcnt(5)
    v_mfma_f32_32x32x16_bf16 v[80:95], v[108:111], a[204:207], v[80:95]
    ds_read_b128 v[100:103], v1 offset:50176
    s_waitcnt lgkmcnt(5)
    v_mfma_f32_32x32x16_bf16 v[80:95], v[112:115], a[208:211], v[80:95]
    ds_read_b128 v[104:107], v1 offset:51200
    s_xor_b32 m0, s53, 202752
    s_xor_b32 s36, s52, 6
    s_mul_i32 s36, s36, 44032
    buffer_load_dwordx4 v16, s[16:19], s36 offen lds
    s_waitcnt lgkmcnt(5)
    v_mfma_f32_32x32x16_bf16 v[80:95], v[116:119], a[212:215], v[80:95]
    ds_read_b128 v[108:111], v1 offset:52224
    s_waitcnt lgkmcnt(5)
    v_mfma_f32_32x32x16_bf16 v[80:95], v[120:123], a[216:219], v[80:95]
    ds_read_b128 v[112:115], v1 offset:53248
    s_xor_b32 m0, s53, 7168
    s_xor_b32 s36, s52, 7
    s_mul_i32 s36, s36, 44032
    buffer_load_dwordx4 v14, s[16:19], s36 offen lds
    s_waitcnt lgkmcnt(5)
    v_mfma_f32_32x32x16_bf16 v[80:95], v[124:127], a[220:223], v[80:95]
    ds_read_b128 v[116:119], v1 offset:54272
    s_waitcnt lgkmcnt(5)
    v_mfma_f32_32x32x16_bf16 v[80:95], v[96:99], a[224:227], v[80:95]
    ds_read_b128 v[120:123], v1 offset:55296
    s_xor_b32 m0, s53, 39936
    s_xor_b32 s36, s52, 7
    s_mul_i32 s36, s36, 44032
    buffer_load_dwordx4 v15, s[16:19], s36 offen lds
    s_waitcnt lgkmcnt(5)
    v_mfma_f32_32x32x16_bf16 v[80:95], v[100:103], a[228:231], v[80:95]
    ds_read_b128 v[124:127], v1 offset:56320
    s_waitcnt lgkmcnt(5)
    v_mfma_f32_32x32x16_bf16 v[80:95], v[104:107], a[232:235], v[80:95]
    s_xor_b32 m0, s53, 203776
    s_xor_b32 s36, s52, 7
    s_mul_i32 s36, s36, 44032
    buffer_load_dwordx4 v16, s[16:19], s36 offen lds
    s_waitcnt lgkmcnt(4)
    v_mfma_f32_32x32x16_bf16 v[80:95], v[108:111], a[236:239], v[80:95]
    s_waitcnt lgkmcnt(3)
    v_mfma_f32_32x32x16_bf16 v[80:95], v[112:115], a[240:243], v[80:95]
    s_waitcnt lgkmcnt(2)
    v_mfma_f32_32x32x16_bf16 v[80:95], v[116:119], a[244:247], v[80:95]
    s_waitcnt lgkmcnt(1)
    v_mfma_f32_32x32x16_bf16 v[80:95], v[120:123], a[248:251], v[80:95]
    s_waitcnt lgkmcnt(0)
    v_mfma_f32_32x32x16_bf16 v[80:95], v[124:127], a[252:255], v[80:95]
    s_waitcnt vmcnt(8)
    v_xor_b32 v236, v30, v167
    v_xor_b32 v237, v30, v171
    v_xor_b32 v238, v30, v175
    v_or3_b32 v236, v236, v237, v238
    v_cmp_ne_u32 vcc, 0, v236
    s_nop 3
    s_cbranch_vccnz PK_32
PKD_33:
    v_lshlrev_b32 v240, 16, v164
    v_and_b32 v241, 0xffff0000, v164
    v_fma_f32 v220, v240, v188, v220
    v_fma_f32 v221, v241, v189, v221
    v_lshlrev_b32 v242, 16, v165
    v_and_b32 v243, 0xffff0000, v165
    v_fma_f32 v222, v242, v190, v222
    v_fma_f32 v223, v243, v191, v223
    v_lshlrev_b32 v244, 16, v166
    v_and_b32 v245, 0xffff0000, v166
    v_fma_f32 v224, v244, v192, v224
    v_fma_f32 v225, v245, v193, v225
    v_lshlrev_b32 v246, 16, v168
    v_and_b32 v247, 0xffff0000, v168
    v_fma_f32 v226, v246, v194, v226
    v_fma_f32 v227, v247, v195, v227
    v_lshlrev_b32 v240, 16, v169
    v_and_b32 v241, 0xffff0000, v169
    v_fma_f32 v228, v240, v196, v228
    v_fma_f32 v229, v241, v197, v229
    v_lshlrev_b32 v242, 16, v170
    v_and_b32 v243, 0xffff0000, v170
    v_fma_f32 v230, v242, v198, v230
    v_fma_f32 v231, v243, v199, v231
    v_lshlrev_b32 v244, 16, v172
    v_and_b32 v245, 0xffff0000, v172
    v_fma_f32 v232, v244, v200, v232
    v_fma_f32 v233, v245, v201, v233
    v_lshlrev_b32 v246, 16, v173
    v_and_b32 v247, 0xffff0000, v173
    v_fma_f32 v234, v246, v202, v234
    v_fma_f32 v235, v247, v203, v235
    v_fma_f32 v220, v80, v188, v220
    v_fma_f32 v221, v81, v189, v221
    v_fma_f32 v222, v82, v190, v222
    v_fma_f32 v223, v83, v191, v223
    v_fma_f32 v224, v84, v192, v224
    v_fma_f32 v225, v85, v193, v225
    v_fma_f32 v226, v86, v194, v226
    v_fma_f32 v227, v87, v195, v227
    v_fma_f32 v228, v88, v196, v228
    v_fma_f32 v229, v89, v197, v229
    v_fma_f32 v230, v90, v198, v230
    v_fma_f32 v231, v91, v199, v231
    v_fma_f32 v232, v92, v200, v232
    v_fma_f32 v233, v93, v201, v233
    v_fma_f32 v234, v94, v202, v234
    v_fma_f32 v235, v95, v203, v235
    v_mul_f32 v204, v220, v204
    v_mul_f32 v205, v221, v205
    v_mul_f32 v206, v222, v206
    v_mul_f32 v207, v223, v207
    v_mul_f32 v208, v224, v208
    v_mul_f32 v209, v225, v209
    v_mul_f32 v210, v226, v210
    v_mul_f32 v211, v227, v211
    v_mul_f32 v212, v228, v212
    v_mul_f32 v213, v229, v213
    v_mul_f32 v214, v230, v214
    v_mul_f32 v215, v231, v215
    v_mul_f32 v216, v232, v216
    v_mul_f32 v217, v233, v217
    v_mul_f32 v218, v234, v218
    v_mul_f32 v219, v235, v219
    v_cvt_pk_bf16_f32 v204, v204, v205
    v_cvt_pk_bf16_f32 v205, v206, v207
    v_cvt_pk_bf16_f32 v206, v208, v209
    v_cvt_pk_bf16_f32 v207, v210, v211
    v_cvt_pk_bf16_f32 v208, v212, v213
    v_cvt_pk_bf16_f32 v209, v214, v215
    v_cvt_pk_bf16_f32 v210, v216, v217
    v_cvt_pk_bf16_f32 v211, v218, v219
    buffer_store_dwordx4 v[204:207], v1, s[4:7], s49 offen offset:0 sc1
    buffer_store_dwordx4 v[208:211], v1, s[4:7], s49 offen offset:1024 sc1
    s_add_u32 s49, s49, 2097152
    s_mov_b32 s36, 0x3f803f80
    v_cvt_pk_bf16_f32 v220, v220, v221
    v_cvt_pk_bf16_f32 v221, v222, v223
    v_cvt_pk_bf16_f32 v222, v224, v225
    v_cvt_pk_bf16_f32 v223, v226, v227
    v_cvt_pk_bf16_f32 v224, v228, v229
    v_cvt_pk_bf16_f32 v225, v230, v231
    v_cvt_pk_bf16_f32 v226, v232, v233
    v_cvt_pk_bf16_f32 v227, v234, v235
    buffer_store_dwordx4 v[220:223], v1, s[4:7], s49 offen offset:0 sc1
    buffer_store_dwordx4 v[224:227], v1, s[4:7], s49 offen offset:1024 sc1
    v_dot2_f32_bf16 v236, v220, s36, 0
    v_dot2_f32_bf16 v237, v220, v220, 0
    v_dot2_f32_bf16 v238, v221, s36, 0
    v_dot2_f32_bf16 v239, v221, v221, 0
    v_dot2c_f32_bf16 v236, s36, v222
    v_dot2c_f32_bf16 v237, v222, v222
    v_dot2c_f32_bf16 v238, s36, v223
    v_dot2c_f32_bf16 v239, v223, v223
    v_dot2c_f32_bf16 v236, s36, v224
    v_dot2c_f32_bf16 v237, v224, v224
    v_dot2c_f32_bf16 v238, s36, v225
    v_dot2c_f32_bf16 v239, v225, v225
    v_dot2c_f32_bf16 v236, s36, v226
    v_dot2c_f32_bf16 v237, v226, v226
    v_dot2c_f32_bf16 v238, s36, v227
    v_dot2c_f32_bf16 v239, v227, v227
    v_lshlrev_b32 v240, 2, v0
    s_nop 0
    v_add_f32 v236, v236, v238
    v_add_f32 v237, v237, v239
    s_nop 1
    v_permlane32_swap_b32 v236, v237
    v_add_f32 v236, v236, v237
    buffer_store_dword v236, v240, s[4:7], s50 offen sc1
    s_waitcnt vmcnt(5)
    s_barrier
K_JOIN:
    s_nop 7
    s_nop 3
    s_load_dwordx2 s[16:17], s[0:1], 80
    ds_read_b64_tr_b16 v[80:81], v20 offset:0
    ds_read_b64_tr_b16 v[82:83], v20 offset:256
    ds_read_b128 v[112:115], v19 offset:0
    ds_read_b64_tr_b16 v[84:85], v20 offset:1024
    ds_read_b64_tr_b16 v[86:87], v20 offset:1280
    ds_read_b128 v[116:119], v19 offset:32
    ds_read_b64_tr_b16 v[88:89], v20 offset:2048
    ds_read_b64_tr_b16 v[90:91], v20 offset:2304
    ds_read_b128 v[120:123], v19 offset:64
    ds_read_b64_tr_b16 v[92:93], v20 offset:3072
    ds_read_b64_tr_b16 v[94:95], v20 offset:3328
    ds_read_b128 v[124:127], v19 offset:96
    s_waitcnt lgkmcnt(9)
    v_mfma_f32_32x32x16_bf16 v[64:79], v[80:83], v[112:115], 0
    ds_read_b64_tr_b16 v[96:97], v20 offset:4096
    ds_read_b64_tr_b16 v[98:99], v20 offset:4352
    ds_read_b128 v[128:131], v19 offset:128
    s_add_u32 m0, s30, 0
    s_lshl4_add_u32 s36, s8, s20
    buffer_load_dwordx4 v2, s[32:35], s36 offen offset:0  lds
    s_waitcnt lgkmcnt(9)
    v_mfma_f32_32x32x16_bf16 v[64:79], v[84:87], v[116:119], v[64:79]
    ds_read_b64_tr_b16 v[100:101], v20 offset:5120
    ds_read_b64_tr_b16 v[102:103], v20 offset:5376
    ds_read_b128 v[132:135], v19 offset:160
    s_add_u32 m0, s30, 0
    s_lshl4_add_u32 s36, s8, s20
    buffer_load_dwordx4 v3, s[32:35], s36 offen offset:1024  lds
    s_waitcnt lgkmcnt(9)
    v_mfma_f32_32x32x16_bf16 v[64:79], v[88:91], v[120:123], v[64:79]
    ds_read_b64_tr_b16 v[104:105], v20 offset:6144
    ds_read_b64_tr_b16 v[106:107], v20 offset:6400
    ds_read_b128 v[136:139], v19 offset:192
    s_add_u32 m0, s30, 0
    s_lshl4_add_u32 s36, s8, s20
    buffer_load_dwordx4 v4, s[32:35], s36 offen offset:2048  lds
    s_waitcnt lgkmcnt(9)
    v_mfma_f32_32x32x16_bf16 v[64:79], v[92:95], v[124:127], v[64:79]
    ds_read_b64_tr_b16 v[108:109], v20 offset:7168
    ds_read_b64_tr_b16 v[110:111], v20 offset:7424
    ds_read_b128 v[140:143], v19 offset:224
    s_add_u32 m0, s30, 0
    s_lshl4_add_u32 s36, s8, s20
    buffer_load_dwordx4 v5, s[32:35], s36 offen offset:3072  lds
    s_waitcnt lgkmcnt(9)
    v_mfma_f32_32x32x16_bf16 v[64:79], v[96:99], v[128:131], v[64:79]
    ds_read_b64_tr_b16 v[80:81], v20 offset:8192
    ds_read_b64_tr_b16 v[82:83], v20 offset:8448
    ds_read_b128 v[112:115], v19 offset:256
    s_add_u32 m0, s30, 16384
    s_lshl4_add_u32 s36, s9, s20
    buffer_load_dwordx4 v2, s[32:35], s36 offen offset:0  lds
    s_waitcnt lgkmcnt(9)
    v_mfma_f32_32x32x16_bf16 v[64:79], v[100:103], v[132:135], v[64:79]
    ds_read_b64_tr_b16 v[84:85], v20 offset:9216
    ds_read_b64_tr_b16 v[86:87], v20 offset:9472
    ds_read_b128 v[116:119], v19 offset:288
    s_add_u32 m0, s30, 16384
    s_lshl4_add_u32 s36, s9, s20
    buffer_load_dwordx4 v3, s[32:35], s36 offen offset:1024  lds
    s_waitcnt lgkmcnt(9)
    v_mfma_f32_32x32x16_bf16 v[64:79], v[104:107], v[136:139], v[64:79]
    ds_read_b64_tr_b16 v[88:89], v20 offset:10240
    ds_read_b64_tr_b16 v[90:91], v20 offset:10496
    ds_read_b128 v[120:123], v19 offset:320
    s_waitcnt vmcnt(6)
    s_mov_b64 exec, 3
    buffer_store_dword v30, v6, s[4:7], s51 offen sc1
    s_mov_b64 exec, -1
    s_add_u32 m0, s30, 16384
    s_lshl4_add_u32 s36, s9, s20
    buffer_load_dwordx4 v4, s[32:35], s36 offen offset:2048  lds
    s_waitcnt lgkmcnt(9)
    v_mfma_f32_32x32x16_bf16 v[64:79], v[108:111], v[140:143], v[64:79]
    ds_read_b64_tr_b16 v[92:93], v20 offset:11264
    ds_read_b64_tr_b16 v[94:95], v20 offset:11520
    ds_read_b128 v[124:127], v19 offset:352
    s_add_u32 m0, s30, 16384
    s_lshl4_add_u32 s36, s9, s20
    buffer_load_dwordx4 v5, s[32:35], s36 offen offset:3072  lds
    s_waitcnt lgkmcnt(9)
    v_mfma_f32_32x32x16_bf16 v[64:79], v[80:83], v[112:115], v[64:79]
    ds_read_b64_tr_b16 v[96:97], v20 offset:12288
    ds_read_b64_tr_b16 v[98:99], v20 offset:12544
    ds_read_b128 v[128:131], v19 offset:384
    s_add_u32 m0, s30, 32768
    s_lshl4_add_u32 s36, s10, s20
    buffer_load_dwordx4 v2, s[32:35], s36 offen offset:0  lds
    s_waitcnt lgkmcnt(9)
    v_mfma_f32_32x32x16_bf16 v[64:79], v[84:87], v[116:119], v[64:79]
    ds_read_b64_tr_b16 v[100:101], v20 offset:13312
    ds_read_b64_tr_b16 v[102:103], v20 offset:13568
    ds_read_b128 v[132:135], v19 offset:416
    s_add_u32 m0, s30, 32768
    s_lshl4_add_u32 s36, s10, s20
    buffer_load_dwordx4 v3, s[32:35], s36 offen offset:1024  lds
    s_waitcnt lgkmcnt(9)
    v_mfma_f32_32x32x16_bf16 v[64:79], v[88:91], v[120:123], v[64:79]
    ds_read_b64_tr_b16 v[104:105], v20 offset:14336
    ds_read_b64_tr_b16 v[106:107], v20 offset:14592
    ds_read_b128 v[136:139], v19 offset:448
    s_add_u32 m0, s30, 32768
    s_lshl4_add_u32 s36, s10, s20
    buffer_load_dwordx4 v4, s[32:35], s36 offen offset:2048  lds
    s_waitcnt lgkmcnt(9)
    v_mfma_f32_32x32x16_bf16 v[64:79], v[92:95], v[124:127], v[64:79]
    ds_read_b64_tr_b16 v[108:109], v20 offset:15360
    ds_read_b64_tr_b16 v[110:111], v20 offset:15616
    ds_read_b128 v[140:143], v19 offset:480
    s_add_u32 m0, s30, 32768
    s_lshl4_add_u32 s36, s10, s20
    buffer_load_dwordx4 v5, s[32:35], s36 offen offset:3072  lds
    s_waitcnt lgkmcnt(9)
    v_mfma_f32_32x32x16_bf16 v[64:79], v[96:99], v[128:131], v[64:79]
    ds_read_b64_tr_b16 v[80:81], v20 offset:16384
    ds_read_b64_tr_b16 v[82:83], v20 offset:16640
    ds_read_b128 v[112:115], v19 offset:512
    s_lshr_b32 s64, s2, 3
    s_lshl2_add_u32 s64, s64, s3
    s_mul_i32 s64, s64, 12
    s_waitcnt lgkmcnt(9)
    v_mfma_f32_32x32x16_bf16 v[64:79], v[100:103], v[132:135], v[64:79]
    ds_read_b64_tr_b16 v[84:85], v20 offset:17408
    ds_read_b64_tr_b16 v[86:87], v20 offset:17664
    ds_read_b128 v[116:119], v19 offset:544
    v_min_u32 v26, 11, v0
    v_add_u32 v26, s64, v26
    v_lshrrev_b32 v27, 8, v26
    s_waitcnt lgkmcnt(9)
    v_mfma_f32_32x32x16_bf16 v[64:79], v[104:107], v[136:139], v[64:79]
    ds_read_b64_tr_b16 v[88:89], v20 offset:18432
    ds_read_b64_tr_b16 v[90:91], v20 offset:18688
    ds_read_b128 v[120:123], v19 offset:576
    v_lshl_add_u32 v26, v27, 9, v26
    v_lshlrev_b32 v26, 7, v26
    s_and_b32 s64, s2, 1
    s_waitcnt lgkmcnt(9)
    v_mfma_f32_32x32x16_bf16 v[64:79], v[108:111], v[140:143], v[64:79]
    ds_read_b64_tr_b16 v[92:93], v20 offset:19456
    ds_read_b64_tr_b16 v[94:95], v20 offset:19712
    ds_read_b128 v[124:127], v19 offset:608
    s_mul_i32 s64, s64, 720896
    s_add_u32 s64, s64, 65536
    s_and_b32 s56, s2, 1
    s_waitcnt lgkmcnt(9)
    v_mfma_f32_32x32x16_bf16 v[64:79], v[80:83], v[112:115], v[64:79]
    ds_read_b64_tr_b16 v[96:97], v20 offset:20480
    ds_read_b64_tr_b16 v[98:99], v20 offset:20736
    ds_read_b128 v[128:131], v19 offset:640
    buffer_load_dword v27, v26, s[32:35], s64 offen
    s_waitcnt lgkmcnt(9)
    v_mfma_f32_32x32x16_bf16 v[64:79], v[84:87], v[116:119], v[64:79]
    ds_read_b64_tr_b16 v[100:101], v20 offset:21504
    ds_read_b64_tr_b16 v[102:103], v20 offset:21760
    ds_read_b128 v[132:135], v19 offset:672
    s_sub_u32 s57, s21, 25821184
    s_lshr_b32 s57, s57, 8
    s_mul_i32 s40, s57, 44
    s_waitcnt lgkmcnt(9)
    v_mfma_f32_32x32x16_bf16 v[64:79], v[88:91], v[120:123], v[64:79]
    ds_read_b64_tr_b16 v[104:105], v20 offset:22528
    ds_read_b64_tr_b16 v[106:107], v20 offset:22784
    ds_read_b128 v[136:139], v19 offset:704
    s_add_u32 s40, s40, s55
    s_lshl_b32 s40, s40, 11
    s_add_u32 s40, s40, 18874368
    s_waitcnt lgkmcnt(9)
    v_mfma_f32_32x32x16_bf16 v[64:79], v[92:95], v[124:127], v[64:79]
    ds_read_b64_tr_b16 v[108:109], v20 offset:23552
    ds_read_b64_tr_b16 v[110:111], v20 offset:23808
    ds_read_b128 v[140:143], v19 offset:736
    s_bfe_u32 s58, s2, 0x30003
    s_add_u32 s59, s58, 2
    s_lshr_b32 s59, s59, 3
    s_waitcnt lgkmcnt(9)
    v_mfma_f32_32x32x16_bf16 v[64:79], v[96:99], v[128:131], v[64:79]
    ds_read_b64_tr_b16 v[80:81], v20 offset:24576
    ds_read_b64_tr_b16 v[82:83], v20 offset:24832
    ds_read_b128 v[112:115], v19 offset:768
    s_lshl_b32 s59, s59, 30
    s_add_u32 s41, s40, s59
    s_add_u32 s41, s41, 4096
    s_waitcnt lgkmcnt(9)
    v_mfma_f32_32x32x16_bf16 v[64:79], v[100:103], v[132:135], v[64:79]
    ds_read_b64_tr_b16 v[84:85], v20 offset:25600
    ds_read_b64_tr_b16 v[86:87], v20 offset:25856
    ds_read_b128 v[116:119], v19 offset:800
    s_lshr_b32 s59, s57, 1
    s_lshl1_add_u32 s59, s59, s56
    s_lshl_b32 s59, s59, 5
    s_waitcnt lgkmcnt(9)
    v_mfma_f32_32x32x16_bf16 v[64:79], v[104:107], v[136:139], v[64:79]
    ds_read_b64_tr_b16 v[88:89], v20 offset:26624
    ds_read_b64_tr_b16 v[90:91], v20 offset:26880
    ds_read_b128 v[120:123], v19 offset:832
    s_add_u32 s59, s59, s58
    s_and_b32 s57, s57, 1
    s_lshl1_add_u32 s59, s59, s57
    s_waitcnt lgkmcnt(9)
    v_mfma_f32_32x32x16_bf16 v[64:79], v[108:111], v[140:143], v[64:79]
    ds_read_b64_tr_b16 v[92:93], v20 offset:27648
    ds_read_b64_tr_b16 v[94:95], v20 offset:27904
    ds_read_b128 v[124:127], v19 offset:864
    s_lshl_b32 s59, s59, 2
    s_add_u32 s42, s59, 25886720
    s_bfe_u32 s57, s2, 0x20001
    s_waitcnt lgkmcnt(9)
    v_mfma_f32_32x32x16_bf16 v[64:79], v[80:83], v[112:115], v[64:79]
    ds_read_b64_tr_b16 v[96:97], v20 offset:28672
    ds_read_b64_tr_b16 v[98:99], v20 offset:28928
    ds_read_b128 v[128:131], v19 offset:896
    s_lshr_b32 s58, s2, 5
    s_lshl3_add_u32 s57, s57, s58
    s_lshl1_add_u32 s58, s57, s56
    s_waitcnt lgkmcnt(9)
    v_mfma_f32_32x32x16_bf16 v[64:79], v[84:87], v[116:119], v[64:79]
    ds_read_b64_tr_b16 v[100:101], v20 offset:29696
    ds_read_b64_tr_b16 v[102:103], v20 offset:29952
    ds_read_b128 v[132:135], v19 offset:928
    s_lshl_b32 s47, s58, 8
    s_add_u32 s47, s47, 25886720
    s_add_u32 s48, s47, 128
    s_waitcnt lgkmcnt(9)
    v_mfma_f32_32x32x16_bf16 v[64:79], v[88:91], v[120:123], v[64:79]
    ds_read_b64_tr_b16 v[104:105], v20 offset:30720
    ds_read_b64_tr_b16 v[106:107], v20 offset:30976
    ds_read_b128 v[136:139], v19 offset:960
    s_mul_i32 s59, s56, 44
    s_add_u32 s59, s59, s3
    s_lshl_b32 s59, s59, 10
    s_waitcnt lgkmcnt(9)
    v_mfma_f32_32x32x16_bf16 v[64:79], v[92:95], v[124:127], v[64:79]
    ds_read_b64_tr_b16 v[108:109], v20 offset:31744
    ds_read_b64_tr_b16 v[110:111], v20 offset:32000
    ds_read_b128 v[140:143], v19 offset:992
    s_add_u32 s59, s59, 18874368
    s_mul_i32 s44, s58, 90112
    s_add_u32 s44, s44, s59
    s_waitcnt lgkmcnt(9)
    v_mfma_f32_32x32x16_bf16 v[64:79], v[96:99], v[128:131], v[64:79]
    s_xor_b32 s60, s58, 1
    s_mul_i32 s43, s60, 90112
    s_add_u32 s43, s43, s59
    s_waitcnt lgkmcnt(6)
    v_mfma_f32_32x32x16_bf16 v[64:79], v[100:103], v[132:135], v[64:79]
    s_lshr_b32 s59, s3, 1
    s_lshl_b32 s59, s59, 12
    s_add_u32 s45, s43, s59
    s_waitcnt lgkmcnt(3)
    v_mfma_f32_32x32x16_bf16 v[64:79], v[104:107], v[136:139], v[64:79]
    s_add_u32 s46, s44, s59
    s_bfe_u32 s59, s2, 0x20003
    s_lshl2_add_u32 s57, s57, s59
    s_waitcnt lgkmcnt(0)
    v_mfma_f32_32x32x16_bf16 v[64:79], v[108:111], v[140:143], v[64:79]
    s_lshl1_add_u32 s57, s57, s56
    s_lshl2_add_u32 s57, s57, s3
    s_mul_i32 s50, s57, 3072
    s_add_u32 s50, s50, 26214400
    s_xor_b32 s57, s57, 4
    s_mul_i32 s49, s57, 3072
    s_add_u32 s49, s49, 26214400
    s_lshl2_add_u32 s59, s59, s3
    s_lshl4_add_u32 s57, s58, s59
    s_lshl_b32 s52, s57, 11
    s_add_u32 s52, s52, 16777216
    s_lshl_b32 s58, s58, 15
    s_lshl_b32 s59, s59, 6
    s_add_u32 s53, s58, s59
    s_add_u32 s59, s59, 60416
    v_lshrrev_b32 v25, 5, v0
    v_lshlrev_b32 v25, 4, v25
    v_add_u32 v25, s59, v25
    s_lshl_b32 s54, s3, 10
    s_add_u32 s54, s54, 65536
    s_mov_b32 exec_lo, 0x00010001
    s_mov_b32 exec_hi, 0x00010001
    ds_write_b128 v21, v[64:67] offset:0
    ds_write_b128 v21, v[68:71] offset:16
    ds_write_b128 v21, v[72:75] offset:32
    ds_write_b128 v21, v[76:79] offset:48
    s_mov_b64 exec, -1
    s_waitcnt lgkmcnt(0)
    s_barrier
    s_and_b32 s17, s17, 0xffff
    s_mov_b32 s18, 2097152
    s_mov_b32 s19, 0x00020000
    s_waitcnt lgkmcnt(0)
    s_mov_b32 s25, s24
    s_mov_b32 s39, 20000
    s_load_dwordx16 s[56:71], s[4:5], s21 glc
FX_34:
    s_waitcnt lgkmcnt(0)
    s_xor_b64 s[56:57], s[56:57], s[24:25]
    s_xor_b64 s[58:59], s[58:59], s[24:25]
    s_xor_b64 s[60:61], s[60:61], s[24:25]
    s_xor_b64 s[62:63], s[62:63], s[24:25]
    s_xor_b64 s[64:65], s[64:65], s[24:25]
    s_xor_b64 s[66:67], s[66:67], s[24:25]
    s_xor_b64 s[68:69], s[68:69], s[24:25]
    s_xor_b64 s[70:71], s[70:71], s[24:25]
    s_or_b64 s[56:57], s[56:57], s[64:65]
    s_or_b64 s[58:59], s[58:59], s[66:67]
    s_or_b64 s[60:61], s[60:61], s[68:69]
    s_or_b64 s[62:63], s[62:63], s[70:71]
    s_or_b64 s[56:57], s[56:57], s[60:61]
    s_or_b64 s[58:59], s[58:59], s[62:63]
    s_or_b64 s[56:57], s[56:57], s[58:59]
    s_cbranch_scc0 FXD_35
    s_sleep 1
    s_load_dwordx16 s[56:71], s[4:5], s21 glc
    s_sub_u32 s39, s39, 1
    s_cmp_lg_u32 s39, 0
    s_cbranch_scc1 FX_34
    s_waitcnt lgkmcnt(0)
FXD_35:
    s_xor_b32 s36, s29, 0
    buffer_load_dwordx4 a[176:179], v1, s[4:7], s36 offen offset:0 sc1
    s_xor_b32 s36, s29, 0
    buffer_load_dwordx4 a[180:183], v1, s[4:7], s36 offen offset:1024 sc1
    s_xor_b32 s36, s29, 0
    buffer_load_dwordx4 a[184:187], v1, s[4:7], s36 offen offset:2048 sc1
    s_xor_b32 s36, s29, 0
    buffer_load_dwordx4 a[188:191], v1, s[4:7], s36 offen offset:3072 sc1
    s_xor_b32 s36, s31, 0
    buffer_load_dwordx4 v[176:179], v1, s[4:7], s36 offen sc1
    s_xor_b32 s36, s29, 4096
    buffer_load_dwordx4 a[192:195], v1, s[4:7], s36 offen offset:0 sc1
    s_xor_b32 s36, s29, 4096
    buffer_load_dwordx4 a[196:199], v1, s[4:7], s36 offen offset:1024 sc1
    s_xor_b32 s36, s29, 4096
    buffer_load_dwordx4 a[200:203], v1, s[4:7], s36 offen offset:2048 sc1
    s_xor_b32 s36, s29, 4096
    buffer_load_dwordx4 a[204:207], v1, s[4:7], s36 offen offset:3072 sc1
    s_xor_b32 s36, s31, 1024
    buffer_load_dwordx4 v[180:183], v1, s[4:7], s36 offen sc1
    s_xor_b32 s36, s29, 8192
    buffer_load_dwordx4 a[208:211], v1, s[4:7], s36 offen offset:0 sc1
    s_xor_b32 s36, s29, 8192
    buffer_load_dwordx4 a[212:215], v1, s[4:7], s36 offen offset:1024 sc1
    s_xor_b32 s36, s29, 8192
    buffer_load_dwordx4 a[216:219], v1, s[4:7], s36 offen offset:2048 sc1
    s_xor_b32 s36, s29, 8192
    buffer_load_dwordx4 a[220:223], v1, s[4:7], s36 offen offset:3072 sc1
    s_xor_b32 s36, s31, 2048
    buffer_load_dwordx4 v[184:187], v1, s[4:7], s36 offen sc1
    v_xor_b32 v11, 0, v17
    ds_read_b64_tr_b16 v[80:81], v11 offset:0
    ds_read_b64_tr_b16 v[82:83], v11 offset:256
    ds_read_b64_tr_b16 v[84:85], v11 offset:32768
    ds_read_b64_tr_b16 v[86:87], v11 offset:33024
    ds_read_b64_tr_b16 v[88:89], v11 offset:1024
    ds_read_b64_tr_b16 v[90:91], v11 offset:1280
    ds_read_b64_tr_b16 v[92:93], v11 offset:33792
    ds_read_b64_tr_b16 v[94:95], v11 offset:34048
    ds_read_b64_tr_b16 v[96:97], v11 offset:2048
    ds_read_b64_tr_b16 v[98:99], v11 offset:2304
    s_waitcnt vmcnt(14) lgkmcnt(8)
    v_mfma_f32_32x32x16_bf16 v[32:47], v[80:83], a[176:179], 0
    ds_read_b64_tr_b16 v[100:101], v11 offset:34816
    ds_read_b64_tr_b16 v[102:103], v11 offset:35072
    s_xor_b32 s36, s29, 12288
    buffer_load_dwordx4 a[224:227], v1, s[4:7], s36 offen offset:0 sc1
    s_waitcnt lgkmcnt(8)
    v_mfma_f32_32x32x16_bf16 v[48:63], v[84:87], a[176:179], 0
    ds_read_b64_tr_b16 v[104:105], v11 offset:3072
    ds_read_b64_tr_b16 v[106:107], v11 offset:3328
    s_xor_b32 s36, s29, 12288
    buffer_load_dwordx4 a[228:231], v1, s[4:7], s36 offen offset:1024 sc1
    s_waitcnt vmcnt(15) lgkmcnt(8)
    v_mfma_f32_32x32x16_bf16 v[32:47], v[88:91], a[180:183], v[32:47]
    ds_read_b64_tr_b16 v[108:109], v11 offset:35840
    ds_read_b64_tr_b16 v[110:111], v11 offset:36096
    s_xor_b32 s36, s29, 12288
    buffer_load_dwordx4 a[232:235], v1, s[4:7], s36 offen offset:2048 sc1
    s_waitcnt lgkmcnt(8)
    v_mfma_f32_32x32x16_bf16 v[48:63], v[92:95], a[180:183], v[48:63]
    v_xor_b32 v12, 4096, v17
    ds_read_b64_tr_b16 v[80:81], v12 offset:0
    ds_read_b64_tr_b16 v[82:83], v12 offset:256
    s_xor_b32 s36, s29, 12288
    buffer_load_dwordx4 a[236:239], v1, s[4:7], s36 offen offset:3072 sc1
    s_waitcnt vmcnt(16) lgkmcnt(8)
    v_mfma_f32_32x32x16_bf16 v[32:47], v[96:99], a[184:187], v[32:47]
    ds_read_b64_tr_b16 v[84:85], v12 offset:32768
    ds_read_b64_tr_b16 v[86:87], v12 offset:33024
    s_xor_b32 s36, s31, 3072
    buffer_load_dwordx4 v[188:191], v1, s[4:7], s36 offen sc1
    s_waitcnt lgkmcnt(8)
    v_mfma_f32_32x32x16_bf16 v[48:63], v[100:103], a[184:187], v[48:63]
    ds_read_b64_tr_b16 v[88:89], v12 offset:1024
    ds_read_b64_tr_b16 v[90:91], v12 offset:1280
    s_xor_b32 s36, s29, 16384
    buffer_load_dwordx4 a[240:243], v1, s[4:7], s36 offen offset:0 sc1
    s_waitcnt vmcnt(17) lgkmcnt(8)
    v_mfma_f32_32x32x16_bf16 v[32:47], v[104:107], a[188:191], v[32:47]
    ds_read_b64_tr_b16 v[92:93], v12 offset:33792
    ds_read_b64_tr_b16 v[94:95], v12 offset:34048
    s_xor_b32 s36, s29, 16384
    buffer_load_dwordx4 a[244:247], v1, s[4:7], s36 offen offset:1024 sc1
    s_waitcnt lgkmcnt(8)
    v_mfma_f32_32x32x16_bf16 v[48:63], v[108:111], a[188:191], v[48:63]
    ds_read_b64_tr_b16 v[96:97], v12 offset:2048
    ds_read_b64_tr_b16 v[98:99], v12 offset:2304
    s_xor_b32 s36, s29, 16384
    buffer_load_dwordx4 a[248:251], v1, s[4:7], s36 offen offset:2048 sc1
    s_waitcnt vmcnt(17) lgkmcnt(8)
    v_mfma_f32_32x32x16_bf16 v[32:47], v[80:83], a[192:195], v[32:47]
    ds_read_b64_tr_b16 v[100:101], v12 offset:34816
    ds_read_b64_tr_b16 v[102:103], v12 offset:35072
    s_xor_b32 s36, s29, 16384
    buffer_load_dwordx4 a[252:255], v1, s[4:7], s36 offen offset:3072 sc1
    s_waitcnt lgkmcnt(8)
    v_mfma_f32_32x32x16_bf16 v[48:63], v[84:87], a[192:195], v[48:63]
    ds_read_b64_tr_b16 v[104:105], v12 offset:3072
    ds_read_b64_tr_b16 v[106:107], v12 offset:3328
    s_xor_b32 s36, s29, 20480
    buffer_load_dwordx4 v[208:211], v1, s[4:7], s36 offen offset:0 sc1
    s_waitcnt vmcnt(18) lgkmcnt(8)
    v_mfma_f32_32x32x16_bf16 v[32:47], v[88:91], a[196:199], v[32:47]
    ds_read_b64_tr_b16 v[108:109], v12 offset:35840
    ds_read_b64_tr_b16 v[110:111], v12 offset:36096
    s_xor_b32 s36, s29, 20480
    buffer_load_dwordx4 v[212:215], v1, s[4:7], s36 offen offset:1024 sc1
    s_waitcnt lgkmcnt(8)
    v_mfma_f32_32x32x16_bf16 v[48:63], v[92:95], a[196:199], v[48:63]
    v_xor_b32 v11, 8192, v17
    ds_read_b64_tr_b16 v[80:81], v11 offset:0
    ds_read_b64_tr_b16 v[82:83], v11 offset:256
    s_xor_b32 s36, s29, 20480
    buffer_load_dwordx4 v[216:219], v1, s[4:7], s36 offen offset:2048 sc1
    s_waitcnt vmcnt(19) lgkmcnt(8)
    v_mfma_f32_32x32x16_bf16 v[32:47], v[96:99], a[200:203], v[32:47]
    ds_read_b64_tr_b16 v[84:85], v11 offset:32768
    ds_read_b64_tr_b16 v[86:87], v11 offset:33024
    s_xor_b32 s36, s29, 20480
    buffer_load_dwordx4 v[220:223], v1, s[4:7], s36 offen offset:3072 sc1
    s_waitcnt lgkmcnt(8)
    v_mfma_f32_32x32x16_bf16 v[48:63], v[100:103], a[200:203], v[48:63]
    ds_read_b64_tr_b16 v[88:89], v11 offset:1024
    ds_read_b64_tr_b16 v[90:91], v11 offset:1280
    s_xor_b32 s36, s29, 24576
    buffer_load_dwordx4 v[224:227], v1, s[4:7], s36 offen offset:0 sc1
    s_waitcnt vmcnt(20) lgkmcnt(8)
    v_mfma_f32_32x32x16_bf16 v[32:47], v[104:107], a[204:207], v[32:47]
    ds_read_b64_tr_b16 v[92:93], v11 offset:33792
    ds_read_b64_tr_b16 v[94:95], v11 offset:34048
    s_xor_b32 s36, s29, 24576
    buffer_load_dwordx4 v[228:231], v1, s[4:7], s36 offen offset:1024 sc1
    s_waitcnt lgkmcnt(8)
    v_mfma_f32_32x32x16_bf16 v[48:63], v[108:111], a[204:207], v[48:63]
    ds_read_b64_tr_b16 v[96:97], v11 offset:2048
    ds_read_b64_tr_b16 v[98:99], v11 offset:2304
    s_xor_b32 s36, s29, 24576
    buffer_load_dwordx4 v[232:235], v1, s[4:7], s36 offen offset:2048 sc1
    s_waitcnt vmcnt(20) lgkmcnt(8)
    v_mfma_f32_32x32x16_bf16 v[32:47], v[80:83], a[208:211], v[32:47]
    ds_read_b64_tr_b16 v[100:101], v11 offset:34816
    ds_read_b64_tr_b16 v[102:103], v11 offset:35072
    s_xor_b32 s36, s29, 24576
    buffer_load_dwordx4 v[236:239], v1, s[4:7], s36 offen offset:3072 sc1
    s_waitcnt lgkmcnt(8)
    v_mfma_f32_32x32x16_bf16 v[48:63], v[84:87], a[208:211], v[48:63]
    ds_read_b64_tr_b16 v[104:105], v11 offset:3072
    ds_read_b64_tr_b16 v[106:107], v11 offset:3328
    s_xor_b32 s36, s29, 28672
    buffer_load_dwordx4 v[240:243], v1, s[4:7], s36 offen offset:0 sc1
    s_waitcnt vmcnt(21) lgkmcnt(8)
    v_mfma_f32_32x32x16_bf16 v[32:47], v[88:91], a[212:215], v[32:47]
    ds_read_b64_tr_b16 v[108:109], v11 offset:35840
    ds_read_b64_tr_b16 v[110:111], v11 offset:36096
    s_xor_b32 s36, s29, 28672
    buffer_load_dwordx4 v[244:247], v1, s[4:7], s36 offen offset:1024 sc1
    s_waitcnt lgkmcnt(8)
    v_mfma_f32_32x32x16_bf16 v[48:63], v[92:95], a[212:215], v[48:63]
    v_xor_b32 v12, 12288, v17
    ds_read_b64_tr_b16 v[80:81], v12 offset:0
    ds_read_b64_tr_b16 v[82:83], v12 offset:256
    s_xor_b32 s36, s29, 28672
    buffer_load_dwordx4 v[248:251], v1, s[4:7], s36 offen offset:2048 sc1
    s_waitcnt vmcnt(22) lgkmcnt(8)
    v_mfma_f32_32x32x16_bf16 v[32:47], v[96:99], a[216:219], v[32:47]
    ds_read_b64_tr_b16 v[84:85], v12 offset:32768
    ds_read_b64_tr_b16 v[86:87], v12 offset:33024
    s_xor_b32 s36, s29, 28672
    buffer_load_dwordx4 v[252:255], v1, s[4:7], s36 offen offset:3072 sc1
    s_waitcnt lgkmcnt(8)
    v_mfma_f32_32x32x16_bf16 v[48:63], v[100:103], a[216:219], v[48:63]
    ds_read_b64_tr_b16 v[88:89], v12 offset:1024
    ds_read_b64_tr_b16 v[90:91], v12 offset:1280
    s_waitcnt vmcnt(22) lgkmcnt(8)
    v_mfma_f32_32x32x16_bf16 v[32:47], v[104:107], a[220:223], v[32:47]
    ds_read_b64_tr_b16 v[92:93], v12 offset:33792
    ds_read_b64_tr_b16 v[94:95], v12 offset:34048
    s_waitcnt lgkmcnt(8)
    v_mfma_f32_32x32x16_bf16 v[48:63], v[108:111], a[220:223], v[48:63]
    ds_read_b64_tr_b16 v[96:97], v12 offset:2048
    ds_read_b64_tr_b16 v[98:99], v12 offset:2304
    s_waitcnt vmcnt(20) lgkmcnt(8)
    v_mfma_f32_32x32x16_bf16 v[32:47], v[80:83], a[224:227], v[32:47]
    ds_read_b64_tr_b16 v[100:101], v12 offset:34816
    ds_read_b64_tr_b16 v[102:103], v12 offset:35072
    s_waitcnt lgkmcnt(8)
    v_mfma_f32_32x32x16_bf16 v[48:63], v[84:87], a[224:227], v[48:63]
    ds_read_b64_tr_b16 v[104:105], v12 offset:3072
    ds_read_b64_tr_b16 v[106:107], v12 offset:3328
    s_waitcnt vmcnt(19) lgkmcnt(8)
    v_mfma_f32_32x32x16_bf16 v[32:47], v[88:91], a[228:231], v[32:47]
    ds_read_b64_tr_b16 v[108:109], v12 offset:35840
    ds_read_b64_tr_b16 v[110:111], v12 offset:36096
    s_waitcnt lgkmcnt(8)
    v_mfma_f32_32x32x16_bf16 v[48:63], v[92:95], a[228:231], v[48:63]
    v_xor_b32 v11, 16384, v17
    ds_read_b64_tr_b16 v[80:81], v11 offset:0
    ds_read_b64_tr_b16 v[82:83], v11 offset:256
    ds_read_b128 v[160:163], v22 offset:0
    ds_read_b128 v[112:115], v22 offset:128
    ds_read_b128 v[164:167], v22 offset:16
    s_waitcnt vmcnt(18) lgkmcnt(11)
    v_mfma_f32_32x32x16_bf16 v[32:47], v[96:99], a[232:235], v[32:47]
    ds_read_b64_tr_b16 v[84:85], v11 offset:32768
    ds_read_b64_tr_b16 v[86:87], v11 offset:33024
    ds_read_b128 v[116:119], v22 offset:144
    ds_read_b128 v[168:171], v22 offset:32
    ds_read_b128 v[120:123], v22 offset:160
    s_waitcnt lgkmcnt(14)
    v_mfma_f32_32x32x16_bf16 v[48:63], v[100:103], a[232:235], v[48:63]
    ds_read_b64_tr_b16 v[88:89], v11 offset:1024
    ds_read_b64_tr_b16 v[90:91], v11 offset:1280
    ds_read_b128 v[172:175], v22 offset:48
    ds_read_b128 v[124:127], v22 offset:176
    s_waitcnt vmcnt(17) lgkmcnt(15)
    v_mfma_f32_32x32x16_bf16 v[32:47], v[104:107], a[236:239], v[32:47]
    ds_read_b64_tr_b16 v[92:93], v11 offset:33792
    ds_read_b64_tr_b16 v[94:95], v11 offset:34048
    s_waitcnt vmcnt(16)
    v_add_f32 v176, v176, v184
    v_add_f32 v177, v177, v185
    s_waitcnt lgkmcnt(15)
    v_mfma_f32_32x32x16_bf16 v[48:63], v[108:111], a[236:239], v[48:63]
    ds_read_b64_tr_b16 v[96:97], v11 offset:2048
    ds_read_b64_tr_b16 v[98:99], v11 offset:2304
    v_add_f32 v178, v178, v186
    v_add_f32 v179, v179, v187
    v_add_f32 v180, v180, v188
    s_waitcnt vmcnt(15) lgkmcnt(15)
    v_mfma_f32_32x32x16_bf16 v[32:47], v[80:83], a[240:243], v[32:47]
    ds_read_b64_tr_b16 v[100:101], v11 offset:34816
    ds_read_b64_tr_b16 v[102:103], v11 offset:35072
    v_add_f32 v181, v181, v189
    v_add_f32 v182, v182, v190
    v_add_f32 v183, v183, v191
    s_waitcnt lgkmcnt(13)
    v_mfma_f32_32x32x16_bf16 v[48:63], v[84:87], a[240:243], v[48:63]
    ds_read_b64_tr_b16 v[104:105], v11 offset:3072
    ds_read_b64_tr_b16 v[106:107], v11 offset:3328
    v_add_f32 v176, v176, v180
    v_add_f32 v177, v177, v181
    v_add_f32 v178, v178, v182
    s_waitcnt vmcnt(14) lgkmcnt(10)
    v_mfma_f32_32x32x16_bf16 v[32:47], v[88:91], a[244:247], v[32:47]
    ds_read_b64_tr_b16 v[108:109], v11 offset:35840
    ds_read_b64_tr_b16 v[110:111], v11 offset:36096
    v_add_f32 v179, v179, v183
    s_lshl_b32 s56, s3, 10
    v_add_u32 v180, s56, v1
    s_waitcnt lgkmcnt(8)
    v_mfma_f32_32x32x16_bf16 v[48:63], v[92:95], a[244:247], v[48:63]
    v_xor_b32 v12, 20480, v17
    ds_read_b64_tr_b16 v[80:81], v12 offset:0
    ds_read_b64_tr_b16 v[82:83], v12 offset:256
    v_lshlrev_b32 v181, 2, v0
    v_add_u32 v181, s56, v181
    ds_write_b128 v180, v[176:179] offset:49152
    s_waitcnt vmcnt(13) lgkmcnt(9)
    v_mfma_f32_32x32x16_bf16 v[32:47], v[96:99], a[248:251], v[32:47]
    ds_read_b64_tr_b16 v[84:85], v12 offset:32768
    ds_read_b64_tr_b16 v[86:87], v12 offset:33024
    ds_read2st64_b32 v[184:185], v181 offset0:192 offset1:193
    ds_read2st64_b32 v[186:187], v181 offset0:194 offset1:195
    s_nop 0
    s_waitcnt lgkmcnt(11)
    v_mfma_f32_32x32x16_bf16 v[48:63], v[100:103], a[248:251], v[48:63]
    ds_read_b64_tr_b16 v[88:89], v12 offset:1024
    ds_read_b64_tr_b16 v[90:91], v12 offset:1280
    s_nop 0
    s_nop 0
    s_nop 0
    s_waitcnt vmcnt(12) lgkmcnt(11)
    v_mfma_f32_32x32x16_bf16 v[32:47], v[104:107], a[252:255], v[32:47]
    ds_read_b64_tr_b16 v[92:93], v12 offset:33792
    ds_read_b64_tr_b16 v[94:95], v12 offset:34048
    s_nop 0
    s_nop 0
    s_nop 0
    s_waitcnt lgkmcnt(11)
    v_mfma_f32_32x32x16_bf16 v[48:63], v[108:111], a[252:255], v[48:63]
    ds_read_b64_tr_b16 v[96:97], v12 offset:2048
    ds_read_b64_tr_b16 v[98:99], v12 offset:2304
    s_nop 0
    s_nop 0
    s_waitcnt lgkmcnt(6)
    s_waitcnt vmcnt(11)
    v_mfma_f32_32x32x16_bf16 v[32:47], v[80:83], v[208:211], v[32:47]
    ds_read_b64_tr_b16 v[100:101], v12 offset:34816
    ds_read_b64_tr_b16 v[102:103], v12 offset:35072
    v_add_f32 v184, v184, v185
    v_add_f32 v186, v186, v187
    v_add_f32 v176, v184, v186
    v_mfma_f32_32x32x16_bf16 v[48:63], v[84:87], v[208:211], v[48:63]
    ds_read_b64_tr_b16 v[104:105], v12 offset:3072
    ds_read_b64_tr_b16 v[106:107], v12 offset:3328
    v_mul_f32 v176, 0x3b000000, v176
    v_mov_b32 v177, v176
    s_nop 1
    v_permlane32_swap_b32 v176, v177
    s_waitcnt vmcnt(10) lgkmcnt(8)
    v_mfma_f32_32x32x16_bf16 v[32:47], v[88:91], v[212:215], v[32:47]
    ds_read_b64_tr_b16 v[108:109], v12 offset:35840
    ds_read_b64_tr_b16 v[110:111], v12 offset:36096
    v_fma_f32 v177, -v176, v176, v177
    v_max_f32 v177, 0, v177
    v_add_f32 v177, 0x3727c5ac, v177
    s_waitcnt lgkmcnt(8)
    v_mfma_f32_32x32x16_bf16 v[48:63], v[92:95], v[212:215], v[48:63]
    v_xor_b32 v11, 24576, v17
    ds_read_b64_tr_b16 v[80:81], v11 offset:0
    ds_read_b64_tr_b16 v[82:83], v11 offset:256
    v_rsq_f32 v192, v177
    s_nop 0
    v_mul_f32 v193, v192, v176
    s_waitcnt vmcnt(9) lgkmcnt(8)
    v_mfma_f32_32x32x16_bf16 v[32:47], v[96:99], v[216:219], v[32:47]
    ds_read_b64_tr_b16 v[84:85], v11 offset:32768
    ds_read_b64_tr_b16 v[86:87], v11 offset:33024
    ds_read_b64_tr_b16 a[0:1], v9 offset:0
    ds_read_b64_tr_b16 a[2:3], v9 offset:256
    ds_read_b64_tr_b16 a[4:5], v9 offset:1024
    ds_read_b64_tr_b16 a[6:7], v9 offset:1280
    ds_read_b64_tr_b16 a[8:9], v9 offset:2048
    ds_read_b64_tr_b16 a[10:11], v9 offset:2304
    ds_read_b64_tr_b16 a[12:13], v9 offset:3072
    ds_read_b64_tr_b16 a[14:15], v9 offset:3328
    s_waitcnt lgkmcnt(0)
    s_add_u32 m0, s30, 0
    s_lshl4_add_u32 s36, s11, s20
    buffer_load_dwordx4 v2, s[32:35], s36 offen offset:0  lds
    s_add_u32 m0, s30, 0
    s_lshl4_add_u32 s36, s11, s20
    buffer_load_dwordx4 v3, s[32:35], s36 offen offset:1024  lds
    s_add_u32 m0, s30, 0
    s_lshl4_add_u32 s36, s11, s20
    buffer_load_dwordx4 v4, s[32:35], s36 offen offset:2048  lds
    s_add_u32 m0, s30, 0
    s_lshl4_add_u32 s36, s11, s20
    buffer_load_dwordx4 v5, s[32:35], s36 offen offset:3072  lds
    v_fma_f32 v112, -v193, v160, v112
    v_fma_f32 v113, -v193, v161, v113
    v_fma_f32 v114, -v193, v162, v114
    v_mfma_f32_32x32x16_bf16 v[48:63], v[100:103], v[216:219], v[48:63]
    ds_read_b64_tr_b16 v[88:89], v11 offset:1024
    ds_read_b64_tr_b16 v[90:91], v11 offset:1280
    v_fma_f32 v115, -v193, v163, v115
    v_fma_f32 v116, -v193, v164, v116
    v_fma_f32 v117, -v193, v165, v117
    s_waitcnt vmcnt(12)
    v_mfma_f32_32x32x16_bf16 v[32:47], v[104:107], v[220:223], v[32:47]
    ds_read_b64_tr_b16 v[92:93], v11 offset:33792
    ds_read_b64_tr_b16 v[94:95], v11 offset:34048
    v_fma_f32 v118, -v193, v166, v118
    v_fma_f32 v119, -v193, v167, v119
    v_fma_f32 v120, -v193, v168, v120
    v_mfma_f32_32x32x16_bf16 v[48:63], v[108:111], v[220:223], v[48:63]
    ds_read_b64_tr_b16 v[96:97], v11 offset:2048
    ds_read_b64_tr_b16 v[98:99], v11 offset:2304
    v_fma_f32 v121, -v193, v169, v121
    v_fma_f32 v122, -v193, v170, v122
    v_fma_f32 v123, -v193, v171, v123
    s_waitcnt vmcnt(11)
    v_mfma_f32_32x32x16_bf16 v[32:47], v[80:83], v[224:227], v[32:47]
    ds_read_b64_tr_b16 v[100:101], v11 offset:34816
    ds_read_b64_tr_b16 v[102:103], v11 offset:35072
    v_fma_f32 v124, -v193, v172, v124
    v_fma_f32 v125, -v193, v173, v125
    v_fma_f32 v126, -v193, v174, v126
    v_mfma_f32_32x32x16_bf16 v[48:63], v[84:87], v[224:227], v[48:63]
    ds_read_b64_tr_b16 v[104:105], v11 offset:3072
    ds_read_b64_tr_b16 v[106:107], v11 offset:3328
    v_fma_f32 v127, -v193, v175, v127
    ds_read_b128 v[160:163], v22 offset:256
    ds_read_b128 v[128:131], v22 offset:384
    s_waitcnt vmcnt(10) lgkmcnt(10)
    v_mfma_f32_32x32x16_bf16 v[32:47], v[88:91], v[228:231], v[32:47]
    ds_read_b64_tr_b16 v[108:109], v11 offset:35840
    ds_read_b64_tr_b16 v[110:111], v11 offset:36096
    ds_read_b128 v[164:167], v22 offset:272
    ds_read_b128 v[132:135], v22 offset:400
    ds_read_b128 v[168:171], v22 offset:288
    s_waitcnt lgkmcnt(13)
    v_mfma_f32_32x32x16_bf16 v[48:63], v[92:95], v[228:231], v[48:63]
    v_xor_b32 v12, 28672, v17
    ds_read_b64_tr_b16 v[80:81], v12 offset:0
    ds_read_b64_tr_b16 v[82:83], v12 offset:256
    ds_read_b128 v[136:139], v22 offset:416
    ds_read_b128 v[172:175], v22 offset:304
    ds_read_b128 v[140:143], v22 offset:432
    s_waitcnt vmcnt(9) lgkmcnt(15)
    v_mfma_f32_32x32x16_bf16 v[32:47], v[96:99], v[232:235], v[32:47]
    ds_read_b64_tr_b16 v[84:85], v12 offset:32768
    ds_read_b64_tr_b16 v[86:87], v12 offset:33024
    s_waitcnt lgkmcnt(2)
    v_fma_f32 v128, -v193, v160, v128
    v_fma_f32 v129, -v193, v161, v129
    v_mfma_f32_32x32x16_bf16 v[48:63], v[100:103], v[232:235], v[48:63]
    ds_read_b64_tr_b16 v[88:89], v12 offset:1024
    ds_read_b64_tr_b16 v[90:91], v12 offset:1280
    v_fma_f32 v130, -v193, v162, v130
    v_fma_f32 v131, -v193, v163, v131
    v_fma_f32 v132, -v193, v164, v132
    s_waitcnt vmcnt(8)
    v_mfma_f32_32x32x16_bf16 v[32:47], v[104:107], v[236:239], v[32:47]
    ds_read_b64_tr_b16 v[92:93], v12 offset:33792
    ds_read_b64_tr_b16 v[94:95], v12 offset:34048
    ds_read_b64_tr_b16 a[16:17], v9 offset:16384
    ds_read_b64_tr_b16 a[18:19], v9 offset:16640
    ds_read_b64_tr_b16 a[20:21], v9 offset:17408
    ds_read_b64_tr_b16 a[22:23], v9 offset:17664
    ds_read_b64_tr_b16 a[24:25], v9 offset:18432
    ds_read_b64_tr_b16 a[26:27], v9 offset:18688
    ds_read_b64_tr_b16 a[28:29], v9 offset:19456
    ds_read_b64_tr_b16 a[30:31], v9 offset:19712
    s_waitcnt lgkmcnt(0)
    s_add_u32 m0, s30, 16384
    s_lshl4_add_u32 s36, s12, s20
    buffer_load_dwordx4 v2, s[32:35], s36 offen offset:0  lds
    s_add_u32 m0, s30, 16384
    s_lshl4_add_u32 s36, s12, s20
    buffer_load_dwordx4 v3, s[32:35], s36 offen offset:1024  lds
    s_add_u32 m0, s30, 16384
    s_lshl4_add_u32 s36, s12, s20
    buffer_load_dwordx4 v4, s[32:35], s36 offen offset:2048  lds
    s_add_u32 m0, s30, 16384
    s_lshl4_add_u32 s36, s12, s20
    buffer_load_dwordx4 v5, s[32:35], s36 offen offset:3072  lds
    v_fma_f32 v133, -v193, v165, v133
    v_fma_f32 v134, -v193, v166, v134
    v_fma_f32 v135, -v193, v167, v135
    v_mfma_f32_32x32x16_bf16 v[48:63], v[108:111], v[236:239], v[48:63]
    ds_read_b64_tr_b16 v[96:97], v12 offset:2048
    ds_read_b64_tr_b16 v[98:99], v12 offset:2304
    v_fma_f32 v136, -v193, v168, v136
    v_fma_f32 v137, -v193, v169, v137
    v_fma_f32 v138, -v193, v170, v138
    s_waitcnt vmcnt(11)
    v_mfma_f32_32x32x16_bf16 v[32:47], v[80:83], v[240:243], v[32:47]
    ds_read_b64_tr_b16 v[100:101], v12 offset:34816
    ds_read_b64_tr_b16 v[102:103], v12 offset:35072
    v_fma_f32 v139, -v193, v171, v139
    v_fma_f32 v140, -v193, v172, v140
    v_fma_f32 v141, -v193, v173, v141
    v_mfma_f32_32x32x16_bf16 v[48:63], v[84:87], v[240:243], v[48:63]
    ds_read_b64_tr_b16 v[104:105], v12 offset:3072
    ds_read_b64_tr_b16 v[106:107], v12 offset:3328
    v_fma_f32 v142, -v193, v174, v142
    v_fma_f32 v143, -v193, v175, v143
    ds_read_b128 v[160:163], v22 offset:512
    s_waitcnt vmcnt(10)
    v_mfma_f32_32x32x16_bf16 v[32:47], v[88:91], v[244:247], v[32:47]
    ds_read_b64_tr_b16 v[108:109], v12 offset:35840
    ds_read_b64_tr_b16 v[110:111], v12 offset:36096
    ds_read_b128 v[144:147], v22 offset:640
    ds_read_b128 v[164:167], v22 offset:528
    ds_read_b128 v[148:151], v22 offset:656
    v_mfma_f32_32x32x16_bf16 v[48:63], v[92:95], v[244:247], v[48:63]
    v_xor_b32 v11, 0, v18
    ds_read_b64_tr_b16 v[80:81], v11 offset:0
    ds_read_b64_tr_b16 v[82:83], v11 offset:256
    ds_read_b128 v[168:171], v22 offset:544
    ds_read_b128 v[152:155], v22 offset:672
    ds_read_b128 v[172:175], v22 offset:560
    s_waitcnt vmcnt(9) lgkmcnt(15)
    v_mfma_f32_32x32x16_bf16 v[32:47], v[96:99], v[248:251], v[32:47]
    ds_read_b64_tr_b16 v[84:85], v11 offset:1024
    ds_read_b64_tr_b16 v[86:87], v11 offset:1280
    ds_read_b128 v[156:159], v22 offset:688
    s_waitcnt lgkmcnt(0)
    v_fma_f32 v144, -v193, v160, v144
    v_mfma_f32_32x32x16_bf16 v[48:63], v[100:103], v[248:251], v[48:63]
    ds_read_b64_tr_b16 v[88:89], v11 offset:2048
    ds_read_b64_tr_b16 v[90:91], v11 offset:2304
    v_fma_f32 v145, -v193, v161, v145
    v_fma_f32 v146, -v193, v162, v146
    v_fma_f32 v147, -v193, v163, v147
    s_waitcnt vmcnt(8)
    v_mfma_f32_32x32x16_bf16 v[32:47], v[104:107], v[252:255], v[32:47]
    ds_read_b64_tr_b16 v[92:93], v11 offset:3072
    ds_read_b64_tr_b16 v[94:95], v11 offset:3328
    v_fma_f32 v148, -v193, v164, v148
    v_fma_f32 v149, -v193, v165, v149
    v_fma_f32 v150, -v193, v166, v150
    v_mfma_f32_32x32x16_bf16 v[48:63], v[108:111], v[252:255], v[48:63]
    v_xor_b32 v12, 4096, v18
    ds_read_b64_tr_b16 v[96:97], v12 offset:0
    ds_read_b64_tr_b16 v[98:99], v12 offset:256
    v_fma_f32 v151, -v193, v167, v151
    v_fma_f32 v152, -v193, v168, v152
    v_fma_f32 v153, -v193, v169, v153
    v_mfma_f32_32x32x16_bf16 v[64:79], v[80:83], a[176:179], 0
    ds_read_b64_tr_b16 v[100:101], v12 offset:1024
    ds_read_b64_tr_b16 v[102:103], v12 offset:1280
    v_fma_f32 v154, -v193, v170, v154
    v_fma_f32 v155, -v193, v171, v155
    v_fma_f32 v156, -v193, v172, v156
    v_fma_f32 v157, -v193, v173, v157
    v_mfma_f32_32x32x16_bf16 v[64:79], v[84:87], a[180:183], v[64:79]
    ds_read_b64_tr_b16 v[104:105], v12 offset:2048
    ds_read_b64_tr_b16 v[106:107], v12 offset:2304
    v_fma_f32 v158, -v193, v174, v158
    v_fma_f32 v159, -v193, v175, v159
    v_fma_f32 v112, v192, v32, v112
    v_fma_f32 v113, v192, v33, v113
    s_waitcnt lgkmcnt(8)
    v_mfma_f32_32x32x16_bf16 v[64:79], v[88:91], a[184:187], v[64:79]
    ds_read_b64_tr_b16 v[108:109], v12 offset:3072
    ds_read_b64_tr_b16 v[110:111], v12 offset:3328
    ds_read_b64_tr_b16 a[32:33], v9 offset:32768
    ds_read_b64_tr_b16 a[34:35], v9 offset:33024
    ds_read_b64_tr_b16 a[36:37], v9 offset:33792
    ds_read_b64_tr_b16 a[38:39], v9 offset:34048
    ds_read_b64_tr_b16 a[40:41], v9 offset:34816
    ds_read_b64_tr_b16 a[42:43], v9 offset:35072
    ds_read_b64_tr_b16 a[44:45], v9 offset:35840
    ds_read_b64_tr_b16 a[46:47], v9 offset:36096
    s_waitcnt lgkmcnt(0)
    s_add_u32 m0, s30, 32768
    s_lshl4_add_u32 s36, s13, s20
    buffer_load_dwordx4 v2, s[32:35], s36 offen offset:0  lds
    s_add_u32 m0, s30, 32768
    s_lshl4_add_u32 s36, s13, s20
    buffer_load_dwordx4 v3, s[32:35], s36 offen offset:1024  lds
    s_add_u32 m0, s30, 32768
    s_lshl4_add_u32 s36, s13, s20
    buffer_load_dwordx4 v4, s[32:35], s36 offen offset:2048  lds
    s_add_u32 m0, s30, 32768
    s_lshl4_add_u32 s36, s13, s20
    buffer_load_dwordx4 v5, s[32:35], s36 offen offset:3072  lds
    v_fma_f32 v114, v192, v34, v114
    v_fma_f32 v115, v192, v35, v115
    v_fma_f32 v116, v192, v36, v116
    v_fma_f32 v117, v192, v37, v117
    v_mfma_f32_32x32x16_bf16 v[64:79], v[92:95], a[188:191], v[64:79]
    v_xor_b32 v11, 8192, v18
    ds_read_b64_tr_b16 v[80:81], v11 offset:0
    ds_read_b64_tr_b16 v[82:83], v11 offset:256
    v_fma_f32 v118, v192, v38, v118
    v_fma_f32 v119, v192, v39, v119
    v_cvt_pk_bf16_f32 v32, v112, v113
    v_cvt_pk_bf16_f32 v33, v114, v115
    v_mfma_f32_32x32x16_bf16 v[64:79], v[96:99], a[192:195], v[64:79]
    ds_read_b64_tr_b16 v[84:85], v11 offset:1024
    ds_read_b64_tr_b16 v[86:87], v11 offset:1280
    v_cvt_pk_bf16_f32 v34, v116, v117
    v_cvt_pk_bf16_f32 v35, v118, v119
    v_pk_max_i16 v32, v32, 0
    v_pk_max_i16 v33, v33, 0
    v_mfma_f32_32x32x16_bf16 v[64:79], v[100:103], a[196:199], v[64:79]
    ds_read_b64_tr_b16 v[88:89], v11 offset:2048
    ds_read_b64_tr_b16 v[90:91], v11 offset:2304
    v_pk_max_i16 v34, v34, 0
    v_pk_max_i16 v35, v35, 0
    s_waitcnt vmcnt(8)
    ds_read_b64_tr_b16 a[48:49], v9 offset:0
    ds_read_b64_tr_b16 a[50:51], v9 offset:256
    v_mfma_f32_32x32x16_bf16 v[64:79], v[104:107], a[200:203], v[64:79]
    ds_read_b64_tr_b16 v[92:93], v11 offset:3072
    ds_read_b64_tr_b16 v[94:95], v11 offset:3328
    buffer_store_dwordx4 v[32:35], v1, s[4:7], s40 offen offset:0 sc1
    v_fma_f32 v120, v192, v40, v120
    v_mfma_f32_32x32x16_bf16 v[64:79], v[108:111], a[204:207], v[64:79]
    v_xor_b32 v12, 12288, v18
    ds_read_b64_tr_b16 v[96:97], v12 offset:0
    ds_read_b64_tr_b16 v[98:99], v12 offset:256
    v_fma_f32 v121, v192, v41, v121
    v_fma_f32 v122, v192, v42, v122
    v_fma_f32 v123, v192, v43, v123
    v_fma_f32 v124, v192, v44, v124
    s_waitcnt lgkmcnt(10)
    v_mfma_f32_32x32x16_bf16 v[64:79], v[80:83], a[208:211], v[64:79]
    ds_read_b64_tr_b16 v[100:101], v12 offset:1024
    ds_read_b64_tr_b16 v[102:103], v12 offset:1280
    v_fma_f32 v125, v192, v45, v125
    v_fma_f32 v126, v192, v46, v126
    v_fma_f32 v127, v192, v47, v127
    v_cvt_pk_bf16_f32 v36, v120, v121
    s_waitcnt lgkmcnt(10)
    v_mfma_f32_32x32x16_bf16 v[64:79], v[84:87], a[212:215], v[64:79]
    ds_read_b64_tr_b16 v[104:105], v12 offset:2048
    ds_read_b64_tr_b16 v[106:107], v12 offset:2304
    v_cvt_pk_bf16_f32 v37, v122, v123
    v_cvt_pk_bf16_f32 v38, v124, v125
    v_cvt_pk_bf16_f32 v39, v126, v127
    v_pk_max_i16 v36, v36, 0
    s_waitcnt lgkmcnt(10)
    v_mfma_f32_32x32x16_bf16 v[64:79], v[88:91], a[216:219], v[64:79]
    ds_read_b64_tr_b16 v[108:109], v12 offset:3072
    ds_read_b64_tr_b16 v[110:111], v12 offset:3328
    v_pk_max_i16 v37, v37, 0
    v_pk_max_i16 v38, v38, 0
    v_pk_max_i16 v39, v39, 0
    ds_read_b64_tr_b16 a[52:53], v9 offset:1024
    s_waitcnt lgkmcnt(9)
    v_mfma_f32_32x32x16_bf16 v[64:79], v[92:95], a[220:223], v[64:79]
    v_xor_b32 v11, 16384, v18
    ds_read_b64_tr_b16 v[80:81], v11 offset:0
    ds_read_b64_tr_b16 v[82:83], v11 offset:256
    ds_read_b64_tr_b16 a[54:55], v9 offset:1280
    ds_read_b64_tr_b16 a[56:57], v9 offset:2048
    ds_read_b64_tr_b16 a[58:59], v9 offset:2304
    ds_read_b64_tr_b16 a[60:61], v9 offset:3072
    s_waitcnt lgkmcnt(13)
    v_mfma_f32_32x32x16_bf16 v[64:79], v[96:99], a[224:227], v[64:79]
    ds_read_b64_tr_b16 v[84:85], v11 offset:1024
    ds_read_b64_tr_b16 v[86:87], v11 offset:1280
    buffer_store_dwordx4 v[36:39], v1, s[4:7], s40 offen offset:1024 sc1
    v_fma_f32 v128, v192, v48, v128
    s_waitcnt lgkmcnt(13)
    v_mfma_f32_32x32x16_bf16 v[64:79], v[100:103], a[228:231], v[64:79]
    ds_read_b64_tr_b16 v[88:89], v11 offset:2048
    ds_read_b64_tr_b16 v[90:91], v11 offset:2304
    v_fma_f32 v129, v192, v49, v129
    v_fma_f32 v130, v192, v50, v130
    v_fma_f32 v131, v192, v51, v131
    v_fma_f32 v132, v192, v52, v132
    s_waitcnt lgkmcnt(13)
    v_mfma_f32_32x32x16_bf16 v[64:79], v[104:107], a[232:235], v[64:79]
    ds_read_b64_tr_b16 v[92:93], v11 offset:3072
    ds_read_b64_tr_b16 v[94:95], v11 offset:3328
    ds_read_b64_tr_b16 a[62:63], v9 offset:3328
    s_waitcnt lgkmcnt(0)
    s_add_u32 m0, s30, 0
    s_lshl4_add_u32 s36, s14, s20
    buffer_load_dwordx4 v2, s[32:35], s36 offen offset:0  lds
    s_add_u32 m0, s30, 0
    s_lshl4_add_u32 s36, s14, s20
    buffer_load_dwordx4 v3, s[32:35], s36 offen offset:1024  lds
    s_add_u32 m0, s30, 0
    s_lshl4_add_u32 s36, s14, s20
    buffer_load_dwordx4 v4, s[32:35], s36 offen offset:2048  lds
    s_add_u32 m0, s30, 0
    s_lshl4_add_u32 s36, s14, s20
    buffer_load_dwordx4 v5, s[32:35], s36 offen offset:3072  lds
    v_fma_f32 v133, v192, v53, v133
    v_fma_f32 v134, v192, v54, v134
    v_fma_f32 v135, v192, v55, v135
    v_cvt_pk_bf16_f32 v48, v128, v129
    v_mfma_f32_32x32x16_bf16 v[64:79], v[108:111], a[236:239], v[64:79]
    v_xor_b32 v12, 20480, v18
    ds_read_b64_tr_b16 v[96:97], v12 offset:0
    ds_read_b64_tr_b16 v[98:99], v12 offset:256
    v_cvt_pk_bf16_f32 v49, v130, v131
    v_cvt_pk_bf16_f32 v50, v132, v133
    v_cvt_pk_bf16_f32 v51, v134, v135
    v_pk_max_i16 v48, v48, 0
    v_mfma_f32_32x32x16_bf16 v[64:79], v[80:83], a[240:243], v[64:79]
    ds_read_b64_tr_b16 v[100:101], v12 offset:1024
    ds_read_b64_tr_b16 v[102:103], v12 offset:1280
    v_pk_max_i16 v49, v49, 0
    v_pk_max_i16 v50, v50, 0
    v_pk_max_i16 v51, v51, 0
    s_waitcnt vmcnt(10)
    ds_read_b64_tr_b16 a[64:65], v9 offset:16384
    v_mfma_f32_32x32x16_bf16 v[64:79], v[84:87], a[244:247], v[64:79]
    ds_read_b64_tr_b16 v[104:105], v12 offset:2048
    ds_read_b64_tr_b16 v[106:107], v12 offset:2304
    ds_read_b64_tr_b16 a[66:67], v9 offset:16640
    ds_read_b64_tr_b16 a[68:69], v9 offset:17408
    ds_read_b64_tr_b16 a[70:71], v9 offset:17664
    ds_read_b64_tr_b16 a[72:73], v9 offset:18432
    v_mfma_f32_32x32x16_bf16 v[64:79], v[88:91], a[248:251], v[64:79]
    ds_read_b64_tr_b16 v[108:109], v12 offset:3072
    ds_read_b64_tr_b16 v[110:111], v12 offset:3328
    buffer_store_dwordx4 v[48:51], v1, s[4:7], s40 offen offset:2048 sc1
    v_fma_f32 v136, v192, v56, v136
    v_mfma_f32_32x32x16_bf16 v[64:79], v[92:95], a[252:255], v[64:79]
    v_xor_b32 v11, 24576, v18
    ds_read_b64_tr_b16 v[80:81], v11 offset:0
    ds_read_b64_tr_b16 v[82:83], v11 offset:256
    v_fma_f32 v137, v192, v57, v137
    v_fma_f32 v138, v192, v58, v138
    v_fma_f32 v139, v192, v59, v139
    v_fma_f32 v140, v192, v60, v140
    s_waitcnt lgkmcnt(13)
    v_mfma_f32_32x32x16_bf16 v[64:79], v[96:99], v[208:211], v[64:79]
    ds_read_b64_tr_b16 v[84:85], v11 offset:1024
    ds_read_b64_tr_b16 v[86:87], v11 offset:1280
    v_fma_f32 v141, v192, v61, v141
    v_fma_f32 v142, v192, v62, v142
    v_fma_f32 v143, v192, v63, v143
    v_cvt_pk_bf16_f32 v52, v136, v137
    s_waitcnt lgkmcnt(13)
    v_mfma_f32_32x32x16_bf16 v[64:79], v[100:103], v[212:215], v[64:79]
    ds_read_b64_tr_b16 v[88:89], v11 offset:2048
    ds_read_b64_tr_b16 v[90:91], v11 offset:2304
    v_cvt_pk_bf16_f32 v53, v138, v139
    v_cvt_pk_bf16_f32 v54, v140, v141
    v_cvt_pk_bf16_f32 v55, v142, v143
    v_pk_max_i16 v52, v52, 0
    s_waitcnt lgkmcnt(12)
    v_mfma_f32_32x32x16_bf16 v[64:79], v[104:107], v[216:219], v[64:79]
    ds_read_b64_tr_b16 v[92:93], v11 offset:3072
    ds_read_b64_tr_b16 v[94:95], v11 offset:3328
    v_pk_max_i16 v53, v53, 0
    v_pk_max_i16 v54, v54, 0
    v_pk_max_i16 v55, v55, 0
    ds_read_b64_tr_b16 a[74:75], v9 offset:18688
    s_waitcnt lgkmcnt(9)
    v_mfma_f32_32x32x16_bf16 v[64:79], v[108:111], v[220:223], v[64:79]
    v_xor_b32 v12, 28672, v18
    ds_read_b64_tr_b16 v[96:97], v12 offset:0
    ds_read_b64_tr_b16 v[98:99], v12 offset:256
    ds_read_b64_tr_b16 a[76:77], v9 offset:19456
    ds_read_b64_tr_b16 a[78:79], v9 offset:19712
    s_waitcnt lgkmcnt(11)
    v_mfma_f32_32x32x16_bf16 v[64:79], v[80:83], v[224:227], v[64:79]
    ds_read_b64_tr_b16 v[100:101], v12 offset:1024
    ds_read_b64_tr_b16 v[102:103], v12 offset:1280
    buffer_store_dwordx4 v[52:55], v1, s[4:7], s40 offen offset:3072 sc1
    s_waitcnt lgkmcnt(11)
    v_mfma_f32_32x32x16_bf16 v[64:79], v[84:87], v[228:231], v[64:79]
    ds_read_b64_tr_b16 v[104:105], v12 offset:2048
    ds_read_b64_tr_b16 v[106:107], v12 offset:2304
    s_waitcnt lgkmcnt(11)
    v_mfma_f32_32x32x16_bf16 v[64:79], v[88:91], v[232:235], v[64:79]
    ds_read_b64_tr_b16 v[108:109], v12 offset:3072
    ds_read_b64_tr_b16 v[110:111], v12 offset:3328
    s_waitcnt lgkmcnt(6)
    s_add_u32 m0, s30, 16384
    s_lshl4_add_u32 s36, s15, s20
    buffer_load_dwordx4 v2, s[32:35], s36 offen offset:0  lds
    v_mfma_f32_32x32x16_bf16 v[64:79], v[92:95], v[236:239], v[64:79]
    v_mfma_f32_32x32x16_bf16 v[64:79], v[96:99], v[240:243], v[64:79]
    s_add_u32 m0, s30, 16384
    s_lshl4_add_u32 s36, s15, s20
    buffer_load_dwordx4 v3, s[32:35], s36 offen offset:1024  lds
    s_waitcnt lgkmcnt(4)
    v_mfma_f32_32x32x16_bf16 v[64:79], v[100:103], v[244:247], v[64:79]
    s_waitcnt lgkmcnt(2)
    v_mfma_f32_32x32x16_bf16 v[64:79], v[104:107], v[248:251], v[64:79]
    s_add_u32 m0, s30, 16384
    s_lshl4_add_u32 s36, s15, s20
    buffer_load_dwordx4 v4, s[32:35], s36 offen offset:2048  lds
    s_waitcnt lgkmcnt(0)
    v_mfma_f32_32x32x16_bf16 v[64:79], v[108:111], v[252:255], v[64:79]
    s_nop 11
    v_fma_f32 v144, v192, v64, v144
    v_fma_f32 v145, v192, v65, v145
    v_fma_f32 v146, v192, v66, v146
    v_fma_f32 v147, v192, v67, v147
    v_fma_f32 v148, v192, v68, v148
    v_fma_f32 v149, v192, v69, v149
    v_fma_f32 v150, v192, v70, v150
    v_fma_f32 v151, v192, v71, v151
    v_cvt_pk_bf16_f32 v64, v144, v145
    v_cvt_pk_bf16_f32 v65, v146, v147
    v_cvt_pk_bf16_f32 v66, v148, v149
    v_cvt_pk_bf16_f32 v67, v150, v151
    v_pk_max_i16 v64, v64, 0
    v_pk_max_i16 v65, v65, 0
    v_pk_max_i16 v66, v66, 0
    v_pk_max_i16 v67, v67, 0
    buffer_store_dwordx4 v[64:67], v1, s[4:7], s41 offen offset:0 sc1
    v_fma_f32 v152, v192, v72, v152
    v_fma_f32 v153, v192, v73, v153
    v_fma_f32 v154, v192, v74, v154
    v_fma_f32 v155, v192, v75, v155
    v_fma_f32 v156, v192, v76, v156
    v_fma_f32 v157, v192, v77, v157
    v_fma_f32 v158, v192, v78, v158
    v_fma_f32 v159, v192, v79, v159
    v_cvt_pk_bf16_f32 v68, v152, v153
    v_cvt_pk_bf16_f32 v69, v154, v155
    v_cvt_pk_bf16_f32 v70, v156, v157
    v_cvt_pk_bf16_f32 v71, v158, v159
    v_pk_max_i16 v68, v68, 0
    v_pk_max_i16 v69, v69, 0
    v_pk_max_i16 v70, v70, 0
    v_pk_max_i16 v71, v71, 0
    buffer_store_dwordx4 v[68:71], v1, s[4:7], s41 offen offset:1024 sc1
    s_add_u32 m0, s30, 16384
    s_lshl4_add_u32 s36, s15, s20
    buffer_load_dwordx4 v5, s[32:35], s36 offen offset:3072  lds
    s_waitcnt vmcnt(6)
    s_mov_b64 exec, 1
    buffer_store_dword v30, v29, s[4:7], s42 offen offset:0 sc1
    s_mov_b64 exec, -1
    s_barrier
    ds_read_b64_tr_b16 a[80:81], v9 offset:32768
    ds_read_b64_tr_b16 a[82:83], v9 offset:33024
    ds_read_b64_tr_b16 a[84:85], v9 offset:33792
    ds_read_b64_tr_b16 a[86:87], v9 offset:34048
    ds_read_b64_tr_b16 a[88:89], v9 offset:34816
    ds_read_b64_tr_b16 a[90:91], v9 offset:35072
    ds_read_b64_tr_b16 a[92:93], v9 offset:35840
    ds_read_b64_tr_b16 a[94:95], v9 offset:36096
    s_waitcnt lgkmcnt(0)
    s_add_u32 m0, s30, 32768
    s_lshl4_add_u32 s36, s26, s20
    buffer_load_dwordx4 v2, s[32:35], s36 offen offset:0  lds
    s_add_u32 m0, s30, 32768
    s_lshl4_add_u32 s36, s26, s20
    buffer_load_dwordx4 v3, s[32:35], s36 offen offset:1024  lds
    s_add_u32 m0, s30, 32768
    s_lshl4_add_u32 s36, s26, s20
    s_add_u32 s36, s36, 65536
    buffer_load_dwordx4 v4, s[32:35], s36 offen offset:2048  lds
    s_add_u32 m0, s30, 32768
    s_lshl4_add_u32 s36, s26, s20
    s_add_u32 s36, s36, 65536
    buffer_load_dwordx4 v5, s[32:35], s36 offen offset:3072  lds
    ds_read_b64_tr_b16 a[96:97], v9 offset:0
    ds_read_b64_tr_b16 a[98:99], v9 offset:256
    ds_read_b64_tr_b16 a[100:101], v9 offset:1024
    ds_read_b64_tr_b16 a[102:103], v9 offset:1280
    ds_read_b64_tr_b16 a[104:105], v9 offset:2048
    ds_read_b64_tr_b16 a[106:107], v9 offset:2304
    ds_read_b64_tr_b16 a[108:109], v9 offset:3072
    ds_read_b64_tr_b16 a[110:111], v9 offset:3328
    s_waitcnt lgkmcnt(0)
    s_add_u32 m0, s30, 0
    s_lshl4_add_u32 s36, s27, s20
    buffer_load_dwordx4 v2, s[32:35], s36 offen offset:0  lds
    s_add_u32 m0, s30, 0
    s_lshl4_add_u32 s36, s27, s20
    buffer_load_dwordx4 v3, s[32:35], s36 offen offset:1024  lds
    s_add_u32 m0, s30, 0
    s_lshl4_add_u32 s36, s27, s20
    s_add_u32 s36, s36, 65536
    buffer_load_dwordx4 v4, s[32:35], s36 offen offset:2048  lds
    s_add_u32 m0, s30, 0
    s_lshl4_add_u32 s36, s27, s20
    s_add_u32 s36, s36, 65536
    buffer_load_dwordx4 v5, s[32:35], s36 offen offset:3072  lds
    s_waitcnt vmcnt(9)
    ds_read_b64_tr_b16 a[112:113], v9 offset:16384
    ds_read_b64_tr_b16 a[114:115], v9 offset:16640
    ds_read_b64_tr_b16 a[116:117], v9 offset:17408
    ds_read_b64_tr_b16 a[118:119], v9 offset:17664
    ds_read_b64_tr_b16 a[120:121], v9 offset:18432
    ds_read_b64_tr_b16 a[122:123], v9 offset:18688
    ds_read_b64_tr_b16 a[124:125], v9 offset:19456
    ds_read_b64_tr_b16 a[126:127], v9 offset:19712
    s_waitcnt lgkmcnt(0)
    s_add_u32 m0, s30, 16384
    s_lshl4_add_u32 s36, s28, s20
    buffer_load_dwordx4 v2, s[32:35], s36 offen offset:0  lds
    s_add_u32 m0, s30, 16384
    s_lshl4_add_u32 s36, s28, s20
    buffer_load_dwordx4 v3, s[32:35], s36 offen offset:1024  lds
    s_add_u32 m0, s30, 16384
    s_lshl4_add_u32 s36, s28, s20
    s_add_u32 s36, s36, 65536
    buffer_load_dwordx4 v4, s[32:35], s36 offen offset:2048  lds
    s_add_u32 m0, s30, 16384
    s_lshl4_add_u32 s36, s28, s20
    s_add_u32 s36, s36, 65536
    buffer_load_dwordx4 v5, s[32:35], s36 offen offset:3072  lds
    s_mov_b64 exec, 1
    buffer_store_dword v30, v29, s[4:7], s42 offen offset:128 sc1
    s_mov_b64 exec, -1
    ds_read_b128 v[176:179], v25 offset:0
    ds_read_b128 v[180:183], v25 offset:32
    v_mov_b32 v115, v30
    v_mov_b32 v119, v30
    v_mov_b32 v123, v30
    v_mov_b32 v122, 0
    s_load_dwordx16 s[84:99], s[4:5], s47 glc
    s_waitcnt vmcnt(9)
    ds_read_b64_tr_b16 a[128:129], v9 offset:32768
    ds_read_b64_tr_b16 a[130:131], v9 offset:33024
    ds_read_b64_tr_b16 a[132:133], v9 offset:33792
    ds_read_b64_tr_b16 a[134:135], v9 offset:34048
    ds_read_b64_tr_b16 a[136:137], v9 offset:34816
    ds_read_b64_tr_b16 a[138:139], v9 offset:35072
    ds_read_b64_tr_b16 a[140:141], v9 offset:35840
    ds_read_b64_tr_b16 a[142:143], v9 offset:36096
    s_waitcnt lgkmcnt(8)
    v_lshlrev_b32 v144, 16, v176
    v_and_b32 v145, 0xffff0000, v176
    v_lshlrev_b32 v146, 16, v177
    v_and_b32 v147, 0xffff0000, v177
    v_lshlrev_b32 v148, 16, v178
    v_and_b32 v149, 0xffff0000, v178
    v_lshlrev_b32 v150, 16, v179
    v_and_b32 v151, 0xffff0000, v179
    v_lshlrev_b32 v152, 16, v180
    v_and_b32 v153, 0xffff0000, v180
    v_lshlrev_b32 v154, 16, v181
    v_and_b32 v155, 0xffff0000, v181
    v_lshlrev_b32 v156, 16, v182
    v_and_b32 v157, 0xffff0000, v182
    v_lshlrev_b32 v158, 16, v183
    v_and_b32 v159, 0xffff0000, v183
    s_waitcnt lgkmcnt(0)
    s_mov_b32 s25, s24
    s_mov_b32 s39, 20000
    s_xor_b64 s[84:85], s[84:85], s[24:25]
    s_xor_b64 s[86:87], s[86:87], s[24:25]
    s_xor_b64 s[88:89], s[88:89], s[24:25]
    s_xor_b64 s[90:91], s[90:91], s[24:25]
    s_xor_b64 s[92:93], s[92:93], s[24:25]
    s_xor_b64 s[94:95], s[94:95], s[24:25]
    s_xor_b64 s[96:97], s[96:97], s[24:25]
    s_xor_b64 s[98:99], s[98:99], s[24:25]
    s_or_b64 s[84:85], s[84:85], s[92:93]
    s_or_b64 s[86:87], s[86:87], s[94:95]
    s_or_b64 s[88:89], s[88:89], s[96:97]
    s_or_b64 s[90:91], s[90:91], s[98:99]
    s_or_b64 s[84:85], s[84:85], s[88:89]
    s_or_b64 s[86:87], s[86:87], s[90:91]
    s_or_b64 s[84:85], s[84:85], s[86:87]
    s_cbranch_scc0 FHD_37
    s_load_dwordx16 s[56:71], s[4:5], s47 glc
FH_36:
    s_waitcnt lgkmcnt(0)
    s_xor_b64 s[56:57], s[56:57], s[24:25]
    s_xor_b64 s[58:59], s[58:59], s[24:25]
    s_xor_b64 s[60:61], s[60:61], s[24:25]
    s_xor_b64 s[62:63], s[62:63], s[24:25]
    s_xor_b64 s[64:65], s[64:65], s[24:25]
    s_xor_b64 s[66:67], s[66:67], s[24:25]
    s_xor_b64 s[68:69], s[68:69], s[24:25]
    s_xor_b64 s[70:71], s[70:71], s[24:25]
    s_or_b64 s[56:57], s[56:57], s[64:65]
    s_or_b64 s[58:59], s[58:59], s[66:67]
    s_or_b64 s[60:61], s[60:61], s[68:69]
    s_or_b64 s[62:63], s[62:63], s[70:71]
    s_or_b64 s[56:57], s[56:57], s[60:61]
    s_or_b64 s[58:59], s[58:59], s[62:63]
    s_or_b64 s[56:57], s[56:57], s[58:59]
    s_cbranch_scc0 FHD_37
    s_sleep 1
    s_load_dwordx16 s[56:71], s[4:5], s47 glc
    s_sub_u32 s39, s39, 1
    s_cmp_lg_u32 s39, 0
    s_cbranch_scc1 FH_36
    s_waitcnt lgkmcnt(0)
FHD_37:
    s_add_u32 m0, s54, 0
    s_add_u32 s36, s43, s8
    buffer_load_dwordx4 v1, s[4:7], s36 offen sc1 lds
    s_add_u32 m0, s54, 4096
    s_add_u32 s36, s43, s9
    buffer_load_dwordx4 v1, s[4:7], s36 offen sc1 lds
    s_add_u32 m0, s54, 8192
    s_add_u32 s36, s43, s10
    buffer_load_dwordx4 v1, s[4:7], s36 offen sc1 lds
    s_add_u32 m0, s54, 12288
    s_add_u32 s36, s43, s11
    buffer_load_dwordx4 v1, s[4:7], s36 offen sc1 lds
    s_add_u32 m0, s54, 16384
    s_add_u32 s36, s43, s12
    buffer_load_dwordx4 v1, s[4:7], s36 offen sc1 lds
    s_add_u32 m0, s54, 20480
    s_add_u32 s36, s43, s13
    buffer_load_dwordx4 v1, s[4:7], s36 offen sc1 lds
    s_add_u32 m0, s54, 24576
    s_add_u32 s36, s43, s14
    buffer_load_dwordx4 v1, s[4:7], s36 offen sc1 lds
    s_add_u32 m0, s54, 28672
    s_add_u32 s36, s43, s15
    buffer_load_dwordx4 v1, s[4:7], s36 offen sc1 lds
    s_waitcnt vmcnt(6)
    s_barrier
    ds_read_b128 v[80:83], v23 offset:0
    ds_read_b128 v[84:87], v23 offset:1024
    ds_read_b128 v[88:91], v23 offset:2048
    ds_read_b128 v[92:95], v23 offset:3072
    ds_read_b128 v[96:99], v23 offset:4096
    ds_read_b128 v[100:103], v23 offset:5120
    s_waitcnt lgkmcnt(5)
    v_mfma_f32_32x32x16_bf16 v[32:47], a[0:3], v[80:83], 0
    ds_read_b128 v[104:107], v23 offset:6144
    s_add_u32 m0, s54, 45056
    s_add_u32 s36, s44, s8
    buffer_load_dwordx4 v1, s[4:7], s36 offen sc1 lds
    ds_read_b64_tr_b16 a[144:145], v9 offset:0
    s_waitcnt lgkmcnt(6)
    v_mfma_f32_32x32x16_bf16 v[32:47], a[4:7], v[84:87], v[32:47]
    ds_read_b128 v[108:111], v23 offset:7168
    ds_read_b64_tr_b16 a[146:147], v9 offset:256
    ds_read_b64_tr_b16 a[148:149], v9 offset:1024
    ds_read_b64_tr_b16 a[150:151], v9 offset:1280
    ds_read_b64_tr_b16 a[152:153], v9 offset:2048
    s_waitcnt lgkmcnt(10)
    v_mfma_f32_32x32x16_bf16 v[32:47], a[8:11], v[88:91], v[32:47]
    s_waitcnt vmcnt(5)
    s_barrier
    ds_read_b128 v[80:83], v23 offset:8192
    s_add_u32 m0, s54, 49152
    s_add_u32 s36, s44, s9
    buffer_load_dwordx4 v1, s[4:7], s36 offen sc1 lds
    ds_read_b64_tr_b16 a[154:155], v9 offset:2304
    s_waitcnt lgkmcnt(11)
    v_mfma_f32_32x32x16_bf16 v[32:47], a[12:15], v[92:95], v[32:47]
    ds_read_b128 v[84:87], v23 offset:9216
    ds_read_b64_tr_b16 a[156:157], v9 offset:3072
    ds_read_b64_tr_b16 a[158:159], v9 offset:3328
    ds_read_b64_tr_b16 a[160:161], v9 offset:16384
    ds_read_b64_tr_b16 a[162:163], v9 offset:16640
    s_waitcnt lgkmcnt(15)
    v_mfma_f32_32x32x16_bf16 v[32:47], a[16:19], v[96:99], v[32:47]
    ds_read_b128 v[88:91], v23 offset:10240
    buffer_load_dword v26, v10, s[4:7], s48 offen sc1
    ds_read_b64_tr_b16 a[164:165], v9 offset:17408
    s_waitcnt lgkmcnt(15)
    v_mfma_f32_32x32x16_bf16 v[32:47], a[20:23], v[100:103], v[32:47]
    ds_read_b128 v[92:95], v23 offset:11264
    ds_read_b64_tr_b16 a[166:167], v9 offset:17664
    ds_read_b64_tr_b16 a[168:169], v9 offset:18432
    ds_read_b64_tr_b16 a[170:171], v9 offset:18688
    ds_read_b64_tr_b16 a[172:173], v9 offset:19456
    v_mfma_f32_32x32x16_bf16 v[32:47], a[24:27], v[104:107], v[32:47]
    ds_read_b128 v[96:99], v23 offset:12288
    s_add_u32 m0, s54, 53248
    s_add_u32 s36, s44, s10
    buffer_load_dwordx4 v1, s[4:7], s36 offen sc1 lds
    ds_read_b64_tr_b16 a[174:175], v9 offset:19712
    s_waitcnt lgkmcnt(15)
    v_mfma_f32_32x32x16_bf16 v[32:47], a[28:31], v[108:111], v[32:47]
    ds_read_b128 v[100:103], v23 offset:13312
    v_mfma_f32_32x32x16_bf16 v[32:47], a[32:35], v[80:83], v[32:47]
    ds_read_b128 v[104:107], v23 offset:14336
    s_add_u32 m0, s54, 57344
    s_add_u32 s36, s44, s11
    buffer_load_dwordx4 v1, s[4:7], s36 offen sc1 lds
    s_waitcnt lgkmcnt(15)
    v_mfma_f32_32x32x16_bf16 v[32:47], a[36:39], v[84:87], v[32:47]
    ds_read_b128 v[108:111], v23 offset:15360
    s_waitcnt lgkmcnt(11)
    v_mfma_f32_32x32x16_bf16 v[32:47], a[40:43], v[88:91], v[32:47]
    s_waitcnt vmcnt(5)
    s_barrier
    ds_read_b128 v[80:83], v23 offset:16384
    s_add_u32 m0, s54, 61440
    s_add_u32 s36, s44, s12
    buffer_load_dwordx4 v1, s[4:7], s36 offen sc1 lds
    s_waitcnt lgkmcnt(10)
    v_mfma_f32_32x32x16_bf16 v[32:47], a[44:47], v[92:95], v[32:47]
    ds_read_b128 v[84:87], v23 offset:17408
    s_waitcnt lgkmcnt(6)
    v_mfma_f32_32x32x16_bf16 v[32:47], a[48:51], v[96:99], v[32:47]
    ds_read_b128 v[88:91], v23 offset:18432
    s_add_u32 m0, s54, 65536
    s_add_u32 s36, s44, s13
    buffer_load_dwordx4 v1, s[4:7], s36 offen sc1 lds
    s_waitcnt lgkmcnt(5)
    v_mfma_f32_32x32x16_bf16 v[32:47], a[52:55], v[100:103], v[32:47]
    ds_read_b128 v[92:95], v23 offset:19456
    s_waitcnt lgkmcnt(5)
    v_mfma_f32_32x32x16_bf16 v[32:47], a[56:59], v[104:107], v[32:47]
    ds_read_b128 v[96:99], v23 offset:20480
    s_add_u32 m0, s54, 69632
    s_add_u32 s36, s44, s14
    buffer_load_dwordx4 v1, s[4:7], s36 offen sc1 lds
    s_waitcnt vmcnt(5)
    v_cmp_ne_u32 vcc, v30, v26
    s_nop 3
    s_cbranch_vccnz FI_38
FID_39:
    s_waitcnt lgkmcnt(5)
    v_mfma_f32_32x32x16_bf16 v[32:47], a[60:63], v[108:111], v[32:47]
    ds_read_b128 v[100:103], v23 offset:21504
    s_add_u32 m0, s54, 32768
    s_add_u32 s36, s45, s26
    buffer_load_dwordx4 v1, s[4:7], s36 offen sc1 lds
    s_waitcnt lgkmcnt(5)
    v_mfma_f32_32x32x16_bf16 v[32:47], a[64:67], v[80:83], v[32:47]
    ds_read_b128 v[104:107], v23 offset:22528
    s_add_u32 m0, s54, 36864
    s_add_u32 s36, s45, s27
    buffer_load_dwordx4 v1, s[4:7], s36 offen sc1 lds
    s_waitcnt lgkmcnt(5)
    v_mfma_f32_32x32x16_bf16 v[32:47], a[68:71], v[84:87], v[32:47]
    ds_read_b128 v[108:111], v23 offset:23552
    s_add_u32 m0, s54, 40960
    s_add_u32 s36, s45, s28
    buffer_load_dwordx4 v1, s[4:7], s36 offen sc1 lds
    s_waitcnt lgkmcnt(5)
    v_mfma_f32_32x32x16_bf16 v[32:47], a[72:75], v[88:91], v[32:47]
    ds_read_b128 v[80:83], v23 offset:24576
    s_add_u32 m0, s54, 73728
    s_add_u32 s36, s44, s15
    buffer_load_dwordx4 v1, s[4:7], s36 offen sc1 lds
    s_waitcnt lgkmcnt(5)
    v_mfma_f32_32x32x16_bf16 v[32:47], a[76:79], v[92:95], v[32:47]
    ds_read_b128 v[84:87], v23 offset:25600
    s_waitcnt lgkmcnt(5)
    v_mfma_f32_32x32x16_bf16 v[32:47], a[80:83], v[96:99], v[32:47]
    ds_read_b128 v[88:91], v23 offset:26624
    s_add_u32 m0, s54, 77824
    s_add_u32 s36, s46, s26
    buffer_load_dwordx4 v1, s[4:7], s36 offen sc1 lds
    s_waitcnt lgkmcnt(5)
    v_mfma_f32_32x32x16_bf16 v[32:47], a[84:87], v[100:103], v[32:47]
    ds_read_b128 v[92:95], v23 offset:27648
    s_waitcnt lgkmcnt(5)
    v_mfma_f32_32x32x16_bf16 v[32:47], a[88:91], v[104:107], v[32:47]
    ds_read_b128 v[96:99], v23 offset:28672
    s_add_u32 m0, s54, 81920
    s_add_u32 s36, s46, s27
    buffer_load_dwordx4 v1, s[4:7], s36 offen sc1 lds
    s_waitcnt lgkmcnt(5)
    v_mfma_f32_32x32x16_bf16 v[32:47], a[92:95], v[108:111], v[32:47]
    ds_read_b128 v[100:103], v23 offset:29696
    s_waitcnt lgkmcnt(5)
    v_mfma_f32_32x32x16_bf16 v[32:47], a[96:99], v[80:83], v[32:47]
    ds_read_b128 v[104:107], v23 offset:30720
    s_add_u32 m0, s54, 86016
    s_add_u32 s36, s46, s28
    buffer_load_dwordx4 v1, s[4:7], s36 offen sc1 lds
    s_waitcnt lgkmcnt(5)
    v_mfma_f32_32x32x16_bf16 v[32:47], a[100:103], v[84:87], v[32:47]
    ds_read_b128 v[108:111], v23 offset:31744
    s_waitcnt lgkmcnt(5)
    v_mfma_f32_32x32x16_bf16 v[32:47], a[104:107], v[88:91], v[32:47]
    s_waitcnt vmcnt(4)
    s_barrier
    ds_read_b128 v[80:83], v23 offset:32768
    buffer_load_dwordx4 v[136:139], v1, s[4:7], s52 offen offset:0 sc1
    s_waitcnt lgkmcnt(5)
    v_mfma_f32_32x32x16_bf16 v[32:47], a[108:111], v[92:95], v[32:47]
    ds_read_b128 v[84:87], v23 offset:33792
    s_waitcnt lgkmcnt(5)
    v_mfma_f32_32x32x16_bf16 v[32:47], a[112:115], v[96:99], v[32:47]
    ds_read_b128 v[88:91], v23 offset:34816
    buffer_load_dwordx4 v[140:143], v1, s[4:7], s52 offen offset:1024 sc1
    s_waitcnt lgkmcnt(5)
    v_mfma_f32_32x32x16_bf16 v[32:47], a[116:119], v[100:103], v[32:47]
    ds_read_b128 v[92:95], v23 offset:35840
    s_waitcnt lgkmcnt(5)
    v_mfma_f32_32x32x16_bf16 v[32:47], a[120:123], v[104:107], v[32:47]
    ds_read_b128 v[96:99], v23 offset:36864
    s_waitcnt lgkmcnt(5)
    v_mfma_f32_32x32x16_bf16 v[32:47], a[124:127], v[108:111], v[32:47]
    ds_read_b128 v[100:103], v23 offset:37888
    s_waitcnt lgkmcnt(5)
    v_mfma_f32_32x32x16_bf16 v[32:47], a[128:131], v[80:83], v[32:47]
    ds_read_b128 v[104:107], v23 offset:38912
    s_waitcnt lgkmcnt(5)
    v_mfma_f32_32x32x16_bf16 v[32:47], a[132:135], v[84:87], v[32:47]
    ds_read_b128 v[108:111], v23 offset:39936
    s_waitcnt lgkmcnt(5)
    v_mfma_f32_32x32x16_bf16 v[32:47], a[136:139], v[88:91], v[32:47]
    ds_read_b128 v[80:83], v23 offset:40960
    s_waitcnt lgkmcnt(5)
    v_mfma_f32_32x32x16_bf16 v[32:47], a[140:143], v[92:95], v[32:47]
    ds_read_b128 v[84:87], v23 offset:41984
    s_waitcnt lgkmcnt(5)
    v_mfma_f32_32x32x16_bf16 v[32:47], a[144:147], v[96:99], v[32:47]
    ds_read_b128 v[88:91], v23 offset:43008
    s_waitcnt lgkmcnt(5)
    v_mfma_f32_32x32x16_bf16 v[32:47], a[148:151], v[100:103], v[32:47]
    ds_read_b128 v[92:95], v23 offset:44032
    s_waitcnt lgkmcnt(5)
    v_mfma_f32_32x32x16_bf16 v[32:47], a[152:155], v[104:107], v[32:47]
    s_barrier
    ds_read_b128 v[96:99], v24 offset:0
    s_waitcnt lgkmcnt(5)
    v_mfma_f32_32x32x16_bf16 v[32:47], a[156:159], v[108:111], v[32:47]
    ds_read_b128 v[100:103], v24 offset:1024
    s_waitcnt lgkmcnt(5)
    v_mfma_f32_32x32x16_bf16 v[32:47], a[160:163], v[80:83], v[32:47]
    ds_read_b128 v[104:107], v24 offset:2048
    s_waitcnt lgkmcnt(5)
    v_mfma_f32_32x32x16_bf16 v[32:47], a[164:167], v[84:87], v[32:47]
    ds_read_b128 v[108:111], v24 offset:3072
    s_waitcnt lgkmcnt(5)
    v_mfma_f32_32x32x16_bf16 v[32:47], a[168:171], v[88:91], v[32:47]
    ds_read_b128 v[80:83], v24 offset:4096
    s_waitcnt lgkmcnt(5)
    v_mfma_f32_32x32x16_bf16 v[32:47], a[172:175], v[92:95], v[32:47]
    ds_read_b128 v[84:87], v24 offset:5120
    s_waitcnt lgkmcnt(5)
    v_mfma_f32_32x32x16_bf16 v[48:63], a[0:3], v[96:99], 0
    ds_read_b128 v[88:91], v24 offset:6144
    s_waitcnt lgkmcnt(5)
    v_mfma_f32_32x32x16_bf16 v[48:63], a[4:7], v[100:103], v[48:63]
    ds_read_b128 v[92:95], v24 offset:7168
    s_nop 4
    v_cvt_pk_bf16_f32 v112, v32, v33
    v_cvt_pk_bf16_f32 v113, v34, v35
    v_cvt_pk_bf16_f32 v114, v36, v37
    v_cvt_pk_bf16_f32 v116, v38, v39
    s_waitcnt lgkmcnt(5)
    v_mfma_f32_32x32x16_bf16 v[48:63], a[8:11], v[104:107], v[48:63]
    ds_read_b128 v[96:99], v24 offset:8192
    v_cvt_pk_bf16_f32 v117, v40, v41
    v_cvt_pk_bf16_f32 v118, v42, v43
    v_cvt_pk_bf16_f32 v120, v44, v45
    v_cvt_pk_bf16_f32 v121, v46, v47
    s_waitcnt lgkmcnt(5)
    v_mfma_f32_32x32x16_bf16 v[48:63], a[12:15], v[108:111], v[48:63]
    ds_read_b128 v[100:103], v24 offset:9216
    buffer_store_dwordx4 v[112:115], v1, s[4:7], s49 offen offset:0 sc1
    s_waitcnt lgkmcnt(5)
    v_mfma_f32_32x32x16_bf16 v[48:63], a[16:19], v[80:83], v[48:63]
    ds_read_b128 v[104:107], v24 offset:10240
    buffer_store_dwordx4 v[116:119], v1, s[4:7], s49 offen offset:1024 sc1
    s_waitcnt lgkmcnt(5)
    v_mfma_f32_32x32x16_bf16 v[48:63], a[20:23], v[84:87], v[48:63]
    ds_read_b128 v[108:111], v24 offset:11264
    buffer_store_dwordx4 v[120:123], v1, s[4:7], s49 offen offset:2048 sc1
    s_waitcnt lgkmcnt(5)
    v_mfma_f32_32x32x16_bf16 v[48:63], a[24:27], v[88:91], v[48:63]
    ds_read_b128 v[80:83], v24 offset:12288
    s_waitcnt lgkmcnt(5)
    v_mfma_f32_32x32x16_bf16 v[48:63], a[28:31], v[92:95], v[48:63]
    ds_read_b128 v[84:87], v24 offset:13312
    s_waitcnt lgkmcnt(5)
    v_mfma_f32_32x32x16_bf16 v[48:63], a[32:35], v[96:99], v[48:63]
    ds_read_b128 v[88:91], v24 offset:14336
    s_waitcnt lgkmcnt(5)
    v_mfma_f32_32x32x16_bf16 v[48:63], a[36:39], v[100:103], v[48:63]
    ds_read_b128 v[92:95], v24 offset:15360
    s_waitcnt lgkmcnt(5)
    v_mfma_f32_32x32x16_bf16 v[48:63], a[40:43], v[104:107], v[48:63]
    ds_read_b128 v[96:99], v24 offset:16384
    s_waitcnt lgkmcnt(5)
    v_mfma_f32_32x32x16_bf16 v[48:63], a[44:47], v[108:111], v[48:63]
    ds_read_b128 v[100:103], v24 offset:17408
    s_waitcnt lgkmcnt(5)
    v_mfma_f32_32x32x16_bf16 v[48:63], a[48:51], v[80:83], v[48:63]
    ds_read_b128 v[104:107], v24 offset:18432
    s_waitcnt lgkmcnt(5)
    v_mfma_f32_32x32x16_bf16 v[48:63], a[52:55], v[84:87], v[48:63]
    ds_read_b128 v[108:111], v24 offset:19456
    s_waitcnt lgkmcnt(5)
    v_mfma_f32_32x32x16_bf16 v[48:63], a[56:59], v[88:91], v[48:63]
    ds_read_b128 v[80:83], v24 offset:20480
    s_waitcnt lgkmcnt(5)
    v_mfma_f32_32x32x16_bf16 v[48:63], a[60:63], v[92:95], v[48:63]
    ds_read_b128 v[84:87], v24 offset:21504
    s_waitcnt lgkmcnt(5)
    v_mfma_f32_32x32x16_bf16 v[48:63], a[64:67], v[96:99], v[48:63]
    ds_read_b128 v[88:91], v24 offset:22528
    s_waitcnt vmcnt(3)
    v_lshlrev_b32 v160, 16, v136
    v_and_b32 v161, 0xffff0000, v136
    v_lshlrev_b32 v162, 16, v137
    s_waitcnt lgkmcnt(5)
    v_mfma_f32_32x32x16_bf16 v[48:63], a[68:71], v[100:103], v[48:63]
    ds_read_b128 v[92:95], v24 offset:23552
    v_and_b32 v163, 0xffff0000, v137
    v_lshlrev_b32 v164, 16, v138
    v_and_b32 v165, 0xffff0000, v138
    v_lshlrev_b32 v166, 16, v139
    s_waitcnt lgkmcnt(5)
    v_mfma_f32_32x32x16_bf16 v[48:63], a[72:75], v[104:107], v[48:63]
    s_barrier
    ds_read_b128 v[96:99], v24 offset:24576
    v_and_b32 v167, 0xffff0000, v139
    v_lshlrev_b32 v168, 16, v140
    v_and_b32 v169, 0xffff0000, v140
    v_lshlrev_b32 v170, 16, v141
    s_waitcnt lgkmcnt(5)
    v_mfma_f32_32x32x16_bf16 v[48:63], a[76:79], v[108:111], v[48:63]
    ds_read_b128 v[100:103], v24 offset:25600
    v_and_b32 v171, 0xffff0000, v141
    v_lshlrev_b32 v172, 16, v142
    v_and_b32 v173, 0xffff0000, v142
    v_lshlrev_b32 v174, 16, v143
    s_waitcnt lgkmcnt(5)
    v_mfma_f32_32x32x16_bf16 v[48:63], a[80:83], v[80:83], v[48:63]
    ds_read_b128 v[104:107], v24 offset:26624
    v_and_b32 v175, 0xffff0000, v143
    s_waitcnt lgkmcnt(5)
    v_mfma_f32_32x32x16_bf16 v[48:63], a[84:87], v[84:87], v[48:63]
    ds_read_b128 v[108:111], v24 offset:27648
    s_waitcnt lgkmcnt(5)
    v_mfma_f32_32x32x16_bf16 v[48:63], a[88:91], v[88:91], v[48:63]
    ds_read_b128 v[80:83], v24 offset:28672
    s_waitcnt lgkmcnt(5)
    v_mfma_f32_32x32x16_bf16 v[48:63], a[92:95], v[92:95], v[48:63]
    ds_read_b128 v[84:87], v24 offset:29696
    s_waitcnt lgkmcnt(5)
    v_mfma_f32_32x32x16_bf16 v[48:63], a[96:99], v[96:99], v[48:63]
    ds_read_b128 v[88:91], v24 offset:30720
    s_waitcnt lgkmcnt(5)
    v_mfma_f32_32x32x16_bf16 v[48:63], a[100:103], v[100:103], v[48:63]
    ds_read_b128 v[92:95], v24 offset:31744
    s_waitcnt lgkmcnt(5)
    v_mfma_f32_32x32x16_bf16 v[48:63], a[104:107], v[104:107], v[48:63]
    ds_read_b128 v[96:99], v24 offset:32768
    s_waitcnt lgkmcnt(5)
    v_mfma_f32_32x32x16_bf16 v[48:63], a[108:111], v[108:111], v[48:63]
    ds_read_b128 v[100:103], v24 offset:33792
    s_waitcnt lgkmcnt(5)
    v_mfma_f32_32x32x16_bf16 v[48:63], a[112:115], v[80:83], v[48:63]
    ds_read_b128 v[104:107], v24 offset:34816
    s_waitcnt lgkmcnt(5)
    v_mfma_f32_32x32x16_bf16 v[48:63], a[116:119], v[84:87], v[48:63]
    ds_read_b128 v[108:111], v24 offset:35840
    s_waitcnt lgkmcnt(5)
    v_mfma_f32_32x32x16_bf16 v[48:63], a[120:123], v[88:91], v[48:63]
    ds_read_b128 v[80:83], v24 offset:36864
    s_waitcnt lgkmcnt(5)
    v_mfma_f32_32x32x16_bf16 v[48:63], a[124:127], v[92:95], v[48:63]
    ds_read_b128 v[84:87], v24 offset:37888
    s_waitcnt lgkmcnt(5)
    v_mfma_f32_32x32x16_bf16 v[48:63], a[128:131], v[96:99], v[48:63]
    ds_read_b128 v[88:91], v24 offset:38912
    s_waitcnt lgkmcnt(5)
    v_mfma_f32_32x32x16_bf16 v[48:63], a[132:135], v[100:103], v[48:63]
    ds_read_b128 v[92:95], v24 offset:39936
    s_waitcnt lgkmcnt(5)
    v_mfma_f32_32x32x16_bf16 v[48:63], a[136:139], v[104:107], v[48:63]
    ds_read_b128 v[96:99], v24 offset:40960
    buffer_load_dwordx4 v[124:127], v1, s[4:7], s50 offen offset:0 sc1
    s_waitcnt lgkmcnt(5)
    v_mfma_f32_32x32x16_bf16 v[48:63], a[140:143], v[108:111], v[48:63]
    ds_read_b128 v[100:103], v24 offset:41984
    buffer_load_dwordx4 v[128:131], v1, s[4:7], s50 offen offset:1024 sc1
    s_waitcnt lgkmcnt(5)
    v_mfma_f32_32x32x16_bf16 v[48:63], a[144:147], v[80:83], v[48:63]
    ds_read_b128 v[104:107], v24 offset:43008
    buffer_load_dwordx4 v[132:135], v1, s[4:7], s50 offen offset:2048 sc1
    s_waitcnt lgkmcnt(5)
    v_mfma_f32_32x32x16_bf16 v[48:63], a[148:151], v[84:87], v[48:63]
    ds_read_b128 v[108:111], v24 offset:44032
    s_waitcnt lgkmcnt(5)
    v_mfma_f32_32x32x16_bf16 v[48:63], a[152:155], v[88:91], v[48:63]
    s_waitcnt lgkmcnt(4)
    v_mfma_f32_32x32x16_bf16 v[48:63], a[156:159], v[92:95], v[48:63]
    s_waitcnt lgkmcnt(3)
    v_mfma_f32_32x32x16_bf16 v[48:63], a[160:163], v[96:99], v[48:63]
    s_waitcnt lgkmcnt(2)
    v_mfma_f32_32x32x16_bf16 v[48:63], a[164:167], v[100:103], v[48:63]
    s_waitcnt lgkmcnt(1)
    v_mfma_f32_32x32x16_bf16 v[48:63], a[168:171], v[104:107], v[48:63]
    s_waitcnt lgkmcnt(0)
    v_mfma_f32_32x32x16_bf16 v[48:63], a[172:175], v[108:111], v[48:63]
    s_waitcnt vmcnt(0)
    v_xor_b32 v176, v30, v127
    v_xor_b32 v177, v30, v131
    v_xor_b32 v178, v30, v135
    v_or3_b32 v176, v176, v177, v178
    v_cmp_ne_u32 vcc, 0, v176
    s_nop 3
    s_cbranch_vccnz PJ_40
PJD_41:
    v_lshlrev_b32 v180, 16, v124
    v_and_b32 v181, 0xffff0000, v124
    v_fma_f32 v160, v180, v144, v160
    v_fma_f32 v161, v181, v145, v161
    v_lshlrev_b32 v182, 16, v125
    v_and_b32 v183, 0xffff0000, v125
    v_fma_f32 v162, v182, v146, v162
    v_fma_f32 v163, v183, v147, v163
    v_lshlrev_b32 v184, 16, v126
    v_and_b32 v185, 0xffff0000, v126
    v_fma_f32 v164, v184, v148, v164
    v_fma_f32 v165, v185, v149, v165
    v_lshlrev_b32 v186, 16, v128
    v_and_b32 v187, 0xffff0000, v128
    v_fma_f32 v166, v186, v150, v166
    v_fma_f32 v167, v187, v151, v167
    v_lshlrev_b32 v180, 16, v129
    v_and_b32 v181, 0xffff0000, v129
    v_fma_f32 v168, v180, v152, v168
    v_fma_f32 v169, v181, v153, v169
    v_lshlrev_b32 v182, 16, v130
    v_and_b32 v183, 0xffff0000, v130
    v_fma_f32 v170, v182, v154, v170
    v_fma_f32 v171, v183, v155, v171
    v_lshlrev_b32 v184, 16, v132
    v_and_b32 v185, 0xffff0000, v132
    v_fma_f32 v172, v184, v156, v172
    v_fma_f32 v173, v185, v157, v173
    v_lshlrev_b32 v186, 16, v133
    v_and_b32 v187, 0xffff0000, v133
    v_fma_f32 v174, v186, v158, v174
    v_fma_f32 v175, v187, v159, v175
    v_fma_f32 v160, v48, v144, v160
    v_fma_f32 v161, v49, v145, v161
    v_fma_f32 v162, v50, v146, v162
    v_fma_f32 v163, v51, v147, v163
    v_fma_f32 v164, v52, v148, v164
    v_fma_f32 v165, v53, v149, v165
    v_fma_f32 v166, v54, v150, v166
    v_fma_f32 v167, v55, v151, v167
    v_cvt_pk_bf16_f32 v136, v160, v161
    v_cvt_pk_bf16_f32 v137, v162, v163
    v_cvt_pk_bf16_f32 v138, v164, v165
    v_cvt_pk_bf16_f32 v139, v166, v167
    buffer_store_dwordx4 v[136:139], v7, s[16:19], s53 offen offset:0
    v_fma_f32 v168, v56, v152, v168
    v_fma_f32 v169, v57, v153, v169
    v_fma_f32 v170, v58, v154, v170
    v_fma_f32 v171, v59, v155, v171
    v_fma_f32 v172, v60, v156, v172
    v_fma_f32 v173, v61, v157, v173
    v_fma_f32 v174, v62, v158, v174
    v_fma_f32 v175, v63, v159, v175
    v_cvt_pk_bf16_f32 v140, v168, v169
    v_cvt_pk_bf16_f32 v141, v170, v171
    v_cvt_pk_bf16_f32 v142, v172, v173
    v_cvt_pk_bf16_f32 v143, v174, v175
    buffer_store_dwordx4 v[140:143], v7, s[16:19], s53 offen offset:32
K_END:
    s_endpgm
MG_3:
    s_mov_b32 s39, 20000
MG_3L:
    s_sleep 1
    buffer_load_dword v30, v29, s[32:35], 0 offen sc1
    buffer_load_dwordx4 v[32:35], v28, s[32:35], 0 offen sc1
    buffer_load_dwordx4 v[36:39], v1, s[4:7], s25 offen sc1
    s_add_u32 s36, s25, 12288
    buffer_load_dwordx4 v[40:43], v1, s[4:7], s36 offen sc1
    s_add_u32 s36, s36, 12288
    buffer_load_dwordx4 v[44:47], v1, s[4:7], s36 offen sc1
    s_add_u32 s36, s36, 12288
    buffer_load_dwordx4 v[48:51], v1, s[4:7], s36 offen sc1
    s_waitcnt vmcnt(0)
    v_xor_b32 v52, v32, v39
    v_xor_b32 v53, v33, v43
    v_xor_b32 v54, v34, v47
    v_xor_b32 v55, v35, v51
    v_and_b32 v56, v32, v33
    v_and_b32 v57, v34, v35
    v_or3_b32 v52, v52, v53, v54
    v_and_b32 v56, v56, v57
    v_and_b32 v56, v56, v30
    v_not_b32 v56, v56
    v_and_b32 v56, 1, v56
    v_or3_b32 v52, v52, v55, v56
    v_cmp_ne_u32 vcc, 0, v52
    s_sub_u32 s39, s39, 1
    s_nop 3
    s_cbranch_vccz MGD_4
    s_cmp_lg_u32 s39, 0
    s_cbranch_scc1 MG_3L
    s_branch MGD_4
LM_10:
    s_mov_b32 s39, 20000
LM_10L:
    s_sleep 1
    s_add_u32 s36, s54, 25694208
    buffer_load_dwordx4 v[140:143], v1, s[4:7], s36 offen offset:0 sc1
    s_add_u32 s36, s54, 25694208
    buffer_load_dwordx4 v[156:159], v1, s[4:7], s36 offen offset:1024 sc1
    s_add_u32 s36, s54, 25706496
    buffer_load_dwordx4 v[144:147], v1, s[4:7], s36 offen offset:0 sc1
    s_add_u32 s36, s54, 25706496
    buffer_load_dwordx4 v[160:163], v1, s[4:7], s36 offen offset:1024 sc1
    s_add_u32 s36, s54, 25718784
    buffer_load_dwordx4 v[148:151], v1, s[4:7], s36 offen offset:0 sc1
    s_add_u32 s36, s54, 25718784
    buffer_load_dwordx4 v[164:167], v1, s[4:7], s36 offen offset:1024 sc1
    s_add_u32 s36, s54, 25731072
    buffer_load_dwordx4 v[152:155], v1, s[4:7], s36 offen offset:0 sc1
    s_add_u32 s36, s54, 25731072
    buffer_load_dwordx4 v[168:171], v1, s[4:7], s36 offen offset:1024 sc1
    s_waitcnt vmcnt(0)
    v_xor_b32 v172, v30, v143
    v_xor_b32 v173, v30, v147
    v_xor_b32 v174, v30, v151
    v_xor_b32 v175, v30, v155
    v_xor_b32 v176, v30, v159
    v_xor_b32 v177, v30, v163
    v_xor_b32 v178, v30, v167
    v_xor_b32 v179, v30, v171
    v_or3_b32 v172, v172, v173, v174
    v_or3_b32 v175, v175, v176, v177
    v_or3_b32 v172, v172, v178, v179
    v_or_b32 v172, v172, v175
    v_cmp_ne_u32 vcc, 0, v172
    s_sub_u32 s39, s39, 1
    s_nop 3
    s_cbranch_vccz LMD_11
    s_cmp_lg_u32 s39, 0
    s_cbranch_scc1 LM_10L
    s_branch LMD_11
PI_12:
    s_mov_b32 s39, 20000
PI_12L:
    s_sleep 1
    s_add_u32 s36, s47, 0
    buffer_load_dwordx4 v[140:143], v1, s[4:7], s36 offen offset:0 sc1
    s_add_u32 s36, s47, 0
    buffer_load_dwordx4 v[144:147], v1, s[4:7], s36 offen offset:1024 sc1
    s_add_u32 s36, s47, 0
    buffer_load_dwordx4 v[148:151], v1, s[4:7], s36 offen offset:2048 sc1
    s_waitcnt vmcnt(0)
    v_xor_b32 v236, v30, v143
    v_xor_b32 v237, v30, v147
    v_xor_b32 v238, v30, v151
    v_or3_b32 v236, v236, v237, v238
    v_cmp_ne_u32 vcc, 0, v236
    s_sub_u32 s39, s39, 1
    s_nop 3
    s_cbranch_vccz PID_13
    s_cmp_lg_u32 s39, 0
    s_cbranch_scc1 PI_12L
    s_branch PID_13
PI_14:
    s_mov_b32 s39, 20000
PI_14L:
    s_sleep 1
    s_add_u32 s36, s47, 3072
    buffer_load_dwordx4 v[152:155], v1, s[4:7], s36 offen offset:0 sc1
    s_add_u32 s36, s47, 3072
    buffer_load_dwordx4 v[156:159], v1, s[4:7], s36 offen offset:1024 sc1
    s_add_u32 s36, s47, 3072
    buffer_load_dwordx4 v[160:163], v1, s[4:7], s36 offen offset:2048 sc1
    s_waitcnt vmcnt(0)
    v_xor_b32 v236, v30, v155
    v_xor_b32 v237, v30, v159
    v_xor_b32 v238, v30, v163
    v_or3_b32 v236, v236, v237, v238
    v_cmp_ne_u32 vcc, 0, v236
    s_sub_u32 s39, s39, 1
    s_nop 3
    s_cbranch_vccz PID_15
    s_cmp_lg_u32 s39, 0
    s_cbranch_scc1 PI_14L
    s_branch PID_15
PK_16:
    s_mov_b32 s39, 20000
PK_16L:
    s_sleep 1
    s_add_u32 s36, s47, 6144
    buffer_load_dwordx4 v[164:167], v1, s[4:7], s36 offen offset:0 sc1
    s_add_u32 s36, s47, 6144
    buffer_load_dwordx4 v[168:171], v1, s[4:7], s36 offen offset:1024 sc1
    s_add_u32 s36, s47, 6144
    buffer_load_dwordx4 v[172:175], v1, s[4:7], s36 offen offset:2048 sc1
    s_waitcnt vmcnt(0)
    v_xor_b32 v236, v30, v167
    v_xor_b32 v237, v30, v171
    v_xor_b32 v238, v30, v175
    v_or3_b32 v236, v236, v237, v238
    v_cmp_ne_u32 vcc, 0, v236
    s_sub_u32 s39, s39, 1
    s_nop 3
    s_cbranch_vccz PKD_17
    s_cmp_lg_u32 s39, 0
    s_cbranch_scc1 PK_16L
    s_branch PKD_17
MG_19:
    s_mov_b32 s39, 20000
MG_19L:
    s_sleep 1
    buffer_load_dword v30, v29, s[32:35], 0 offen sc1
    buffer_load_dwordx4 v[32:35], v28, s[32:35], 0 offen sc1
    buffer_load_dwordx4 v[36:39], v1, s[4:7], s25 offen sc1
    s_add_u32 s36, s25, 12288
    buffer_load_dwordx4 v[40:43], v1, s[4:7], s36 offen sc1
    s_add_u32 s36, s36, 12288
    buffer_load_dwordx4 v[44:47], v1, s[4:7], s36 offen sc1
    s_add_u32 s36, s36, 12288
    buffer_load_dwordx4 v[48:51], v1, s[4:7], s36 offen sc1
    s_waitcnt vmcnt(0)
    v_xor_b32 v52, v32, v39
    v_xor_b32 v53, v33, v43
    v_xor_b32 v54, v34, v47
    v_xor_b32 v55, v35, v51
    v_and_b32 v56, v32, v33
    v_and_b32 v57, v34, v35
    v_or3_b32 v52, v52, v53, v54
    v_and_b32 v56, v56, v57
    v_and_b32 v56, v56, v30
    v_not_b32 v56, v56
    v_and_b32 v56, 1, v56
    v_or3_b32 v52, v52, v55, v56
    v_cmp_ne_u32 vcc, 0, v52
    s_sub_u32 s39, s39, 1
    s_nop 3
    s_cbranch_vccz MGD_20
    s_cmp_lg_u32 s39, 0
    s_cbranch_scc1 MG_19L
    s_branch MGD_20
LM_26:
    s_mov_b32 s39, 20000
LM_26L:
    s_sleep 1
    s_add_u32 s36, s54, 25694208
    buffer_load_dwordx4 v[140:143], v1, s[4:7], s36 offen offset:0 sc1
    s_add_u32 s36, s54, 25694208
    buffer_load_dwordx4 v[156:159], v1, s[4:7], s36 offen offset:1024 sc1
    s_add_u32 s36, s54, 25706496
    buffer_load_dwordx4 v[144:147], v1, s[4:7], s36 offen offset:0 sc1
    s_add_u32 s36, s54, 25706496
    buffer_load_dwordx4 v[160:163], v1, s[4:7], s36 offen offset:1024 sc1
    s_add_u32 s36, s54, 25718784
    buffer_load_dwordx4 v[148:151], v1, s[4:7], s36 offen offset:0 sc1
    s_add_u32 s36, s54, 25718784
    buffer_load_dwordx4 v[164:167], v1, s[4:7], s36 offen offset:1024 sc1
    s_add_u32 s36, s54, 25731072
    buffer_load_dwordx4 v[152:155], v1, s[4:7], s36 offen offset:0 sc1
    s_add_u32 s36, s54, 25731072
    buffer_load_dwordx4 v[168:171], v1, s[4:7], s36 offen offset:1024 sc1
    s_waitcnt vmcnt(0)
    v_xor_b32 v172, v30, v143
    v_xor_b32 v173, v30, v147
    v_xor_b32 v174, v30, v151
    v_xor_b32 v175, v30, v155
    v_xor_b32 v176, v30, v159
    v_xor_b32 v177, v30, v163
    v_xor_b32 v178, v30, v167
    v_xor_b32 v179, v30, v171
    v_or3_b32 v172, v172, v173, v174
    v_or3_b32 v175, v175, v176, v177
    v_or3_b32 v172, v172, v178, v179
    v_or_b32 v172, v172, v175
    v_cmp_ne_u32 vcc, 0, v172
    s_sub_u32 s39, s39, 1
    s_nop 3
    s_cbranch_vccz LMD_27
    s_cmp_lg_u32 s39, 0
    s_cbranch_scc1 LM_26L
    s_branch LMD_27
PI_28:
    s_mov_b32 s39, 20000
PI_28L:
    s_sleep 1
    s_add_u32 s36, s47, 0
    buffer_load_dwordx4 v[140:143], v1, s[4:7], s36 offen offset:0 sc1
    s_add_u32 s36, s47, 0
    buffer_load_dwordx4 v[144:147], v1, s[4:7], s36 offen offset:1024 sc1
    s_add_u32 s36, s47, 0
    buffer_load_dwordx4 v[148:151], v1, s[4:7], s36 offen offset:2048 sc1
    s_waitcnt vmcnt(0)
    v_xor_b32 v236, v30, v143
    v_xor_b32 v237, v30, v147
    v_xor_b32 v238, v30, v151
    v_or3_b32 v236, v236, v237, v238
    v_cmp_ne_u32 vcc, 0, v236
    s_sub_u32 s39, s39, 1
    s_nop 3
    s_cbranch_vccz PID_29
    s_cmp_lg_u32 s39, 0
    s_cbranch_scc1 PI_28L
    s_branch PID_29
PI_30:
    s_mov_b32 s39, 20000
PI_30L:
    s_sleep 1
    s_add_u32 s36, s47, 3072
    buffer_load_dwordx4 v[152:155], v1, s[4:7], s36 offen offset:0 sc1
    s_add_u32 s36, s47, 3072
    buffer_load_dwordx4 v[156:159], v1, s[4:7], s36 offen offset:1024 sc1
    s_add_u32 s36, s47, 3072
    buffer_load_dwordx4 v[160:163], v1, s[4:7], s36 offen offset:2048 sc1
    s_waitcnt vmcnt(0)
    v_xor_b32 v236, v30, v155
    v_xor_b32 v237, v30, v159
    v_xor_b32 v238, v30, v163
    v_or3_b32 v236, v236, v237, v238
    v_cmp_ne_u32 vcc, 0, v236
    s_sub_u32 s39, s39, 1
    s_nop 3
    s_cbranch_vccz PID_31
    s_cmp_lg_u32 s39, 0
    s_cbranch_scc1 PI_30L
    s_branch PID_31
PK_32:
    s_mov_b32 s39, 20000
PK_32L:
    s_sleep 1
    s_add_u32 s36, s47, 6144
    buffer_load_dwordx4 v[164:167], v1, s[4:7], s36 offen offset:0 sc1
    s_add_u32 s36, s47, 6144
    buffer_load_dwordx4 v[168:171], v1, s[4:7], s36 offen offset:1024 sc1
    s_add_u32 s36, s47, 6144
    buffer_load_dwordx4 v[172:175], v1, s[4:7], s36 offen offset:2048 sc1
    s_waitcnt vmcnt(0)
    v_xor_b32 v236, v30, v167
    v_xor_b32 v237, v30, v171
    v_xor_b32 v238, v30, v175
    v_or3_b32 v236, v236, v237, v238
    v_cmp_ne_u32 vcc, 0, v236
    s_sub_u32 s39, s39, 1
    s_nop 3
    s_cbranch_vccz PKD_33
    s_cmp_lg_u32 s39, 0
    s_cbranch_scc1 PK_32L
    s_branch PKD_33
FI_38:
    s_mov_b32 s39, 20000
FI_38L:
    s_sleep 1
    buffer_load_dword v26, v10, s[4:7], s48 offen sc1
    s_waitcnt vmcnt(0)
    v_cmp_ne_u32 vcc, v30, v26
    s_sub_u32 s39, s39, 1
    s_nop 3
    s_cbranch_vccz FID_39
    s_cmp_lg_u32 s39, 0
    s_cbranch_scc1 FI_38L
    s_branch FID_39
PJ_40:
    s_mov_b32 s39, 20000
PJ_40L:
    s_sleep 1
    buffer_load_dwordx4 v[124:127], v1, s[4:7], s50 offen offset:0 sc1
    buffer_load_dwordx4 v[128:131], v1, s[4:7], s50 offen offset:1024 sc1
    buffer_load_dwordx4 v[132:135], v1, s[4:7], s50 offen offset:2048 sc1
    s_waitcnt vmcnt(0)
    v_xor_b32 v176, v30, v127
    v_xor_b32 v177, v30, v131
    v_xor_b32 v178, v30, v135
    v_or3_b32 v176, v176, v177, v178
    v_cmp_ne_u32 vcc, 0, v176
    s_sub_u32 s39, s39, 1
    s_nop 3
    s_cbranch_vccz PJD_41
    s_cmp_lg_u32 s39, 0
    s_cbranch_scc1 PJ_40L
    s_branch PJD_41
K_LAST:
    s_endpgm

.section .rodata,"a"
.p2align 6
.amdhsa_kernel adaLN_cond__spectral_fnet__dense_activation_relu__prompt_kernel
  .amdhsa_next_free_vgpr 512
  .amdhsa_next_free_sgpr 102
  .amdhsa_accum_offset 256
  .amdhsa_group_segment_fixed_size 0
  .amdhsa_kernarg_size 104
  .amdhsa_user_sgpr_count 2
  .amdhsa_user_sgpr_kernarg_segment_ptr 1
  .amdhsa_system_sgpr_workgroup_id_x 1
  .amdhsa_float_denorm_mode_32 3
  .amdhsa_float_denorm_mode_16_64 3
.end_amdhsa_kernel
```
